```python
import torch

def _softmax(x, axis=-1):
    return torch.softmax(x, dim=axis)
def _gelu(x):
    return torch.nn.functional.gelu(x, approximate="tanh")
def _silu(x):
    return torch.nn.functional.silu(x)
def _sigmoid(x):
    return torch.sigmoid(x)
def _layernorm(x, axis=-1, eps=1e-5):
    m = x.mean(dim=axis, keepdim=True)
    v = x.var(dim=axis, keepdim=True, unbiased=False)
    return (x - m) / torch.sqrt(v + eps)
def _scatter_add(tgt, idx, src, axis=0):
    return tgt.clone().index_add_(axis, idx, src)
def _segment_sum(src, seg, n):
    out = torch.zeros((n,) + src.shape[1:], dtype=src.dtype)
    return out.index_add_(0, seg, src)
def _pad(x, pw):
    flat = tuple(v for pair in reversed(pw) for v in pair)
    return torch.nn.functional.pad(x, flat)

kernel_name = 'sequential_preLN__mha_block__glu_gated_swiglu__prompt'

def setup_inputs():

    _w = (lambda a: (lambda t: t.to(torch.bfloat16) if t.is_floating_point() else t)(torch.as_tensor(a)))
    def _A_setup():
        B, S, D, H = 1, 2048, 448, 16
        return {
            "x": _w((lambda *s: torch.randn(*s, dtype=torch.bfloat16) * 0.05)(B, S, D)),
            "wqkv": _w((lambda *s: torch.randn(*s, dtype=torch.bfloat16) * 0.05)(D, 3 * D)),
            "wo": _w((lambda *s: torch.randn(*s, dtype=torch.bfloat16) * 0.05)(D, D)),
        }
    _A_in = _A_setup()

    def _B_setup():
        B, S, D, F = 1, 2048, 448, 1792
        return {
            "x": _w((lambda *s: torch.randn(*s, dtype=torch.bfloat16) * 0.05)(B, S, D)),
            "w1": _w((lambda *s: torch.randn(*s, dtype=torch.bfloat16) * 0.4)(D, F) * (2.0 / D) ** 0.5),
            "w3": _w((lambda *s: torch.randn(*s, dtype=torch.bfloat16) * 0.4)(D, F) * (2.0 / D) ** 0.5),
            "w2": _w((lambda *s: torch.randn(*s, dtype=torch.bfloat16) * 0.4)(F, D) * (2.0 / F) ** 0.5),
        }
    _B_in = _B_setup()

    return {
        "A_x": _A_in["x"],
        "A_wqkv": _A_in["wqkv"],
        "A_wo": _A_in["wo"],
        "B_x": _B_in["x"],
        "B_w1": _B_in["w1"],
        "B_w3": _B_in["w3"],
        "B_w2": _B_in["w2"],
    }

def reference(A_x, A_wqkv, A_wo, B_x, B_w1, B_w3, B_w2):
    def _A_ref(x, wqkv, wo):
        B, S, D = x.shape
        H = 16
        Dh = D // H
        qkv = (lambda x, *d: x.permute(*d))((x @ wqkv).reshape(B, S, 3, H, Dh), 2, 0, 3, 1, 4)
        q, k, v = qkv[0], qkv[1], qkv[2]
        scores = torch.einsum("bhqd,bhkd->bhqk", q, k) * (Dh ** -0.5)
        p = _softmax(scores, axis=-1)
        o = torch.einsum("bhqk,bhkd->bhqd", p, v)
        return (lambda x, *d: x.permute(*d))(o, 0, 2, 1, 3).reshape(B, S, D) @ wo

    def _B_ref(x, w1, w3, w2):
        gate = torch.einsum("bsd,df->bsf", x, w1)
        up = torch.einsum("bsd,df->bsf", x, w3)
        h = _silu(gate) * up
        out = torch.einsum("bsf,fd->bsd", h, w2)
        return out

    x = A_x
    h = x + _A_ref(_layernorm(x, axis=-1), A_wqkv, A_wo)
    h2 = h + _B_ref(_layernorm(h, axis=-1), B_w1, B_w3, B_w2)
    return h2
```

```asm
; @launch grid=(256,1,1) block=(256,1,1) lds=163840
.amdgcn_target "amdgcn-amd-amdhsa--gfx950"
.text
.p2align 12
.fill 832, 4, 0xbf800000
.globl sequential_preLN__mha_block__glu_gated_swiglu__prompt_kernel
.p2align 8
.type sequential_preLN__mha_block__glu_gated_swiglu__prompt_kernel,@function
sequential_preLN__mha_block__glu_gated_swiglu__prompt_kernel:
    s_cmp_ge_u32 s2, 256
    s_cbranch_scc1 Lend
    s_load_dwordx16 s[32:47], s[0:1], 0
    s_load_dwordx2 s[50:51], s[0:1], 72
    v_lshrrev_b32 v2, 6, v0
    v_and_b32 v1, 63, v0
    v_readfirstlane_b32 s3, v2
    v_lshlrev_b32 v2, 4, v1
    v_lshlrev_b32 v3, 7, v1
    s_and_b32 s53, s2, 7
    s_lshr_b32 s31, s2, 3
    s_and_b32 s25, s53, 1
    s_lshl_b32 s25, s25, 3
    s_and_b32 s54, s31, 7
    s_add_u32 s25, s25, s54
    s_lshr_b32 s26, s53, 1
    s_lshl_b32 s26, s26, 2
    s_lshr_b32 s54, s31, 3
    s_add_u32 s26, s26, s54
    s_mul_i32 s54, s31, 9363
    s_lshr_b32 s54, s54, 16
    s_mul_i32 s55, s54, 7
    s_sub_u32 s28, s31, s55
    s_lshl_b32 s27, s53, 2
    s_add_u32 s27, s27, s54
    s_and_b32 s29, s53, 1
    s_lshl_b32 s29, s29, 3
    s_and_b32 s54, s31, 7
    s_add_u32 s29, s29, s54
    s_lshr_b32 s30, s53, 1
    s_lshl_b32 s30, s30, 2
    s_lshr_b32 s54, s31, 3
    s_add_u32 s30, s30, s54
    s_getpc_b64 s[54:55]
Lpc:
    s_lshl_b32 s53, s31, 2
    s_add_u32 s53, s53, s3
    s_mul_i32 s53, s53, 3
    v_add_u32 v4, s53, v1
    v_lshlrev_b32 v4, 7, v4
    v_min_u32 v4, Lcode_end-Lpc-4, v4
    v_mov_b32 v5, s55
    v_add_co_u32 v4, vcc, s54, v4
    s_nop 1
    v_addc_co_u32 v5, vcc, 0, v5, vcc
    s_mov_b64 exec, 7
    global_load_dword a4, v[4:5], off
    s_mov_b64 exec, -1
    v_lshrrev_b32 v229, 5, v1
    v_and_b32 v231, 31, v1
    v_lshrrev_b32 v233, 3, v1
    v_add_u32 v233, 0, v233
    v_lshrrev_b32 v234, 1, v233
    v_and_b32 v234, 7, v234
    v_and_b32 v235, 7, v1
    v_xor_b32 v234, v234, v235
    v_lshlrev_b32 v234, 4, v234
    v_mul_u32_u24 v233, 896, v233
    v_add_u32 v204, v233, v234
    v_lshrrev_b32 v233, 3, v1
    v_add_u32 v233, 8, v233
    v_lshrrev_b32 v234, 1, v233
    v_and_b32 v234, 7, v234
    v_and_b32 v235, 7, v1
    v_xor_b32 v234, v234, v235
    v_lshlrev_b32 v234, 4, v234
    v_mul_u32_u24 v233, 896, v233
    v_add_u32 v205, v233, v234
    v_subrev_u32 v205, 1024, v205
    v_lshrrev_b32 v233, 3, v1
    v_lshrrev_b32 v234, 2, v1
    v_and_b32 v234, 4, v234
    v_xor_b32 v234, v234, v235
    v_min_u32 v234, 6, v234
    v_mul_u32_u24 v233, 2688, v233
    v_lshl_add_u32 v206, v234, 4, v233
    v_add_u32 v207, 20480, v206
    s_lshl_b32 s56, s26, 2
    s_add_u32 s56, s56, s3
    s_mul_i32 s56, s56, 28672
    s_mul_i32 s57, s3, 43008
    s_lshr_b32 s53, s25, 1
    s_mul_i32 s53, s53, 112
    s_add_u32 s57, s57, s53
    s_and_b32 s53, s25, 1
    s_mul_i32 s53, s53, 896
    s_add_u32 s57, s57, s53
    s_add_u32 s57, s57, 896
    s_mul_i32 s58, s3, 28672
    s_lshl_b32 s59, s3, 11
    s_lshr_b32 s55, s31, 3
    s_mul_i32 s55, s55, 2
    s_and_b32 s53, s31, 7
    s_add_u32 s55, s55, s53
    s_mul_i32 s53, s55, 37
    s_lshr_b32 s53, s53, 8
    s_mul_i32 s53, s53, 7
    s_sub_u32 s55, s55, s53
    s_lshl_b32 s100, s55, 2
    s_lshl_b32 s99, s55, 7
    s_mov_b32 s6, 1835008
    s_mov_b32 s7, 0x20000
    s_waitcnt lgkmcnt(0)
    s_mov_b32 s4, s32
    s_mov_b32 s5, s33
    s_mov_b32 s39, s55
    s_add_u32 m0, s58, 0
    s_add_u32 s53, s99, s56
    buffer_load_dwordx4 v204, s[4:7], s53 offen offset:0 lds
    buffer_load_dwordx4 v205, s[4:7], s53 offen offset:1024 lds
    s_add_u32 s53, s53, 12288
    buffer_load_dwordx4 v204, s[4:7], s53 offen offset:2048 lds
    buffer_load_dwordx4 v205, s[4:7], s53 offen offset:3072 lds
    s_add_u32 s99, s99, 128
    s_cmp_eq_u32 s99, 896
    s_cselect_b32 s99, 0, s99
    s_mov_b32 s8, s34
    s_mov_b32 s9, s35
    s_mov_b32 s10, 1204224
    s_mov_b32 s11, 0x20000
    s_mov_b32 s20, s36
    s_mov_b32 s21, s37
    s_mov_b32 s22, 401408
    s_mov_b32 s23, 0x20000
    s_lshl_b32 s32, s25, 4
    s_add_u32 s32, s32, s26
    s_lshl_b32 s54, s3, 7
    s_add_u32 s54, s54, s32
    s_cmp_lt_u32 s54, 112
    s_cselect_b32 s32, s32, 0x100000
    s_mul_i32 s33, s32, 224
    s_lshl_b32 s33, s33, 4
    s_min_u32 s33, s33, 0x40000000
    v_cmp_gt_u32 vcc, 56, v1
    v_mov_b32 v238, 0x40000000
    s_nop 0
    v_cndmask_b32 v238, v238, v2, vcc
    buffer_load_dwordx4 a[232:235], v238, s[20:23], s33 offen offset:0
    buffer_load_dwordx4 a[236:239], v238, s[20:23], s33 offen offset:896
    buffer_load_dwordx4 a[240:243], v238, s[20:23], s33 offen offset:1792
    buffer_load_dwordx4 a[244:247], v238, s[20:23], s33 offen offset:2688
    s_add_u32 m0, s59, 114688
    s_mul_i32 s53, s39, 172032
    s_add_u32 s53, s53, s57
    buffer_load_dwordx4 v206, s[8:11], s53 offen lds
    buffer_load_dwordx4 v207, s[8:11], s53 offen offset:1024 lds
    s_add_u32 s39, s39, 1
    s_cmp_eq_u32 s39, 7
    s_cselect_b32 s39, 0, s39
    s_add_u32 m0, s59, 122880
    s_mul_i32 s53, s39, 172032
    s_add_u32 s53, s53, s57
    buffer_load_dwordx4 v206, s[8:11], s53 offen lds
    buffer_load_dwordx4 v207, s[8:11], s53 offen offset:1024 lds
    s_add_u32 s39, s39, 1
    s_cmp_eq_u32 s39, 7
    s_cselect_b32 s39, 0, s39
    s_add_u32 m0, s58, 4096
    s_add_u32 s53, s99, s56
    buffer_load_dwordx4 v204, s[4:7], s53 offen offset:0 lds
    buffer_load_dwordx4 v205, s[4:7], s53 offen offset:1024 lds
    s_add_u32 s53, s53, 12288
    buffer_load_dwordx4 v204, s[4:7], s53 offen offset:2048 lds
    buffer_load_dwordx4 v205, s[4:7], s53 offen offset:3072 lds
    s_add_u32 s99, s99, 128
    s_cmp_eq_u32 s99, 896
    s_cselect_b32 s99, 0, s99
    s_add_u32 s54, s50, 16777216
    s_addc_u32 s55, s51, 0
    s_load_dword s24, s[54:55], 0
    s_mov_b32 s12, s50
    s_mov_b32 s13, s51
    s_mov_b32 s14, 18874368
    s_mov_b32 s15, 0x20000
    s_mul_i32 s48, s3, 7168
    s_add_u32 s48, s48, 16384
    s_mul_i32 s49, s3, 7
    s_add_u32 s49, s49, s100
    s_cmp_ge_u32 s49, 28
    s_cselect_b32 s53, 28, 0
    s_sub_u32 s49, s49, s53
    s_mul_i32 s38, s25, 56
    v_lshrrev_b32 v233, 2, v1
    v_mul_u32_u24 v233, 2688, v233
    v_and_b32 v236, 3, v1
    v_lshl_add_u32 v232, v236, 4, v233
    v_lshrrev_b32 v233, 1, v231
    v_and_b32 v233, 7, v233
    v_lshlrev_b32 v234, 7, v231
    v_add_u32 v234, s58, v234
    v_bfe_u32 v235, v1, 4, 1
    v_lshlrev_b32 v235, 5, v235
    v_lshl_add_u32 v235, v236, 3, v235
    v_bfe_u32 v236, v1, 2, 2
    v_lshl_add_u32 v238, v229, 3, v236
    v_lshl_add_u32 v239, v238, 6, v235
    v_bfe_u32 v236, v1, 3, 1
    v_lshlrev_b32 v236, 6, v236
    v_add_u32 v237, 56, v235
    v_xor_b32 v237, v237, v236
    v_xor_b32 v235, v235, v236
    v_sub_u32 v0, v237, v235
    v_lshl_add_u32 v235, v238, 7, v235
    v_add_u32 v235, 114688, v235
    s_add_u32 s53, s3, 0
    s_and_b32 s53, s53, 3
    s_lshl_b32 s54, s53, 1
    v_add_u32 v237, s54, v229
    v_xor_b32 v237, v237, v233
    v_lshl_add_u32 v208, v237, 4, v234
    s_lshl_b32 s54, s53, 11
    v_add_u32 v212, s54, v235
    v_add_u32 v216, v0, v212
    s_add_u32 s53, s3, 1
    s_and_b32 s53, s53, 3
    s_lshl_b32 s54, s53, 1
    v_add_u32 v237, s54, v229
    v_xor_b32 v237, v237, v233
    v_lshl_add_u32 v209, v237, 4, v234
    s_lshl_b32 s54, s53, 11
    v_add_u32 v213, s54, v235
    v_add_u32 v217, v0, v213
    s_add_u32 s53, s3, 2
    s_and_b32 s53, s53, 3
    s_lshl_b32 s54, s53, 1
    v_add_u32 v237, s54, v229
    v_xor_b32 v237, v237, v233
    v_lshl_add_u32 v210, v237, 4, v234
    s_lshl_b32 s54, s53, 11
    v_add_u32 v214, s54, v235
    v_add_u32 v218, v0, v214
    s_add_u32 s53, s3, 3
    s_and_b32 s53, s53, 3
    s_lshl_b32 s54, s53, 1
    v_add_u32 v237, s54, v229
    v_xor_b32 v237, v237, v233
    v_lshl_add_u32 v211, v237, 4, v234
    s_lshl_b32 s54, s53, 11
    v_add_u32 v215, s54, v235
    v_add_u32 v219, v0, v215
    v_mov_b32 v221, 0
    v_mov_b32 v223, 0
    v_mov_b32 v225, 0
    v_mov_b32 v227, 0
    v_mov_b32 v220, 0
    v_mov_b32 v222, 0
    v_mov_b32 v224, 0
    s_mov_b32 s52, 0x3f803f80
    s_lshl_b32 s54, s2, 2
    s_add_u32 s54, s54, s3
    s_mov_b32 s18, 1605632
    s_cmp_ge_u32 s54, 512
    s_cselect_b32 s16, s42, s40
    s_cselect_b32 s17, s43, s41
    s_cselect_b32 s18, 1605632, s18
    s_cselect_b32 s55, 512, 0
    s_sub_u32 s54, s54, s55
    s_mul_i32 s54, s54, 3200
    s_min_u32 s54, s54, s18
    s_sub_u32 s18, s18, s54
    s_add_u32 s16, s16, s54
    s_addc_u32 s17, s17, 0
    s_mov_b32 s19, 0x20000
    s_mov_b64 exec, 0
    s_cmp_eq_u32 s3, 0
    s_cbranch_scc1 Lpage1
    s_cmp_eq_u32 s3, 1
    s_cbranch_scc1 Lpage2
    s_cmp_eq_u32 s3, 2
    s_cbranch_scc1 Lpage3
    s_cmp_eq_u32 s3, 3
    s_cbranch_scc1 Lpage4
Lvis0:
    s_mov_b64 exec, -1
    v_mov_b32 v52, s52
    v_mov_b32 v53, s52
    v_mov_b32 v54, s52
    v_mov_b32 v55, s52
    s_waitcnt vmcnt(12) lgkmcnt(0)
    s_add_u32 s24, s24, 1
    ds_read_b128 v[60:63], v208 offset:0
    ds_read_b128 v[64:67], v209 offset:0
    ds_read_b128 v[68:71], v210 offset:0
    ds_read_b128 v[72:75], v211 offset:0
    v_mov_b32 v0, s24
    v_add_u32 v0, -1, v0
    v_lshlrev_b32 v238, 2, v1
    s_mov_b32 exec_lo, -1
    s_mov_b32 exec_hi, 0x0
    s_lshr_b32 s54, s25, 1
    s_lshl_b32 s54, s54, 2
    s_add_u32 s54, s54, s3
    s_lshl_b32 s54, s54, 1
    s_and_b32 s55, s25, 1
    s_add_u32 s54, s54, s55
    s_lshl_b32 s54, s54, 4
    s_add_u32 s54, s54, s26
    s_lshl_b32 s54, s54, 7
    s_add_u32 s54, s54, 16842752
    buffer_store_dword v0, v238, s[12:15], s54 offen sc1
    s_lshl_b32 s54, s26, 2
    s_add_u32 s54, s54, s3
    s_lshl_b32 s54, s54, 4
    s_add_u32 s54, s54, s25
    s_lshl_b32 s54, s54, 7
    s_add_u32 s54, s54, 16973824
    buffer_store_dword v0, v238, s[12:15], s54 offen sc1
    s_lshl_b32 s54, s29, 2
    s_add_u32 s54, s54, s3
    s_lshl_b32 s54, s54, 4
    s_add_u32 s54, s54, s30
    s_lshl_b32 s54, s54, 7
    s_add_u32 s54, s54, 17235968
    buffer_store_dword v0, v238, s[12:15], s54 offen sc1
    s_add_u32 s54, s54, 131072
    buffer_store_dword v0, v238, s[12:15], s54 offen sc1
    s_add_u32 s54, s54, 131072
    buffer_store_dword v0, v238, s[12:15], s54 offen sc1
    s_add_u32 s54, s54, 131072
    s_lshl_b32 s54, s32, 7
    s_add_u32 s54, s54, 17629184
    buffer_store_dword v0, v238, s[12:15], s54 offen sc1
    s_lshl_b32 s54, s27, 1
    s_and_b32 s55, s3, 1
    s_add_u32 s54, s54, s55
    s_lshl_b32 s54, s54, 3
    s_add_u32 s54, s54, s28
    s_lshl_b32 s54, s54, 1
    s_lshr_b32 s55, s3, 1
    s_add_u32 s54, s54, s55
    s_lshl_b32 s54, s54, 7
    s_add_u32 s54, s54, 17104896
    s_cmp_ge_u32 s31, 28
    s_cselect_b32 s54, 0x40000000, s54
    buffer_store_dword v0, v238, s[12:15], s54 offen sc1
    s_mov_b64 exec, -1
    s_bitcmp1_b32 s25, 0
    s_cbranch_scc1 LAV
    s_add_u32 m0, s58, 8192
    s_add_u32 s53, s99, s56
    buffer_load_dwordx4 v204, s[4:7], s53 offen offset:0 lds
    buffer_load_dwordx4 v205, s[4:7], s53 offen offset:1024 lds
    s_add_u32 s53, s53, 12288
    buffer_load_dwordx4 v204, s[4:7], s53 offen offset:2048 lds
    buffer_load_dwordx4 v205, s[4:7], s53 offen offset:3072 lds
    s_add_u32 s99, s99, 128
    s_cmp_eq_u32 s99, 896
    s_cselect_b32 s99, 0, s99
    s_waitcnt vmcnt(11)
    ds_read_b128 v[76:79], v208 offset:4096
    ds_read_b128 v[80:83], v209 offset:4096
    ds_read_b128 v[84:87], v210 offset:4096
    ds_read_b128 v[88:91], v211 offset:4096
    s_barrier
    ds_read_b64_tr_b16 v[172:173], v212 offset:0
    ds_read_b64_tr_b16 v[174:175], v212 offset:512
    ds_read_b64_tr_b16 v[176:177], v216 offset:0
    ds_read_b64_tr_b16 v[178:179], v216 offset:512
    ds_read_b64_tr_b16 v[180:181], v213 offset:0
    ds_read_b64_tr_b16 v[182:183], v213 offset:512
    ds_read_b64_tr_b16 v[184:185], v217 offset:0
    ds_read_b64_tr_b16 v[186:187], v217 offset:512
    s_waitcnt lgkmcnt(12)
    v_dot2c_f32_bf16 v221, s52, v60
    v_dot2c_f32_bf16 v225, v60, v60
    v_dot2c_f32_bf16 v223, s52, v61
    v_dot2c_f32_bf16 v227, v61, v61
    v_dot2c_f32_bf16 v221, s52, v62
    v_dot2c_f32_bf16 v225, v62, v62
    v_dot2c_f32_bf16 v223, s52, v63
    v_dot2c_f32_bf16 v227, v63, v63
    s_add_u32 m0, s58, 12288
    s_add_u32 s53, s99, s56
    buffer_load_dwordx4 v204, s[4:7], s53 offen offset:0 lds
    buffer_load_dwordx4 v205, s[4:7], s53 offen offset:1024 lds
    v_dot2c_f32_bf16 v221, s52, v64
    v_dot2c_f32_bf16 v225, v64, v64
    v_dot2c_f32_bf16 v223, s52, v65
    v_dot2c_f32_bf16 v227, v65, v65
    v_dot2c_f32_bf16 v221, s52, v66
    v_dot2c_f32_bf16 v225, v66, v66
    v_dot2c_f32_bf16 v223, s52, v67
    v_dot2c_f32_bf16 v227, v67, v67
    s_add_u32 s53, s53, 12288
    buffer_load_dwordx4 v204, s[4:7], s53 offen offset:2048 lds
    buffer_load_dwordx4 v205, s[4:7], s53 offen offset:3072 lds
    s_add_u32 s99, s99, 128
    s_cmp_eq_u32 s99, 896
    s_cselect_b32 s99, 0, s99
    v_dot2c_f32_bf16 v221, s52, v68
    v_dot2c_f32_bf16 v225, v68, v68
    v_dot2c_f32_bf16 v223, s52, v69
    v_dot2c_f32_bf16 v227, v69, v69
    v_dot2c_f32_bf16 v221, s52, v70
    v_dot2c_f32_bf16 v225, v70, v70
    v_dot2c_f32_bf16 v223, s52, v71
    v_dot2c_f32_bf16 v227, v71, v71
    s_add_u32 m0, s58, 16384
    s_add_u32 s53, s99, s56
    buffer_load_dwordx4 v204, s[4:7], s53 offen offset:0 lds
    buffer_load_dwordx4 v205, s[4:7], s53 offen offset:1024 lds
    v_dot2c_f32_bf16 v221, s52, v72
    v_dot2c_f32_bf16 v225, v72, v72
    v_dot2c_f32_bf16 v223, s52, v73
    v_dot2c_f32_bf16 v227, v73, v73
    v_dot2c_f32_bf16 v221, s52, v74
    v_dot2c_f32_bf16 v225, v74, v74
    v_dot2c_f32_bf16 v223, s52, v75
    v_dot2c_f32_bf16 v227, v75, v75
    s_add_u32 s53, s53, 12288
    buffer_load_dwordx4 v204, s[4:7], s53 offen offset:2048 lds
    buffer_load_dwordx4 v205, s[4:7], s53 offen offset:3072 lds
    s_add_u32 s99, s99, 128
    s_cmp_eq_u32 s99, 896
    s_cselect_b32 s99, 0, s99
    s_waitcnt lgkmcnt(4)
    v_mfma_f32_32x32x16_bf16 v[36:51], v[52:55], v[172:175], 0
    s_add_u32 m0, s59, 131072
    s_mul_i32 s53, s39, 172032
    s_add_u32 s53, s53, s57
    buffer_load_dwordx4 v206, s[8:11], s53 offen lds
    v_mfma_f32_32x32x16_bf16 v[240:255], v[52:55], v[176:179], 0
    buffer_load_dwordx4 v207, s[8:11], s53 offen offset:1024 lds
    s_add_u32 s39, s39, 1
    s_cmp_eq_u32 s39, 7
    s_cselect_b32 s39, 0, s39
    v_mfma_f32_32x32x16_bf16 v[4:19], v[172:175], v[60:63], 0
    ds_read_b64_tr_b16 v[188:189], v214 offset:0
    ds_read_b64_tr_b16 v[190:191], v214 offset:512
    s_add_u32 m0, s58, 20480
    s_add_u32 s53, s99, s56
    buffer_load_dwordx4 v204, s[4:7], s53 offen offset:0 lds
    v_mfma_f32_32x32x16_bf16 v[20:35], v[176:179], v[60:63], 0
    ds_read_b64_tr_b16 v[192:193], v218 offset:0
    ds_read_b64_tr_b16 v[194:195], v218 offset:512
    buffer_load_dwordx4 v205, s[4:7], s53 offen offset:1024 lds
    s_waitcnt lgkmcnt(4)
    v_mfma_f32_32x32x16_bf16 v[4:19], v[180:183], v[64:67], v[4:19]
    ds_read_b64_tr_b16 v[196:197], v215 offset:0
    ds_read_b64_tr_b16 v[198:199], v215 offset:512
    s_add_u32 s53, s53, 12288
    buffer_load_dwordx4 v204, s[4:7], s53 offen offset:2048 lds
    v_mfma_f32_32x32x16_bf16 v[20:35], v[184:187], v[64:67], v[20:35]
    ds_read_b64_tr_b16 v[200:201], v219 offset:0
    ds_read_b64_tr_b16 v[202:203], v219 offset:512
    buffer_load_dwordx4 v205, s[4:7], s53 offen offset:3072 lds
    s_add_u32 s99, s99, 128
    s_cmp_eq_u32 s99, 896
    s_cselect_b32 s99, 0, s99
    s_waitcnt lgkmcnt(4)
    v_mfma_f32_32x32x16_bf16 v[4:19], v[188:191], v[68:71], v[4:19]
    ds_read_b64_tr_b16 v[172:173], v212 offset:8192
    ds_read_b64_tr_b16 v[174:175], v212 offset:8704
    s_add_u32 m0, s58, 24576
    s_add_u32 s53, s99, s56
    buffer_load_dwordx4 v204, s[4:7], s53 offen offset:0 lds
    v_mfma_f32_32x32x16_bf16 v[20:35], v[192:195], v[68:71], v[20:35]
    ds_read_b64_tr_b16 v[176:177], v216 offset:8192
    ds_read_b64_tr_b16 v[178:179], v216 offset:8704
    buffer_load_dwordx4 v205, s[4:7], s53 offen offset:1024 lds
    s_waitcnt lgkmcnt(4)
    v_mfma_f32_32x32x16_bf16 v[4:19], v[196:199], v[72:75], v[4:19]
    ds_read_b64_tr_b16 v[180:181], v213 offset:8192
    ds_read_b64_tr_b16 v[182:183], v213 offset:8704
    s_add_u32 s53, s53, 12288
    buffer_load_dwordx4 v204, s[4:7], s53 offen offset:2048 lds
    v_mfma_f32_32x32x16_bf16 v[20:35], v[200:203], v[72:75], v[20:35]
    ds_read_b64_tr_b16 v[184:185], v217 offset:8192
    ds_read_b64_tr_b16 v[186:187], v217 offset:8704
    buffer_load_dwordx4 v205, s[4:7], s53 offen offset:3072 lds
    s_add_u32 s99, s99, 128
    s_cmp_eq_u32 s99, 896
    s_cselect_b32 s99, 0, s99
    s_waitcnt vmcnt(18)
    ds_read_b128 v[92:95], v208 offset:8192
    ds_read_b128 v[96:99], v209 offset:8192
    ds_read_b128 v[100:103], v210 offset:8192
    ds_read_b128 v[104:107], v211 offset:8192
    s_waitcnt lgkmcnt(4)
    v_dot2c_f32_bf16 v221, s52, v76
    v_dot2c_f32_bf16 v225, v76, v76
    v_dot2c_f32_bf16 v223, s52, v77
    v_dot2c_f32_bf16 v227, v77, v77
    v_dot2c_f32_bf16 v221, s52, v78
    v_dot2c_f32_bf16 v225, v78, v78
    v_dot2c_f32_bf16 v223, s52, v79
    v_dot2c_f32_bf16 v227, v79, v79
    s_add_u32 m0, s59, 139264
    s_mul_i32 s53, s39, 172032
    s_add_u32 s53, s53, s57
    buffer_load_dwordx4 v206, s[8:11], s53 offen lds
    buffer_load_dwordx4 v207, s[8:11], s53 offen offset:1024 lds
    s_add_u32 s39, s39, 1
    s_cmp_eq_u32 s39, 7
    s_cselect_b32 s39, 0, s39
    v_dot2c_f32_bf16 v221, s52, v80
    v_dot2c_f32_bf16 v225, v80, v80
    v_dot2c_f32_bf16 v223, s52, v81
    v_dot2c_f32_bf16 v227, v81, v81
    v_dot2c_f32_bf16 v221, s52, v82
    v_dot2c_f32_bf16 v225, v82, v82
    v_dot2c_f32_bf16 v223, s52, v83
    v_dot2c_f32_bf16 v227, v83, v83
    s_add_u32 m0, s59, 147456
    s_mul_i32 s53, s39, 172032
    s_add_u32 s53, s53, s57
    buffer_load_dwordx4 v206, s[8:11], s53 offen lds
    buffer_load_dwordx4 v207, s[8:11], s53 offen offset:1024 lds
    s_add_u32 s39, s39, 1
    s_cmp_eq_u32 s39, 7
    s_cselect_b32 s39, 0, s39
    v_dot2c_f32_bf16 v221, s52, v84
    v_dot2c_f32_bf16 v225, v84, v84
    v_dot2c_f32_bf16 v223, s52, v85
    v_dot2c_f32_bf16 v227, v85, v85
    v_dot2c_f32_bf16 v221, s52, v86
    v_dot2c_f32_bf16 v225, v86, v86
    v_dot2c_f32_bf16 v223, s52, v87
    v_dot2c_f32_bf16 v227, v87, v87
    v_dot2c_f32_bf16 v221, s52, v88
    v_dot2c_f32_bf16 v225, v88, v88
    v_dot2c_f32_bf16 v223, s52, v89
    v_dot2c_f32_bf16 v227, v89, v89
    v_dot2c_f32_bf16 v221, s52, v90
    v_dot2c_f32_bf16 v225, v90, v90
    v_dot2c_f32_bf16 v223, s52, v91
    v_dot2c_f32_bf16 v227, v91, v91
    s_waitcnt lgkmcnt(4)
    v_mfma_f32_32x32x16_bf16 v[36:51], v[52:55], v[172:175], v[36:51]
    v_mfma_f32_32x32x16_bf16 v[240:255], v[52:55], v[176:179], v[240:255]
    v_mfma_f32_32x32x16_bf16 v[4:19], v[172:175], v[76:79], v[4:19]
    ds_read_b64_tr_b16 v[188:189], v214 offset:8192
    ds_read_b64_tr_b16 v[190:191], v214 offset:8704
    v_mfma_f32_32x32x16_bf16 v[20:35], v[176:179], v[76:79], v[20:35]
    ds_read_b64_tr_b16 v[192:193], v218 offset:8192
    ds_read_b64_tr_b16 v[194:195], v218 offset:8704
    s_waitcnt lgkmcnt(4)
    v_mfma_f32_32x32x16_bf16 v[4:19], v[180:183], v[80:83], v[4:19]
    ds_read_b64_tr_b16 v[196:197], v215 offset:8192
    ds_read_b64_tr_b16 v[198:199], v215 offset:8704
    v_mfma_f32_32x32x16_bf16 v[20:35], v[184:187], v[80:83], v[20:35]
    ds_read_b64_tr_b16 v[200:201], v219 offset:8192
    ds_read_b64_tr_b16 v[202:203], v219 offset:8704
    s_waitcnt lgkmcnt(4)
    v_mfma_f32_32x32x16_bf16 v[4:19], v[188:191], v[84:87], v[4:19]
    v_mfma_f32_32x32x16_bf16 v[20:35], v[192:195], v[84:87], v[20:35]
    s_waitcnt lgkmcnt(0)
    v_mfma_f32_32x32x16_bf16 v[4:19], v[196:199], v[88:91], v[4:19]
    v_mfma_f32_32x32x16_bf16 v[20:35], v[200:203], v[88:91], v[20:35]
    s_waitcnt vmcnt(18)
    ds_read_b128 v[108:111], v208 offset:12288
    ds_read_b128 v[112:115], v209 offset:12288
    ds_read_b128 v[116:119], v210 offset:12288
    ds_read_b128 v[120:123], v211 offset:12288
    s_waitcnt lgkmcnt(4)
    v_dot2c_f32_bf16 v221, s52, v92
    v_dot2c_f32_bf16 v225, v92, v92
    v_dot2c_f32_bf16 v223, s52, v93
    v_dot2c_f32_bf16 v227, v93, v93
    v_dot2c_f32_bf16 v221, s52, v94
    v_dot2c_f32_bf16 v225, v94, v94
    v_dot2c_f32_bf16 v223, s52, v95
    v_dot2c_f32_bf16 v227, v95, v95
    v_dot2c_f32_bf16 v221, s52, v96
    v_dot2c_f32_bf16 v225, v96, v96
    v_dot2c_f32_bf16 v223, s52, v97
    v_dot2c_f32_bf16 v227, v97, v97
    v_dot2c_f32_bf16 v221, s52, v98
    v_dot2c_f32_bf16 v225, v98, v98
    v_dot2c_f32_bf16 v223, s52, v99
    v_dot2c_f32_bf16 v227, v99, v99
    v_dot2c_f32_bf16 v221, s52, v100
    v_dot2c_f32_bf16 v225, v100, v100
    v_dot2c_f32_bf16 v223, s52, v101
    v_dot2c_f32_bf16 v227, v101, v101
    v_dot2c_f32_bf16 v221, s52, v102
    v_dot2c_f32_bf16 v225, v102, v102
    v_dot2c_f32_bf16 v223, s52, v103
    v_dot2c_f32_bf16 v227, v103, v103
    v_dot2c_f32_bf16 v221, s52, v104
    v_dot2c_f32_bf16 v225, v104, v104
    v_dot2c_f32_bf16 v223, s52, v105
    v_dot2c_f32_bf16 v227, v105, v105
    v_dot2c_f32_bf16 v221, s52, v106
    v_dot2c_f32_bf16 v225, v106, v106
    v_dot2c_f32_bf16 v223, s52, v107
    v_dot2c_f32_bf16 v227, v107, v107
    s_waitcnt vmcnt(14)
    ds_read_b128 v[124:127], v208 offset:16384
    ds_read_b128 v[128:131], v209 offset:16384
    ds_read_b128 v[132:135], v210 offset:16384
    ds_read_b128 v[136:139], v211 offset:16384
    s_waitcnt lgkmcnt(4)
    v_dot2c_f32_bf16 v221, s52, v108
    v_dot2c_f32_bf16 v225, v108, v108
    v_dot2c_f32_bf16 v223, s52, v109
    v_dot2c_f32_bf16 v227, v109, v109
    v_dot2c_f32_bf16 v221, s52, v110
    v_dot2c_f32_bf16 v225, v110, v110
    v_dot2c_f32_bf16 v223, s52, v111
    v_dot2c_f32_bf16 v227, v111, v111
    v_dot2c_f32_bf16 v221, s52, v112
    v_dot2c_f32_bf16 v225, v112, v112
    v_dot2c_f32_bf16 v223, s52, v113
    v_dot2c_f32_bf16 v227, v113, v113
    v_dot2c_f32_bf16 v221, s52, v114
    v_dot2c_f32_bf16 v225, v114, v114
    v_dot2c_f32_bf16 v223, s52, v115
    v_dot2c_f32_bf16 v227, v115, v115
    v_dot2c_f32_bf16 v221, s52, v116
    v_dot2c_f32_bf16 v225, v116, v116
    v_dot2c_f32_bf16 v223, s52, v117
    v_dot2c_f32_bf16 v227, v117, v117
    v_dot2c_f32_bf16 v221, s52, v118
    v_dot2c_f32_bf16 v225, v118, v118
    v_dot2c_f32_bf16 v223, s52, v119
    v_dot2c_f32_bf16 v227, v119, v119
    v_dot2c_f32_bf16 v221, s52, v120
    v_dot2c_f32_bf16 v225, v120, v120
    v_dot2c_f32_bf16 v223, s52, v121
    v_dot2c_f32_bf16 v227, v121, v121
    v_dot2c_f32_bf16 v221, s52, v122
    v_dot2c_f32_bf16 v225, v122, v122
    v_dot2c_f32_bf16 v223, s52, v123
    v_dot2c_f32_bf16 v227, v123, v123
    s_waitcnt vmcnt(8)
    ds_read_b128 v[140:143], v208 offset:20480
    ds_read_b128 v[144:147], v209 offset:20480
    ds_read_b128 v[148:151], v210 offset:20480
    ds_read_b128 v[152:155], v211 offset:20480
    s_waitcnt lgkmcnt(4)
    v_dot2c_f32_bf16 v221, s52, v124
    v_dot2c_f32_bf16 v225, v124, v124
    v_dot2c_f32_bf16 v223, s52, v125
    v_dot2c_f32_bf16 v227, v125, v125
    v_dot2c_f32_bf16 v221, s52, v126
    v_dot2c_f32_bf16 v225, v126, v126
    v_dot2c_f32_bf16 v223, s52, v127
    v_dot2c_f32_bf16 v227, v127, v127
    v_dot2c_f32_bf16 v221, s52, v128
    v_dot2c_f32_bf16 v225, v128, v128
    v_dot2c_f32_bf16 v223, s52, v129
    v_dot2c_f32_bf16 v227, v129, v129
    v_dot2c_f32_bf16 v221, s52, v130
    v_dot2c_f32_bf16 v225, v130, v130
    v_dot2c_f32_bf16 v223, s52, v131
    v_dot2c_f32_bf16 v227, v131, v131
    v_dot2c_f32_bf16 v221, s52, v132
    v_dot2c_f32_bf16 v225, v132, v132
    v_dot2c_f32_bf16 v223, s52, v133
    v_dot2c_f32_bf16 v227, v133, v133
    v_dot2c_f32_bf16 v221, s52, v134
    v_dot2c_f32_bf16 v225, v134, v134
    v_dot2c_f32_bf16 v223, s52, v135
    v_dot2c_f32_bf16 v227, v135, v135
    v_dot2c_f32_bf16 v221, s52, v136
    v_dot2c_f32_bf16 v225, v136, v136
    v_dot2c_f32_bf16 v223, s52, v137
    v_dot2c_f32_bf16 v227, v137, v137
    v_dot2c_f32_bf16 v221, s52, v138
    v_dot2c_f32_bf16 v225, v138, v138
    v_dot2c_f32_bf16 v223, s52, v139
    v_dot2c_f32_bf16 v227, v139, v139
    s_waitcnt vmcnt(4)
    ds_read_b128 v[156:159], v208 offset:24576
    ds_read_b128 v[160:163], v209 offset:24576
    ds_read_b128 v[164:167], v210 offset:24576
    ds_read_b128 v[168:171], v211 offset:24576
    s_waitcnt lgkmcnt(0)
    s_barrier
    ds_read_b64_tr_b16 v[172:173], v212 offset:16384
    ds_read_b64_tr_b16 v[174:175], v212 offset:16896
    ds_read_b64_tr_b16 v[176:177], v216 offset:16384
    ds_read_b64_tr_b16 v[178:179], v216 offset:16896
    ds_read_b64_tr_b16 v[180:181], v213 offset:16384
    ds_read_b64_tr_b16 v[182:183], v213 offset:16896
    ds_read_b64_tr_b16 v[184:185], v217 offset:16384
    ds_read_b64_tr_b16 v[186:187], v217 offset:16896
    s_add_u32 m0, s59, 0
    s_mul_i32 s53, s39, 172032
    s_add_u32 s53, s53, s57
    buffer_load_dwordx4 v206, s[8:11], s53 offen lds
    buffer_load_dwordx4 v207, s[8:11], s53 offen offset:1024 lds
    s_add_u32 s39, s39, 1
    s_cmp_eq_u32 s39, 7
    s_cselect_b32 s39, 0, s39
    v_dot2c_f32_bf16 v221, s52, v140
    v_dot2c_f32_bf16 v225, v140, v140
    v_dot2c_f32_bf16 v223, s52, v141
    v_dot2c_f32_bf16 v227, v141, v141
    v_dot2c_f32_bf16 v221, s52, v142
    v_dot2c_f32_bf16 v225, v142, v142
    v_dot2c_f32_bf16 v223, s52, v143
    v_dot2c_f32_bf16 v227, v143, v143
    v_dot2c_f32_bf16 v221, s52, v144
    v_dot2c_f32_bf16 v225, v144, v144
    v_dot2c_f32_bf16 v223, s52, v145
    v_dot2c_f32_bf16 v227, v145, v145
    v_dot2c_f32_bf16 v221, s52, v146
    v_dot2c_f32_bf16 v225, v146, v146
    v_dot2c_f32_bf16 v223, s52, v147
    v_dot2c_f32_bf16 v227, v147, v147
    v_dot2c_f32_bf16 v221, s52, v148
    v_dot2c_f32_bf16 v225, v148, v148
    v_dot2c_f32_bf16 v223, s52, v149
    v_dot2c_f32_bf16 v227, v149, v149
    v_dot2c_f32_bf16 v221, s52, v150
    v_dot2c_f32_bf16 v225, v150, v150
    v_dot2c_f32_bf16 v223, s52, v151
    v_dot2c_f32_bf16 v227, v151, v151
    v_dot2c_f32_bf16 v221, s52, v152
    v_dot2c_f32_bf16 v225, v152, v152
    v_dot2c_f32_bf16 v223, s52, v153
    v_dot2c_f32_bf16 v227, v153, v153
    v_dot2c_f32_bf16 v221, s52, v154
    v_dot2c_f32_bf16 v225, v154, v154
    v_dot2c_f32_bf16 v223, s52, v155
    v_dot2c_f32_bf16 v227, v155, v155
    v_dot2c_f32_bf16 v221, s52, v156
    v_dot2c_f32_bf16 v225, v156, v156
    v_dot2c_f32_bf16 v223, s52, v157
    v_dot2c_f32_bf16 v227, v157, v157
    v_dot2c_f32_bf16 v221, s52, v158
    v_dot2c_f32_bf16 v225, v158, v158
    v_dot2c_f32_bf16 v223, s52, v159
    v_dot2c_f32_bf16 v227, v159, v159
    v_dot2c_f32_bf16 v221, s52, v160
    v_dot2c_f32_bf16 v225, v160, v160
    v_dot2c_f32_bf16 v223, s52, v161
    v_dot2c_f32_bf16 v227, v161, v161
    v_dot2c_f32_bf16 v221, s52, v162
    v_dot2c_f32_bf16 v225, v162, v162
    v_dot2c_f32_bf16 v223, s52, v163
    v_dot2c_f32_bf16 v227, v163, v163
    v_dot2c_f32_bf16 v221, s52, v164
    v_dot2c_f32_bf16 v225, v164, v164
    v_dot2c_f32_bf16 v223, s52, v165
    v_dot2c_f32_bf16 v227, v165, v165
    v_dot2c_f32_bf16 v221, s52, v166
    v_dot2c_f32_bf16 v225, v166, v166
    v_dot2c_f32_bf16 v223, s52, v167
    v_dot2c_f32_bf16 v227, v167, v167
    v_dot2c_f32_bf16 v221, s52, v168
    v_dot2c_f32_bf16 v225, v168, v168
    v_dot2c_f32_bf16 v223, s52, v169
    v_dot2c_f32_bf16 v227, v169, v169
    v_dot2c_f32_bf16 v221, s52, v170
    v_dot2c_f32_bf16 v225, v170, v170
    v_dot2c_f32_bf16 v223, s52, v171
    v_dot2c_f32_bf16 v227, v171, v171
    s_waitcnt lgkmcnt(4)
    v_mfma_f32_32x32x16_bf16 v[36:51], v[52:55], v[172:175], v[36:51]
    v_add_f32 v221, v221, v223
    v_add_f32 v225, v225, v227
    v_mov_b32 v236, v221
    v_mfma_f32_32x32x16_bf16 v[240:255], v[52:55], v[176:179], v[240:255]
    s_nop 0
    v_permlane32_swap_b32 v221, v236
    v_add_f32 v221, v221, v236
    v_mov_b32 v237, v225
    v_mfma_f32_32x32x16_bf16 v[4:19], v[172:175], v[92:95], v[4:19]
    ds_read_b64_tr_b16 v[188:189], v214 offset:16384
    ds_read_b64_tr_b16 v[190:191], v214 offset:16896
    v_permlane32_swap_b32 v225, v237
    v_add_f32 v225, v225, v237
    v_mul_f32 v226, 0x3b124925, v221
    v_mfma_f32_32x32x16_bf16 v[20:35], v[176:179], v[92:95], v[20:35]
    ds_read_b64_tr_b16 v[192:193], v218 offset:16384
    ds_read_b64_tr_b16 v[194:195], v218 offset:16896
    v_mul_f32 v236, 0x3b124925, v225
    v_fma_f32 v236, -v226, v226, v236
    v_max_f32 v236, 0, v236
    s_add_u32 m0, s59, 8192
    s_mul_i32 s53, s39, 172032
Lpage1:
    s_cbranch_execz Lvis0
    s_add_u32 s53, s53, s57
    buffer_load_dwordx4 v206, s[8:11], s53 offen lds
    s_waitcnt lgkmcnt(4)
    v_mfma_f32_32x32x16_bf16 v[4:19], v[180:183], v[96:99], v[4:19]
    ds_read_b64_tr_b16 v[196:197], v215 offset:16384
    ds_read_b64_tr_b16 v[198:199], v215 offset:16896
    v_add_f32 v236, 0x3727c5ac, v236
    v_rsq_f32 v228, v236
    v_lshlrev_b32 v237, 2, v231
    v_mfma_f32_32x32x16_bf16 v[20:35], v[184:187], v[96:99], v[20:35]
    ds_read_b64_tr_b16 v[200:201], v219 offset:16384
    ds_read_b64_tr_b16 v[202:203], v219 offset:16896
    s_lshl_b32 s55, s3, 9
    s_add_u32 s55, s55, 157184
    v_add_u32 v233, s55, v237
    buffer_load_dwordx4 v207, s[8:11], s53 offen offset:1024 lds
    s_add_u32 s39, s39, 1
    s_cmp_eq_u32 s39, 7
    s_cselect_b32 s39, 0, s39
    s_waitcnt vmcnt(4) lgkmcnt(0)
    s_barrier
    v_mfma_f32_32x32x16_bf16 v[4:19], v[188:191], v[100:103], v[4:19]
    ds_read_b64_tr_b16 v[172:173], v212 offset:24576
    ds_read_b64_tr_b16 v[174:175], v212 offset:25088
    v_lshlrev_b32 v204, 4, v229
    v_add_u32 v204, s55, v204
    s_mul_i32 s55, s3, 384
    v_mfma_f32_32x32x16_bf16 v[20:35], v[192:195], v[100:103], v[20:35]
    ds_read_b64_tr_b16 v[176:177], v216 offset:24576
    ds_read_b64_tr_b16 v[178:179], v216 offset:25088
    s_add_u32 s55, s55, 155648
    v_add_u32 v234, s55, v237
    v_mul_u32_u24 v235, 768, v229
    s_add_u32 m0, s48, 0
    s_mul_i32 s53, s49, 43008
    s_add_u32 s53, s53, s38
    buffer_load_dwordx4 v232, s[8:11], s53 offen lds
    s_add_u32 s49, s49, 1
    s_cmp_eq_u32 s49, 28
    s_cselect_b32 s49, 0, s49
    s_waitcnt lgkmcnt(4)
    v_mfma_f32_32x32x16_bf16 v[4:19], v[196:199], v[104:107], v[4:19]
    ds_read_b64_tr_b16 v[180:181], v213 offset:24576
    ds_read_b64_tr_b16 v[182:183], v213 offset:25088
    v_add_u32 v235, v235, v237
    v_add_u32 v235, 155648, v235
    v_mul_f32 v230, 0x3e8b97f6, v228
    v_mfma_f32_32x32x16_bf16 v[20:35], v[200:203], v[104:107], v[20:35]
    ds_read_b64_tr_b16 v[184:185], v217 offset:24576
    ds_read_b64_tr_b16 v[186:187], v217 offset:25088
    s_add_u32 m0, s48, 1024
    s_mul_i32 s53, s49, 43008
    s_add_u32 s53, s53, s38
    buffer_load_dwordx4 v232, s[8:11], s53 offen lds
    s_add_u32 s49, s49, 1
    s_cmp_eq_u32 s49, 28
    s_cselect_b32 s49, 0, s49
    s_waitcnt lgkmcnt(4)
    v_mfma_f32_32x32x16_bf16 v[36:51], v[52:55], v[172:175], v[36:51]
    v_mfma_f32_32x32x16_bf16 v[240:255], v[52:55], v[176:179], v[240:255]
    v_mfma_f32_32x32x16_bf16 v[4:19], v[172:175], v[108:111], v[4:19]
    ds_read_b64_tr_b16 v[188:189], v214 offset:24576
    ds_read_b64_tr_b16 v[190:191], v214 offset:25088
    v_mfma_f32_32x32x16_bf16 v[20:35], v[176:179], v[108:111], v[20:35]
    ds_read_b64_tr_b16 v[192:193], v218 offset:24576
    ds_read_b64_tr_b16 v[194:195], v218 offset:25088
    s_add_u32 m0, s48, 2048
    s_mul_i32 s53, s49, 43008
    s_add_u32 s53, s53, s38
    buffer_load_dwordx4 v232, s[8:11], s53 offen lds
    s_add_u32 s49, s49, 1
    s_cmp_eq_u32 s49, 28
    s_cselect_b32 s49, 0, s49
    s_waitcnt lgkmcnt(4)
    v_mfma_f32_32x32x16_bf16 v[4:19], v[180:183], v[112:115], v[4:19]
    ds_read_b64_tr_b16 v[196:197], v215 offset:24576
    ds_read_b64_tr_b16 v[198:199], v215 offset:25088
    v_mfma_f32_32x32x16_bf16 v[20:35], v[184:187], v[112:115], v[20:35]
    ds_read_b64_tr_b16 v[200:201], v219 offset:24576
    ds_read_b64_tr_b16 v[202:203], v219 offset:25088
    s_add_u32 m0, s48, 3072
    s_mul_i32 s53, s49, 43008
    s_add_u32 s53, s53, s38
    buffer_load_dwordx4 v232, s[8:11], s53 offen lds
    s_add_u32 s49, s49, 1
    s_cmp_eq_u32 s49, 28
    s_cselect_b32 s49, 0, s49
    s_waitcnt lgkmcnt(4)
    v_mfma_f32_32x32x16_bf16 v[4:19], v[188:191], v[116:119], v[4:19]
    ds_read_b64_tr_b16 v[172:173], v212 offset:32768
    ds_read_b64_tr_b16 v[174:175], v212 offset:33280
    v_mfma_f32_32x32x16_bf16 v[20:35], v[192:195], v[116:119], v[20:35]
    ds_read_b64_tr_b16 v[176:177], v216 offset:32768
    ds_read_b64_tr_b16 v[178:179], v216 offset:33280
    s_add_u32 m0, s48, 4096
    s_mul_i32 s53, s49, 43008
    s_add_u32 s53, s53, s38
    buffer_load_dwordx4 v232, s[8:11], s53 offen lds
    s_add_u32 s49, s49, 1
    s_cmp_eq_u32 s49, 28
    s_cselect_b32 s49, 0, s49
    s_waitcnt lgkmcnt(4)
    v_mfma_f32_32x32x16_bf16 v[4:19], v[196:199], v[120:123], v[4:19]
    ds_read_b64_tr_b16 v[180:181], v213 offset:32768
    ds_read_b64_tr_b16 v[182:183], v213 offset:33280
    v_mfma_f32_32x32x16_bf16 v[20:35], v[200:203], v[120:123], v[20:35]
    ds_read_b64_tr_b16 v[184:185], v217 offset:32768
    ds_read_b64_tr_b16 v[186:187], v217 offset:33280
    s_add_u32 m0, s48, 5120
    s_mul_i32 s53, s49, 43008
    s_add_u32 s53, s53, s38
    buffer_load_dwordx4 v232, s[8:11], s53 offen lds
    s_add_u32 s49, s49, 1
    s_cmp_eq_u32 s49, 28
    s_cselect_b32 s49, 0, s49
    s_waitcnt lgkmcnt(4)
    v_mfma_f32_32x32x16_bf16 v[36:51], v[52:55], v[172:175], v[36:51]
    v_mfma_f32_32x32x16_bf16 v[240:255], v[52:55], v[176:179], v[240:255]
    v_mfma_f32_32x32x16_bf16 v[4:19], v[172:175], v[124:127], v[4:19]
    ds_read_b64_tr_b16 v[188:189], v214 offset:32768
    ds_read_b64_tr_b16 v[190:191], v214 offset:33280
    v_mfma_f32_32x32x16_bf16 v[20:35], v[176:179], v[124:127], v[20:35]
    ds_read_b64_tr_b16 v[192:193], v218 offset:32768
    ds_read_b64_tr_b16 v[194:195], v218 offset:33280
    s_add_u32 m0, s48, 6144
    s_mul_i32 s53, s49, 43008
    s_add_u32 s53, s53, s38
    buffer_load_dwordx4 v232, s[8:11], s53 offen lds
    s_add_u32 s49, s49, 1
    s_cmp_eq_u32 s49, 28
    s_cselect_b32 s49, 0, s49
    s_waitcnt lgkmcnt(4)
    v_mfma_f32_32x32x16_bf16 v[4:19], v[180:183], v[128:131], v[4:19]
    ds_read_b64_tr_b16 v[196:197], v215 offset:32768
    ds_read_b64_tr_b16 v[198:199], v215 offset:33280
    v_mfma_f32_32x32x16_bf16 v[20:35], v[184:187], v[128:131], v[20:35]
    ds_read_b64_tr_b16 v[200:201], v219 offset:32768
    ds_read_b64_tr_b16 v[202:203], v219 offset:33280
    s_waitcnt vmcnt(7) lgkmcnt(0)
    s_barrier
    v_subrev_u32 v212, 114688, v212
    v_subrev_u32 v216, 114688, v216
    v_subrev_u32 v213, 114688, v213
    v_subrev_u32 v217, 114688, v217
    v_subrev_u32 v214, 114688, v214
    v_subrev_u32 v218, 114688, v218
    v_subrev_u32 v215, 114688, v215
    v_subrev_u32 v219, 114688, v219
    v_mfma_f32_32x32x16_bf16 v[4:19], v[188:191], v[132:135], v[4:19]
    ds_read_b64_tr_b16 v[172:173], v212 offset:0
    ds_read_b64_tr_b16 v[174:175], v212 offset:512
    v_mfma_f32_32x32x16_bf16 v[20:35], v[192:195], v[132:135], v[20:35]
    ds_read_b64_tr_b16 v[176:177], v216 offset:0
    ds_read_b64_tr_b16 v[178:179], v216 offset:512
    s_waitcnt lgkmcnt(4)
    v_mfma_f32_32x32x16_bf16 v[4:19], v[196:199], v[136:139], v[4:19]
    ds_read_b64_tr_b16 v[180:181], v212 offset:8192
    ds_read_b64_tr_b16 v[182:183], v212 offset:8704
    v_mfma_f32_32x32x16_bf16 v[20:35], v[200:203], v[136:139], v[20:35]
    ds_read_b64_tr_b16 v[184:185], v216 offset:8192
    ds_read_b64_tr_b16 v[186:187], v216 offset:8704
    s_waitcnt lgkmcnt(4)
    v_mfma_f32_32x32x16_bf16 v[36:51], v[52:55], v[172:175], v[36:51]
    v_mfma_f32_32x32x16_bf16 v[240:255], v[52:55], v[176:179], v[240:255]
    v_mfma_f32_32x32x16_bf16 v[4:19], v[172:175], v[140:143], v[4:19]
    ds_read_b64_tr_b16 v[188:189], v213 offset:0
    ds_read_b64_tr_b16 v[190:191], v213 offset:512
    v_mfma_f32_32x32x16_bf16 v[20:35], v[176:179], v[140:143], v[20:35]
    ds_read_b64_tr_b16 v[192:193], v217 offset:0
    ds_read_b64_tr_b16 v[194:195], v217 offset:512
    s_waitcnt lgkmcnt(4)
    v_mfma_f32_32x32x16_bf16 v[36:51], v[52:55], v[180:183], v[36:51]
    v_mfma_f32_32x32x16_bf16 v[240:255], v[52:55], v[184:187], v[240:255]
    v_mfma_f32_32x32x16_bf16 v[4:19], v[180:183], v[156:159], v[4:19]
    ds_read_b64_tr_b16 v[196:197], v214 offset:0
    ds_read_b64_tr_b16 v[198:199], v214 offset:512
    ds_read_b64_tr_b16 v[200:201], v218 offset:0
    ds_read_b64_tr_b16 v[202:203], v218 offset:512
    v_mfma_f32_32x32x16_bf16 v[20:35], v[184:187], v[156:159], v[20:35]
    ds_read_b64_tr_b16 v[172:173], v215 offset:0
    ds_read_b64_tr_b16 v[174:175], v215 offset:512
    ds_read_b64_tr_b16 v[176:177], v219 offset:0
    ds_read_b64_tr_b16 v[178:179], v219 offset:512
    s_waitcnt lgkmcnt(4)
    v_mfma_f32_32x32x16_bf16 v[4:19], v[188:191], v[144:147], v[4:19]
    ds_write_b32 v234, v36 offset:128
    ds_write_b32 v234, v240 offset:256
    ds_read_b64_tr_b16 v[180:181], v213 offset:8192
    ds_read_b64_tr_b16 v[182:183], v213 offset:8704
    v_mfma_f32_32x32x16_bf16 v[20:35], v[192:195], v[144:147], v[20:35]
    ds_read_b64_tr_b16 v[184:185], v217 offset:8192
    ds_read_b64_tr_b16 v[186:187], v217 offset:8704
    s_waitcnt lgkmcnt(0)
    s_barrier
    v_mfma_f32_32x32x16_bf16 v[4:19], v[196:199], v[148:151], v[4:19]
    ds_read_b64_tr_b16 v[188:189], v214 offset:8192
    ds_read_b64_tr_b16 v[190:191], v214 offset:8704
    ds_read_b64_tr_b16 v[192:193], v218 offset:8192
    ds_read_b64_tr_b16 v[194:195], v218 offset:8704
    v_mfma_f32_32x32x16_bf16 v[20:35], v[200:203], v[148:151], v[20:35]
    ds_read_b64_tr_b16 v[196:197], v215 offset:8192
    ds_read_b64_tr_b16 v[198:199], v215 offset:8704
    ds_read_b64_tr_b16 v[200:201], v219 offset:8192
    ds_read_b64_tr_b16 v[202:203], v219 offset:8704
    v_mfma_f32_32x32x16_bf16 v[4:19], v[172:175], v[152:155], v[4:19]
    ds_read_b32 v222, v235 offset:128
    ds_read_b32 v237, v235 offset:512
    ds_read_b32 v224, v235 offset:256
    ds_read_b32 v238, v235 offset:640
    s_waitcnt lgkmcnt(0)
    v_mfma_f32_32x32x16_bf16 v[20:35], v[176:179], v[152:155], v[20:35]
    v_mfma_f32_32x32x16_bf16 v[4:19], v[180:183], v[160:163], v[4:19]
    v_mfma_f32_32x32x16_bf16 v[20:35], v[184:187], v[160:163], v[20:35]
    v_mfma_f32_32x32x16_bf16 v[4:19], v[188:191], v[164:167], v[4:19]
    v_add_f32 v222, v222, v237
    v_add_f32 v224, v224, v238
    v_mov_b32 v236, v222
    s_nop 1
    v_permlane32_swap_b32 v222, v236
    v_add_f32 v222, v222, v236
    v_mov_b32 v237, v224
    s_nop 1
    v_permlane32_swap_b32 v224, v237
    v_add_f32 v224, v224, v237
    v_mfma_f32_32x32x16_bf16 v[20:35], v[192:195], v[164:167], v[20:35]
    ds_write_b32 v233, v222
    ds_write_b32 v233, v224 offset:128
    ds_read_b128 v[240:243], v204 offset:0
    ds_read_b128 v[244:247], v204 offset:32
    ds_read_b128 v[248:251], v204 offset:64
    ds_read_b128 v[252:255], v204 offset:96
    ds_read_b128 v[36:39], v204 offset:128
    ds_read_b128 v[40:43], v204 offset:160
    v_mfma_f32_32x32x16_bf16 v[4:19], v[196:199], v[168:171], v[4:19]
    ds_read_b128 v[44:47], v204 offset:192
    ds_read_b128 v[48:51], v204 offset:224
    v_cmp_lt_u32 vcc, 31, v1
    s_lshl_b32 s53, s26, 2
    s_add_u32 s53, s53, s3
    s_and_b32 s54, s25, 14
    s_lshl_b32 s54, s54, 6
    s_add_u32 s53, s53, s54
    v_mfma_f32_32x32x16_bf16 v[20:35], v[200:203], v[168:171], v[20:35]
    s_lshl_b32 s53, s53, 12
    s_add_u32 s54, s53, 262144
    s_waitcnt lgkmcnt(4)
    v_pk_fma_f32 v[4:5], v[240:241], v[226:227], v[4:5] op_sel_hi:[1,0,1] neg_lo:[0,1,0] neg_hi:[0,1,0]
    v_pk_fma_f32 v[6:7], v[242:243], v[226:227], v[6:7] op_sel_hi:[1,0,1] neg_lo:[0,1,0] neg_hi:[0,1,0]
    v_pk_fma_f32 v[8:9], v[244:245], v[226:227], v[8:9] op_sel_hi:[1,0,1] neg_lo:[0,1,0] neg_hi:[0,1,0]
    v_pk_fma_f32 v[10:11], v[246:247], v[226:227], v[10:11] op_sel_hi:[1,0,1] neg_lo:[0,1,0] neg_hi:[0,1,0]
    v_pk_fma_f32 v[12:13], v[248:249], v[226:227], v[12:13] op_sel_hi:[1,0,1] neg_lo:[0,1,0] neg_hi:[0,1,0]
    v_pk_fma_f32 v[14:15], v[250:251], v[226:227], v[14:15] op_sel_hi:[1,0,1] neg_lo:[0,1,0] neg_hi:[0,1,0]
    v_pk_fma_f32 v[16:17], v[252:253], v[226:227], v[16:17] op_sel_hi:[1,0,1] neg_lo:[0,1,0] neg_hi:[0,1,0]
    v_pk_fma_f32 v[18:19], v[254:255], v[226:227], v[18:19] op_sel_hi:[1,0,1] neg_lo:[0,1,0] neg_hi:[0,1,0]
    v_pk_mul_f32 v[4:5], v[4:5], v[228:229] op_sel_hi:[1,0]
    v_pk_mul_f32 v[6:7], v[6:7], v[228:229] op_sel_hi:[1,0]
    v_pk_mul_f32 v[8:9], v[8:9], v[228:229] op_sel_hi:[1,0]
    v_pk_mul_f32 v[10:11], v[10:11], v[228:229] op_sel_hi:[1,0]
    v_pk_mul_f32 v[12:13], v[12:13], v[228:229] op_sel_hi:[1,0]
    v_pk_mul_f32 v[14:15], v[14:15], v[228:229] op_sel_hi:[1,0]
    v_pk_mul_f32 v[16:17], v[16:17], v[228:229] op_sel_hi:[1,0]
    v_pk_mul_f32 v[18:19], v[18:19], v[228:229] op_sel_hi:[1,0]
    v_cvt_pk_bf16_f32 v172, v4, v5
    v_cvt_pk_bf16_f32 v173, v6, v7
    v_cvt_pk_bf16_f32 v174, v8, v9
    v_cvt_pk_bf16_f32 v175, v10, v11
    v_cvt_pk_bf16_f32 v176, v12, v13
    v_cvt_pk_bf16_f32 v177, v14, v15
    v_cvt_pk_bf16_f32 v178, v16, v17
    v_cvt_pk_bf16_f32 v179, v18, v19
    v_mov_b32 v236, s52
    v_mov_b32 v237, 0x3f80
    v_cndmask_b32 v178, v178, v236, vcc
    v_cndmask_b32 v179, v179, v237, vcc
    buffer_store_dwordx4 v[172:175], v2, s[12:15], s53 offen offset:0 sc1
    buffer_store_dwordx4 v[176:179], v2, s[12:15], s53 offen offset:1024 sc1
    s_waitcnt lgkmcnt(0)
    v_pk_fma_f32 v[20:21], v[36:37], v[226:227], v[20:21] op_sel_hi:[1,0,1] neg_lo:[0,1,0] neg_hi:[0,1,0]
    v_pk_fma_f32 v[22:23], v[38:39], v[226:227], v[22:23] op_sel_hi:[1,0,1] neg_lo:[0,1,0] neg_hi:[0,1,0]
    v_pk_fma_f32 v[24:25], v[40:41], v[226:227], v[24:25] op_sel_hi:[1,0,1] neg_lo:[0,1,0] neg_hi:[0,1,0]
    v_pk_fma_f32 v[26:27], v[42:43], v[226:227], v[26:27] op_sel_hi:[1,0,1] neg_lo:[0,1,0] neg_hi:[0,1,0]
    v_pk_fma_f32 v[28:29], v[44:45], v[226:227], v[28:29] op_sel_hi:[1,0,1] neg_lo:[0,1,0] neg_hi:[0,1,0]
    v_pk_fma_f32 v[30:31], v[46:47], v[226:227], v[30:31] op_sel_hi:[1,0,1] neg_lo:[0,1,0] neg_hi:[0,1,0]
    v_pk_fma_f32 v[32:33], v[48:49], v[226:227], v[32:33] op_sel_hi:[1,0,1] neg_lo:[0,1,0] neg_hi:[0,1,0]
    v_pk_fma_f32 v[34:35], v[50:51], v[226:227], v[34:35] op_sel_hi:[1,0,1] neg_lo:[0,1,0] neg_hi:[0,1,0]
    v_pk_mul_f32 v[20:21], v[20:21], v[228:229] op_sel_hi:[1,0]
    v_pk_mul_f32 v[22:23], v[22:23], v[228:229] op_sel_hi:[1,0]
    v_pk_mul_f32 v[24:25], v[24:25], v[228:229] op_sel_hi:[1,0]
    v_pk_mul_f32 v[26:27], v[26:27], v[228:229] op_sel_hi:[1,0]
    v_pk_mul_f32 v[28:29], v[28:29], v[228:229] op_sel_hi:[1,0]
    v_pk_mul_f32 v[30:31], v[30:31], v[228:229] op_sel_hi:[1,0]
    v_pk_mul_f32 v[32:33], v[32:33], v[228:229] op_sel_hi:[1,0]
    v_pk_mul_f32 v[34:35], v[34:35], v[228:229] op_sel_hi:[1,0]
    v_cvt_pk_bf16_f32 v180, v20, v21
    v_cvt_pk_bf16_f32 v181, v22, v23
    v_cvt_pk_bf16_f32 v182, v24, v25
    v_cvt_pk_bf16_f32 v183, v26, v27
    v_cvt_pk_bf16_f32 v184, v28, v29
    v_cvt_pk_bf16_f32 v185, v30, v31
    v_cvt_pk_bf16_f32 v186, v32, v33
    v_cvt_pk_bf16_f32 v187, v34, v35
    v_cndmask_b32 v186, v186, v236, vcc
    v_cndmask_b32 v187, v187, v237, vcc
    buffer_store_dwordx4 v[180:183], v2, s[12:15], s54 offen offset:0 sc1
    buffer_store_dwordx4 v[184:187], v2, s[12:15], s54 offen offset:1024 sc1
    s_branch LAQ
LAV:
    s_add_u32 m0, s58, 8192
    s_add_u32 s53, s99, s56
    buffer_load_dwordx4 v204, s[4:7], s53 offen offset:0 lds
    buffer_load_dwordx4 v205, s[4:7], s53 offen offset:1024 lds
    s_add_u32 s53, s53, 12288
    buffer_load_dwordx4 v204, s[4:7], s53 offen offset:2048 lds
    buffer_load_dwordx4 v205, s[4:7], s53 offen offset:3072 lds
    s_add_u32 s99, s99, 128
    s_cmp_eq_u32 s99, 896
    s_cselect_b32 s99, 0, s99
    s_waitcnt vmcnt(11)
    ds_read_b128 v[76:79], v208 offset:4096
    ds_read_b128 v[80:83], v209 offset:4096
    ds_read_b128 v[84:87], v210 offset:4096
    ds_read_b128 v[88:91], v211 offset:4096
    s_barrier
    ds_read_b64_tr_b16 v[172:173], v212 offset:0
    ds_read_b64_tr_b16 v[174:175], v212 offset:512
    ds_read_b64_tr_b16 v[176:177], v216 offset:0
    ds_read_b64_tr_b16 v[178:179], v216 offset:512
    ds_read_b64_tr_b16 v[180:181], v213 offset:0
    ds_read_b64_tr_b16 v[182:183], v213 offset:512
    ds_read_b64_tr_b16 v[184:185], v217 offset:0
    ds_read_b64_tr_b16 v[186:187], v217 offset:512
    s_waitcnt lgkmcnt(12)
    v_dot2c_f32_bf16 v221, s52, v60
    v_dot2c_f32_bf16 v225, v60, v60
    v_dot2c_f32_bf16 v223, s52, v61
    v_dot2c_f32_bf16 v227, v61, v61
    v_dot2c_f32_bf16 v221, s52, v62
    v_dot2c_f32_bf16 v225, v62, v62
    v_dot2c_f32_bf16 v223, s52, v63
    v_dot2c_f32_bf16 v227, v63, v63
    s_add_u32 m0, s58, 12288
    s_add_u32 s53, s99, s56
    buffer_load_dwordx4 v204, s[4:7], s53 offen offset:0 lds
    buffer_load_dwordx4 v205, s[4:7], s53 offen offset:1024 lds
    v_dot2c_f32_bf16 v221, s52, v64
    v_dot2c_f32_bf16 v225, v64, v64
    v_dot2c_f32_bf16 v223, s52, v65
    v_dot2c_f32_bf16 v227, v65, v65
    v_dot2c_f32_bf16 v221, s52, v66
    v_dot2c_f32_bf16 v225, v66, v66
    v_dot2c_f32_bf16 v223, s52, v67
    v_dot2c_f32_bf16 v227, v67, v67
    s_add_u32 s53, s53, 12288
    buffer_load_dwordx4 v204, s[4:7], s53 offen offset:2048 lds
    buffer_load_dwordx4 v205, s[4:7], s53 offen offset:3072 lds
    s_add_u32 s99, s99, 128
    s_cmp_eq_u32 s99, 896
    s_cselect_b32 s99, 0, s99
    v_dot2c_f32_bf16 v221, s52, v68
    v_dot2c_f32_bf16 v225, v68, v68
    v_dot2c_f32_bf16 v223, s52, v69
    v_dot2c_f32_bf16 v227, v69, v69
    v_dot2c_f32_bf16 v221, s52, v70
    v_dot2c_f32_bf16 v225, v70, v70
    v_dot2c_f32_bf16 v223, s52, v71
    v_dot2c_f32_bf16 v227, v71, v71
    s_add_u32 m0, s58, 16384
    s_add_u32 s53, s99, s56
    buffer_load_dwordx4 v204, s[4:7], s53 offen offset:0 lds
    buffer_load_dwordx4 v205, s[4:7], s53 offen offset:1024 lds
    v_dot2c_f32_bf16 v221, s52, v72
    v_dot2c_f32_bf16 v225, v72, v72
    v_dot2c_f32_bf16 v223, s52, v73
    v_dot2c_f32_bf16 v227, v73, v73
    v_dot2c_f32_bf16 v221, s52, v74
    v_dot2c_f32_bf16 v225, v74, v74
    v_dot2c_f32_bf16 v223, s52, v75
    v_dot2c_f32_bf16 v227, v75, v75
    s_add_u32 s53, s53, 12288
    buffer_load_dwordx4 v204, s[4:7], s53 offen offset:2048 lds
    buffer_load_dwordx4 v205, s[4:7], s53 offen offset:3072 lds
    s_add_u32 s99, s99, 128
    s_cmp_eq_u32 s99, 896
    s_cselect_b32 s99, 0, s99
    s_waitcnt lgkmcnt(4)
    v_mfma_f32_32x32x16_bf16 v[36:51], v[52:55], v[172:175], 0
    s_add_u32 m0, s59, 131072
    s_mul_i32 s53, s39, 172032
    s_add_u32 s53, s53, s57
    buffer_load_dwordx4 v206, s[8:11], s53 offen lds
    v_mfma_f32_32x32x16_bf16 v[240:255], v[52:55], v[176:179], 0
    buffer_load_dwordx4 v207, s[8:11], s53 offen offset:1024 lds
    s_add_u32 s39, s39, 1
    s_cmp_eq_u32 s39, 7
    s_cselect_b32 s39, 0, s39
    v_mfma_f32_32x32x16_bf16 v[4:19], v[60:63], v[172:175], 0
    ds_read_b64_tr_b16 v[188:189], v214 offset:0
    ds_read_b64_tr_b16 v[190:191], v214 offset:512
    s_add_u32 m0, s58, 20480
    s_add_u32 s53, s99, s56
    buffer_load_dwordx4 v204, s[4:7], s53 offen offset:0 lds
    v_mfma_f32_32x32x16_bf16 v[20:35], v[60:63], v[176:179], 0
    ds_read_b64_tr_b16 v[192:193], v218 offset:0
    ds_read_b64_tr_b16 v[194:195], v218 offset:512
    buffer_load_dwordx4 v205, s[4:7], s53 offen offset:1024 lds
    s_waitcnt lgkmcnt(4)
    v_mfma_f32_32x32x16_bf16 v[4:19], v[64:67], v[180:183], v[4:19]
    ds_read_b64_tr_b16 v[196:197], v215 offset:0
    ds_read_b64_tr_b16 v[198:199], v215 offset:512
    s_add_u32 s53, s53, 12288
    buffer_load_dwordx4 v204, s[4:7], s53 offen offset:2048 lds
    v_mfma_f32_32x32x16_bf16 v[20:35], v[64:67], v[184:187], v[20:35]
    ds_read_b64_tr_b16 v[200:201], v219 offset:0
    ds_read_b64_tr_b16 v[202:203], v219 offset:512
    buffer_load_dwordx4 v205, s[4:7], s53 offen offset:3072 lds
    s_add_u32 s99, s99, 128
    s_cmp_eq_u32 s99, 896
    s_cselect_b32 s99, 0, s99
    s_waitcnt lgkmcnt(4)
    v_mfma_f32_32x32x16_bf16 v[4:19], v[68:71], v[188:191], v[4:19]
    ds_read_b64_tr_b16 v[172:173], v212 offset:8192
    ds_read_b64_tr_b16 v[174:175], v212 offset:8704
    s_add_u32 m0, s58, 24576
    s_add_u32 s53, s99, s56
    buffer_load_dwordx4 v204, s[4:7], s53 offen offset:0 lds
    v_mfma_f32_32x32x16_bf16 v[20:35], v[68:71], v[192:195], v[20:35]
    ds_read_b64_tr_b16 v[176:177], v216 offset:8192
    ds_read_b64_tr_b16 v[178:179], v216 offset:8704
    buffer_load_dwordx4 v205, s[4:7], s53 offen offset:1024 lds
    s_waitcnt lgkmcnt(4)
    v_mfma_f32_32x32x16_bf16 v[4:19], v[72:75], v[196:199], v[4:19]
    ds_read_b64_tr_b16 v[180:181], v213 offset:8192
    ds_read_b64_tr_b16 v[182:183], v213 offset:8704
    s_add_u32 s53, s53, 12288
    buffer_load_dwordx4 v204, s[4:7], s53 offen offset:2048 lds
    v_mfma_f32_32x32x16_bf16 v[20:35], v[72:75], v[200:203], v[20:35]
    ds_read_b64_tr_b16 v[184:185], v217 offset:8192
    ds_read_b64_tr_b16 v[186:187], v217 offset:8704
    buffer_load_dwordx4 v205, s[4:7], s53 offen offset:3072 lds
    s_add_u32 s99, s99, 128
    s_cmp_eq_u32 s99, 896
    s_cselect_b32 s99, 0, s99
    s_waitcnt vmcnt(18)
    ds_read_b128 v[92:95], v208 offset:8192
    ds_read_b128 v[96:99], v209 offset:8192
    ds_read_b128 v[100:103], v210 offset:8192
    ds_read_b128 v[104:107], v211 offset:8192
    s_waitcnt lgkmcnt(4)
    v_dot2c_f32_bf16 v221, s52, v76
    v_dot2c_f32_bf16 v225, v76, v76
    v_dot2c_f32_bf16 v223, s52, v77
    v_dot2c_f32_bf16 v227, v77, v77
    v_dot2c_f32_bf16 v221, s52, v78
    v_dot2c_f32_bf16 v225, v78, v78
    v_dot2c_f32_bf16 v223, s52, v79
    v_dot2c_f32_bf16 v227, v79, v79
    s_add_u32 m0, s59, 139264
    s_mul_i32 s53, s39, 172032
    s_add_u32 s53, s53, s57
    buffer_load_dwordx4 v206, s[8:11], s53 offen lds
    buffer_load_dwordx4 v207, s[8:11], s53 offen offset:1024 lds
    s_add_u32 s39, s39, 1
    s_cmp_eq_u32 s39, 7
    s_cselect_b32 s39, 0, s39
    v_dot2c_f32_bf16 v221, s52, v80
    v_dot2c_f32_bf16 v225, v80, v80
    v_dot2c_f32_bf16 v223, s52, v81
    v_dot2c_f32_bf16 v227, v81, v81
    v_dot2c_f32_bf16 v221, s52, v82
    v_dot2c_f32_bf16 v225, v82, v82
    v_dot2c_f32_bf16 v223, s52, v83
    v_dot2c_f32_bf16 v227, v83, v83
    s_add_u32 m0, s59, 147456
    s_mul_i32 s53, s39, 172032
    s_add_u32 s53, s53, s57
    buffer_load_dwordx4 v206, s[8:11], s53 offen lds
    buffer_load_dwordx4 v207, s[8:11], s53 offen offset:1024 lds
    s_add_u32 s39, s39, 1
    s_cmp_eq_u32 s39, 7
    s_cselect_b32 s39, 0, s39
    v_dot2c_f32_bf16 v221, s52, v84
    v_dot2c_f32_bf16 v225, v84, v84
    v_dot2c_f32_bf16 v223, s52, v85
    v_dot2c_f32_bf16 v227, v85, v85
    v_dot2c_f32_bf16 v221, s52, v86
    v_dot2c_f32_bf16 v225, v86, v86
    v_dot2c_f32_bf16 v223, s52, v87
    v_dot2c_f32_bf16 v227, v87, v87
    v_dot2c_f32_bf16 v221, s52, v88
    v_dot2c_f32_bf16 v225, v88, v88
    v_dot2c_f32_bf16 v223, s52, v89
    v_dot2c_f32_bf16 v227, v89, v89
    v_dot2c_f32_bf16 v221, s52, v90
    v_dot2c_f32_bf16 v225, v90, v90
    v_dot2c_f32_bf16 v223, s52, v91
    v_dot2c_f32_bf16 v227, v91, v91
    s_waitcnt lgkmcnt(4)
    v_mfma_f32_32x32x16_bf16 v[36:51], v[52:55], v[172:175], v[36:51]
    v_mfma_f32_32x32x16_bf16 v[240:255], v[52:55], v[176:179], v[240:255]
    v_mfma_f32_32x32x16_bf16 v[4:19], v[76:79], v[172:175], v[4:19]
    ds_read_b64_tr_b16 v[188:189], v214 offset:8192
    ds_read_b64_tr_b16 v[190:191], v214 offset:8704
    v_mfma_f32_32x32x16_bf16 v[20:35], v[76:79], v[176:179], v[20:35]
    ds_read_b64_tr_b16 v[192:193], v218 offset:8192
    ds_read_b64_tr_b16 v[194:195], v218 offset:8704
    s_waitcnt lgkmcnt(4)
    v_mfma_f32_32x32x16_bf16 v[4:19], v[80:83], v[180:183], v[4:19]
    ds_read_b64_tr_b16 v[196:197], v215 offset:8192
    ds_read_b64_tr_b16 v[198:199], v215 offset:8704
    v_mfma_f32_32x32x16_bf16 v[20:35], v[80:83], v[184:187], v[20:35]
    ds_read_b64_tr_b16 v[200:201], v219 offset:8192
    ds_read_b64_tr_b16 v[202:203], v219 offset:8704
    s_waitcnt lgkmcnt(4)
    v_mfma_f32_32x32x16_bf16 v[4:19], v[84:87], v[188:191], v[4:19]
    v_mfma_f32_32x32x16_bf16 v[20:35], v[84:87], v[192:195], v[20:35]
    s_waitcnt lgkmcnt(0)
    v_mfma_f32_32x32x16_bf16 v[4:19], v[88:91], v[196:199], v[4:19]
    v_mfma_f32_32x32x16_bf16 v[20:35], v[88:91], v[200:203], v[20:35]
    s_waitcnt vmcnt(18)
    ds_read_b128 v[108:111], v208 offset:12288
    ds_read_b128 v[112:115], v209 offset:12288
    ds_read_b128 v[116:119], v210 offset:12288
    ds_read_b128 v[120:123], v211 offset:12288
    s_waitcnt lgkmcnt(4)
    v_dot2c_f32_bf16 v221, s52, v92
    v_dot2c_f32_bf16 v225, v92, v92
    v_dot2c_f32_bf16 v223, s52, v93
    v_dot2c_f32_bf16 v227, v93, v93
    v_dot2c_f32_bf16 v221, s52, v94
    v_dot2c_f32_bf16 v225, v94, v94
    v_dot2c_f32_bf16 v223, s52, v95
    v_dot2c_f32_bf16 v227, v95, v95
    v_dot2c_f32_bf16 v221, s52, v96
    v_dot2c_f32_bf16 v225, v96, v96
    v_dot2c_f32_bf16 v223, s52, v97
    v_dot2c_f32_bf16 v227, v97, v97
    v_dot2c_f32_bf16 v221, s52, v98
    v_dot2c_f32_bf16 v225, v98, v98
    v_dot2c_f32_bf16 v223, s52, v99
    v_dot2c_f32_bf16 v227, v99, v99
    v_dot2c_f32_bf16 v221, s52, v100
    v_dot2c_f32_bf16 v225, v100, v100
    v_dot2c_f32_bf16 v223, s52, v101
    v_dot2c_f32_bf16 v227, v101, v101
    v_dot2c_f32_bf16 v221, s52, v102
    v_dot2c_f32_bf16 v225, v102, v102
    v_dot2c_f32_bf16 v223, s52, v103
    v_dot2c_f32_bf16 v227, v103, v103
    v_dot2c_f32_bf16 v221, s52, v104
    v_dot2c_f32_bf16 v225, v104, v104
    v_dot2c_f32_bf16 v223, s52, v105
    v_dot2c_f32_bf16 v227, v105, v105
    v_dot2c_f32_bf16 v221, s52, v106
    v_dot2c_f32_bf16 v225, v106, v106
    v_dot2c_f32_bf16 v223, s52, v107
    v_dot2c_f32_bf16 v227, v107, v107
    s_waitcnt vmcnt(14)
    ds_read_b128 v[124:127], v208 offset:16384
    ds_read_b128 v[128:131], v209 offset:16384
    ds_read_b128 v[132:135], v210 offset:16384
    ds_read_b128 v[136:139], v211 offset:16384
    s_waitcnt lgkmcnt(4)
    v_dot2c_f32_bf16 v221, s52, v108
    v_dot2c_f32_bf16 v225, v108, v108
    v_dot2c_f32_bf16 v223, s52, v109
    v_dot2c_f32_bf16 v227, v109, v109
    v_dot2c_f32_bf16 v221, s52, v110
    v_dot2c_f32_bf16 v225, v110, v110
    v_dot2c_f32_bf16 v223, s52, v111
    v_dot2c_f32_bf16 v227, v111, v111
    v_dot2c_f32_bf16 v221, s52, v112
    v_dot2c_f32_bf16 v225, v112, v112
    v_dot2c_f32_bf16 v223, s52, v113
    v_dot2c_f32_bf16 v227, v113, v113
    v_dot2c_f32_bf16 v221, s52, v114
    v_dot2c_f32_bf16 v225, v114, v114
    v_dot2c_f32_bf16 v223, s52, v115
    v_dot2c_f32_bf16 v227, v115, v115
    v_dot2c_f32_bf16 v221, s52, v116
    v_dot2c_f32_bf16 v225, v116, v116
    v_dot2c_f32_bf16 v223, s52, v117
    v_dot2c_f32_bf16 v227, v117, v117
    v_dot2c_f32_bf16 v221, s52, v118
    v_dot2c_f32_bf16 v225, v118, v118
    v_dot2c_f32_bf16 v223, s52, v119
    v_dot2c_f32_bf16 v227, v119, v119
    v_dot2c_f32_bf16 v221, s52, v120
    v_dot2c_f32_bf16 v225, v120, v120
    v_dot2c_f32_bf16 v223, s52, v121
    v_dot2c_f32_bf16 v227, v121, v121
    v_dot2c_f32_bf16 v221, s52, v122
    v_dot2c_f32_bf16 v225, v122, v122
    v_dot2c_f32_bf16 v223, s52, v123
    v_dot2c_f32_bf16 v227, v123, v123
    s_waitcnt vmcnt(8)
    ds_read_b128 v[140:143], v208 offset:20480
    ds_read_b128 v[144:147], v209 offset:20480
    ds_read_b128 v[148:151], v210 offset:20480
    ds_read_b128 v[152:155], v211 offset:20480
    s_waitcnt lgkmcnt(4)
    v_dot2c_f32_bf16 v221, s52, v124
    v_dot2c_f32_bf16 v225, v124, v124
    v_dot2c_f32_bf16 v223, s52, v125
    v_dot2c_f32_bf16 v227, v125, v125
    v_dot2c_f32_bf16 v221, s52, v126
    v_dot2c_f32_bf16 v225, v126, v126
    v_dot2c_f32_bf16 v223, s52, v127
    v_dot2c_f32_bf16 v227, v127, v127
    v_dot2c_f32_bf16 v221, s52, v128
    v_dot2c_f32_bf16 v225, v128, v128
    v_dot2c_f32_bf16 v223, s52, v129
    v_dot2c_f32_bf16 v227, v129, v129
    v_dot2c_f32_bf16 v221, s52, v130
    v_dot2c_f32_bf16 v225, v130, v130
    v_dot2c_f32_bf16 v223, s52, v131
    v_dot2c_f32_bf16 v227, v131, v131
    v_dot2c_f32_bf16 v221, s52, v132
    v_dot2c_f32_bf16 v225, v132, v132
    v_dot2c_f32_bf16 v223, s52, v133
    v_dot2c_f32_bf16 v227, v133, v133
    v_dot2c_f32_bf16 v221, s52, v134
    v_dot2c_f32_bf16 v225, v134, v134
    v_dot2c_f32_bf16 v223, s52, v135
    v_dot2c_f32_bf16 v227, v135, v135
    v_dot2c_f32_bf16 v221, s52, v136
    v_dot2c_f32_bf16 v225, v136, v136
    v_dot2c_f32_bf16 v223, s52, v137
    v_dot2c_f32_bf16 v227, v137, v137
    v_dot2c_f32_bf16 v221, s52, v138
    v_dot2c_f32_bf16 v225, v138, v138
    v_dot2c_f32_bf16 v223, s52, v139
    v_dot2c_f32_bf16 v227, v139, v139
    s_waitcnt vmcnt(4)
    ds_read_b128 v[156:159], v208 offset:24576
    ds_read_b128 v[160:163], v209 offset:24576
    ds_read_b128 v[164:167], v210 offset:24576
    ds_read_b128 v[168:171], v211 offset:24576
    s_waitcnt lgkmcnt(0)
    s_barrier
    ds_read_b64_tr_b16 v[172:173], v212 offset:16384
    ds_read_b64_tr_b16 v[174:175], v212 offset:16896
    ds_read_b64_tr_b16 v[176:177], v216 offset:16384
    ds_read_b64_tr_b16 v[178:179], v216 offset:16896
    ds_read_b64_tr_b16 v[180:181], v213 offset:16384
    ds_read_b64_tr_b16 v[182:183], v213 offset:16896
    ds_read_b64_tr_b16 v[184:185], v217 offset:16384
    ds_read_b64_tr_b16 v[186:187], v217 offset:16896
    s_add_u32 m0, s59, 0
    s_mul_i32 s53, s39, 172032
    s_add_u32 s53, s53, s57
    buffer_load_dwordx4 v206, s[8:11], s53 offen lds
    buffer_load_dwordx4 v207, s[8:11], s53 offen offset:1024 lds
    s_add_u32 s39, s39, 1
    s_cmp_eq_u32 s39, 7
    s_cselect_b32 s39, 0, s39
    v_dot2c_f32_bf16 v221, s52, v140
    v_dot2c_f32_bf16 v225, v140, v140
    v_dot2c_f32_bf16 v223, s52, v141
    v_dot2c_f32_bf16 v227, v141, v141
    v_dot2c_f32_bf16 v221, s52, v142
    v_dot2c_f32_bf16 v225, v142, v142
    v_dot2c_f32_bf16 v223, s52, v143
    v_dot2c_f32_bf16 v227, v143, v143
    v_dot2c_f32_bf16 v221, s52, v144
Lpage2:
    s_cbranch_execz Lvis0
    v_dot2c_f32_bf16 v225, v144, v144
    v_dot2c_f32_bf16 v223, s52, v145
    v_dot2c_f32_bf16 v227, v145, v145
    v_dot2c_f32_bf16 v221, s52, v146
    v_dot2c_f32_bf16 v225, v146, v146
    v_dot2c_f32_bf16 v223, s52, v147
    v_dot2c_f32_bf16 v227, v147, v147
    v_dot2c_f32_bf16 v221, s52, v148
    v_dot2c_f32_bf16 v225, v148, v148
    v_dot2c_f32_bf16 v223, s52, v149
    v_dot2c_f32_bf16 v227, v149, v149
    v_dot2c_f32_bf16 v221, s52, v150
    v_dot2c_f32_bf16 v225, v150, v150
    v_dot2c_f32_bf16 v223, s52, v151
    v_dot2c_f32_bf16 v227, v151, v151
    v_dot2c_f32_bf16 v221, s52, v152
    v_dot2c_f32_bf16 v225, v152, v152
    v_dot2c_f32_bf16 v223, s52, v153
    v_dot2c_f32_bf16 v227, v153, v153
    v_dot2c_f32_bf16 v221, s52, v154
    v_dot2c_f32_bf16 v225, v154, v154
    v_dot2c_f32_bf16 v223, s52, v155
    v_dot2c_f32_bf16 v227, v155, v155
    v_dot2c_f32_bf16 v221, s52, v156
    v_dot2c_f32_bf16 v225, v156, v156
    v_dot2c_f32_bf16 v223, s52, v157
    v_dot2c_f32_bf16 v227, v157, v157
    v_dot2c_f32_bf16 v221, s52, v158
    v_dot2c_f32_bf16 v225, v158, v158
    v_dot2c_f32_bf16 v223, s52, v159
    v_dot2c_f32_bf16 v227, v159, v159
    v_dot2c_f32_bf16 v221, s52, v160
    v_dot2c_f32_bf16 v225, v160, v160
    v_dot2c_f32_bf16 v223, s52, v161
    v_dot2c_f32_bf16 v227, v161, v161
    v_dot2c_f32_bf16 v221, s52, v162
    v_dot2c_f32_bf16 v225, v162, v162
    v_dot2c_f32_bf16 v223, s52, v163
    v_dot2c_f32_bf16 v227, v163, v163
    v_dot2c_f32_bf16 v221, s52, v164
    v_dot2c_f32_bf16 v225, v164, v164
    v_dot2c_f32_bf16 v223, s52, v165
    v_dot2c_f32_bf16 v227, v165, v165
    v_dot2c_f32_bf16 v221, s52, v166
    v_dot2c_f32_bf16 v225, v166, v166
    v_dot2c_f32_bf16 v223, s52, v167
    v_dot2c_f32_bf16 v227, v167, v167
    v_dot2c_f32_bf16 v221, s52, v168
    v_dot2c_f32_bf16 v225, v168, v168
    v_dot2c_f32_bf16 v223, s52, v169
    v_dot2c_f32_bf16 v227, v169, v169
    v_dot2c_f32_bf16 v221, s52, v170
    v_dot2c_f32_bf16 v225, v170, v170
    v_dot2c_f32_bf16 v223, s52, v171
    v_dot2c_f32_bf16 v227, v171, v171
    s_waitcnt lgkmcnt(4)
    v_mfma_f32_32x32x16_bf16 v[36:51], v[52:55], v[172:175], v[36:51]
    v_add_f32 v221, v221, v223
    v_add_f32 v225, v225, v227
    v_mov_b32 v236, v221
    v_mfma_f32_32x32x16_bf16 v[240:255], v[52:55], v[176:179], v[240:255]
    s_nop 0
    v_permlane32_swap_b32 v221, v236
    v_add_f32 v221, v221, v236
    v_mov_b32 v237, v225
    v_mfma_f32_32x32x16_bf16 v[4:19], v[92:95], v[172:175], v[4:19]
    ds_read_b64_tr_b16 v[188:189], v214 offset:16384
    ds_read_b64_tr_b16 v[190:191], v214 offset:16896
    v_permlane32_swap_b32 v225, v237
    v_add_f32 v225, v225, v237
    v_mul_f32 v226, 0x3b124925, v221
    v_mfma_f32_32x32x16_bf16 v[20:35], v[92:95], v[176:179], v[20:35]
    ds_read_b64_tr_b16 v[192:193], v218 offset:16384
    ds_read_b64_tr_b16 v[194:195], v218 offset:16896
    v_mul_f32 v236, 0x3b124925, v225
    v_fma_f32 v236, -v226, v226, v236
    v_max_f32 v236, 0, v236
    s_add_u32 m0, s59, 8192
    s_mul_i32 s53, s39, 172032
    s_add_u32 s53, s53, s57
    buffer_load_dwordx4 v206, s[8:11], s53 offen lds
    s_waitcnt lgkmcnt(4)
    v_mfma_f32_32x32x16_bf16 v[4:19], v[96:99], v[180:183], v[4:19]
    ds_read_b64_tr_b16 v[196:197], v215 offset:16384
    ds_read_b64_tr_b16 v[198:199], v215 offset:16896
    v_add_f32 v236, 0x3727c5ac, v236
    v_rsq_f32 v228, v236
    v_lshlrev_b32 v237, 2, v231
    v_mfma_f32_32x32x16_bf16 v[20:35], v[96:99], v[184:187], v[20:35]
    ds_read_b64_tr_b16 v[200:201], v219 offset:16384
    ds_read_b64_tr_b16 v[202:203], v219 offset:16896
    s_lshl_b32 s55, s3, 9
    s_add_u32 s55, s55, 157184
    v_add_u32 v233, s55, v237
    buffer_load_dwordx4 v207, s[8:11], s53 offen offset:1024 lds
    s_add_u32 s39, s39, 1
    s_cmp_eq_u32 s39, 7
    s_cselect_b32 s39, 0, s39
    s_waitcnt vmcnt(4) lgkmcnt(0)
    s_barrier
    v_mfma_f32_32x32x16_bf16 v[4:19], v[100:103], v[188:191], v[4:19]
    ds_read_b64_tr_b16 v[172:173], v212 offset:24576
    ds_read_b64_tr_b16 v[174:175], v212 offset:25088
    v_lshlrev_b32 v204, 4, v229
    v_add_u32 v204, s55, v204
    s_mul_i32 s55, s3, 384
    v_mfma_f32_32x32x16_bf16 v[20:35], v[100:103], v[192:195], v[20:35]
    ds_read_b64_tr_b16 v[176:177], v216 offset:24576
    ds_read_b64_tr_b16 v[178:179], v216 offset:25088
    s_add_u32 s55, s55, 155648
    v_add_u32 v234, s55, v237
    v_mul_u32_u24 v235, 768, v229
    s_add_u32 m0, s48, 0
    s_mul_i32 s53, s49, 43008
    s_add_u32 s53, s53, s38
    buffer_load_dwordx4 v232, s[8:11], s53 offen lds
    s_add_u32 s49, s49, 1
    s_cmp_eq_u32 s49, 28
    s_cselect_b32 s49, 0, s49
    s_waitcnt lgkmcnt(4)
    v_mfma_f32_32x32x16_bf16 v[4:19], v[104:107], v[196:199], v[4:19]
    ds_read_b64_tr_b16 v[180:181], v213 offset:24576
    ds_read_b64_tr_b16 v[182:183], v213 offset:25088
    v_add_u32 v235, v235, v237
    v_add_u32 v235, 155648, v235
    v_mul_f32 v230, 0x3e8b97f6, v228
    v_mfma_f32_32x32x16_bf16 v[20:35], v[104:107], v[200:203], v[20:35]
    ds_read_b64_tr_b16 v[184:185], v217 offset:24576
    ds_read_b64_tr_b16 v[186:187], v217 offset:25088
    s_add_u32 m0, s48, 1024
    s_mul_i32 s53, s49, 43008
    s_add_u32 s53, s53, s38
    buffer_load_dwordx4 v232, s[8:11], s53 offen lds
    s_add_u32 s49, s49, 1
    s_cmp_eq_u32 s49, 28
    s_cselect_b32 s49, 0, s49
    s_waitcnt lgkmcnt(4)
    v_mfma_f32_32x32x16_bf16 v[36:51], v[52:55], v[172:175], v[36:51]
    v_mfma_f32_32x32x16_bf16 v[240:255], v[52:55], v[176:179], v[240:255]
    v_mfma_f32_32x32x16_bf16 v[4:19], v[108:111], v[172:175], v[4:19]
    ds_read_b64_tr_b16 v[188:189], v214 offset:24576
    ds_read_b64_tr_b16 v[190:191], v214 offset:25088
    v_mfma_f32_32x32x16_bf16 v[20:35], v[108:111], v[176:179], v[20:35]
    ds_read_b64_tr_b16 v[192:193], v218 offset:24576
    ds_read_b64_tr_b16 v[194:195], v218 offset:25088
    s_add_u32 m0, s48, 2048
    s_mul_i32 s53, s49, 43008
    s_add_u32 s53, s53, s38
    buffer_load_dwordx4 v232, s[8:11], s53 offen lds
    s_add_u32 s49, s49, 1
    s_cmp_eq_u32 s49, 28
    s_cselect_b32 s49, 0, s49
    s_waitcnt lgkmcnt(4)
    v_mfma_f32_32x32x16_bf16 v[4:19], v[112:115], v[180:183], v[4:19]
    ds_read_b64_tr_b16 v[196:197], v215 offset:24576
    ds_read_b64_tr_b16 v[198:199], v215 offset:25088
    v_mfma_f32_32x32x16_bf16 v[20:35], v[112:115], v[184:187], v[20:35]
    ds_read_b64_tr_b16 v[200:201], v219 offset:24576
    ds_read_b64_tr_b16 v[202:203], v219 offset:25088
    s_add_u32 m0, s48, 3072
    s_mul_i32 s53, s49, 43008
    s_add_u32 s53, s53, s38
    buffer_load_dwordx4 v232, s[8:11], s53 offen lds
    s_add_u32 s49, s49, 1
    s_cmp_eq_u32 s49, 28
    s_cselect_b32 s49, 0, s49
    s_waitcnt lgkmcnt(4)
    v_mfma_f32_32x32x16_bf16 v[4:19], v[116:119], v[188:191], v[4:19]
    ds_read_b64_tr_b16 v[172:173], v212 offset:32768
    ds_read_b64_tr_b16 v[174:175], v212 offset:33280
    v_mfma_f32_32x32x16_bf16 v[20:35], v[116:119], v[192:195], v[20:35]
    ds_read_b64_tr_b16 v[176:177], v216 offset:32768
    ds_read_b64_tr_b16 v[178:179], v216 offset:33280
    s_add_u32 m0, s48, 4096
    s_mul_i32 s53, s49, 43008
    s_add_u32 s53, s53, s38
    buffer_load_dwordx4 v232, s[8:11], s53 offen lds
    s_add_u32 s49, s49, 1
    s_cmp_eq_u32 s49, 28
    s_cselect_b32 s49, 0, s49
    s_waitcnt lgkmcnt(4)
    v_mfma_f32_32x32x16_bf16 v[4:19], v[120:123], v[196:199], v[4:19]
    ds_read_b64_tr_b16 v[180:181], v213 offset:32768
    ds_read_b64_tr_b16 v[182:183], v213 offset:33280
    v_mfma_f32_32x32x16_bf16 v[20:35], v[120:123], v[200:203], v[20:35]
    ds_read_b64_tr_b16 v[184:185], v217 offset:32768
    ds_read_b64_tr_b16 v[186:187], v217 offset:33280
    s_add_u32 m0, s48, 5120
    s_mul_i32 s53, s49, 43008
    s_add_u32 s53, s53, s38
    buffer_load_dwordx4 v232, s[8:11], s53 offen lds
    s_add_u32 s49, s49, 1
    s_cmp_eq_u32 s49, 28
    s_cselect_b32 s49, 0, s49
    s_waitcnt lgkmcnt(4)
    v_mfma_f32_32x32x16_bf16 v[36:51], v[52:55], v[172:175], v[36:51]
    v_mfma_f32_32x32x16_bf16 v[240:255], v[52:55], v[176:179], v[240:255]
    v_mfma_f32_32x32x16_bf16 v[4:19], v[124:127], v[172:175], v[4:19]
    ds_read_b64_tr_b16 v[188:189], v214 offset:32768
    ds_read_b64_tr_b16 v[190:191], v214 offset:33280
    v_mfma_f32_32x32x16_bf16 v[20:35], v[124:127], v[176:179], v[20:35]
    ds_read_b64_tr_b16 v[192:193], v218 offset:32768
    ds_read_b64_tr_b16 v[194:195], v218 offset:33280
    s_add_u32 m0, s48, 6144
    s_mul_i32 s53, s49, 43008
    s_add_u32 s53, s53, s38
    buffer_load_dwordx4 v232, s[8:11], s53 offen lds
    s_add_u32 s49, s49, 1
    s_cmp_eq_u32 s49, 28
    s_cselect_b32 s49, 0, s49
    s_waitcnt lgkmcnt(4)
    v_mfma_f32_32x32x16_bf16 v[4:19], v[128:131], v[180:183], v[4:19]
    ds_read_b64_tr_b16 v[196:197], v215 offset:32768
    ds_read_b64_tr_b16 v[198:199], v215 offset:33280
    v_mfma_f32_32x32x16_bf16 v[20:35], v[128:131], v[184:187], v[20:35]
    ds_read_b64_tr_b16 v[200:201], v219 offset:32768
    ds_read_b64_tr_b16 v[202:203], v219 offset:33280
    s_waitcnt vmcnt(7) lgkmcnt(0)
    s_barrier
    v_subrev_u32 v212, 114688, v212
    v_subrev_u32 v216, 114688, v216
    v_subrev_u32 v213, 114688, v213
    v_subrev_u32 v217, 114688, v217
    v_subrev_u32 v214, 114688, v214
    v_subrev_u32 v218, 114688, v218
    v_subrev_u32 v215, 114688, v215
    v_subrev_u32 v219, 114688, v219
    v_mfma_f32_32x32x16_bf16 v[4:19], v[132:135], v[188:191], v[4:19]
    ds_read_b64_tr_b16 v[172:173], v212 offset:0
    ds_read_b64_tr_b16 v[174:175], v212 offset:512
    v_mfma_f32_32x32x16_bf16 v[20:35], v[132:135], v[192:195], v[20:35]
    ds_read_b64_tr_b16 v[176:177], v216 offset:0
    ds_read_b64_tr_b16 v[178:179], v216 offset:512
    s_waitcnt lgkmcnt(4)
    v_mfma_f32_32x32x16_bf16 v[4:19], v[136:139], v[196:199], v[4:19]
    ds_read_b64_tr_b16 v[180:181], v212 offset:8192
    ds_read_b64_tr_b16 v[182:183], v212 offset:8704
    v_mfma_f32_32x32x16_bf16 v[20:35], v[136:139], v[200:203], v[20:35]
    ds_read_b64_tr_b16 v[184:185], v216 offset:8192
    ds_read_b64_tr_b16 v[186:187], v216 offset:8704
    s_waitcnt lgkmcnt(4)
    v_mfma_f32_32x32x16_bf16 v[36:51], v[52:55], v[172:175], v[36:51]
    v_mfma_f32_32x32x16_bf16 v[240:255], v[52:55], v[176:179], v[240:255]
    v_mfma_f32_32x32x16_bf16 v[4:19], v[140:143], v[172:175], v[4:19]
    ds_read_b64_tr_b16 v[188:189], v213 offset:0
    ds_read_b64_tr_b16 v[190:191], v213 offset:512
    v_mfma_f32_32x32x16_bf16 v[20:35], v[140:143], v[176:179], v[20:35]
    ds_read_b64_tr_b16 v[192:193], v217 offset:0
    ds_read_b64_tr_b16 v[194:195], v217 offset:512
    s_waitcnt lgkmcnt(4)
    v_mfma_f32_32x32x16_bf16 v[36:51], v[52:55], v[180:183], v[36:51]
    v_mfma_f32_32x32x16_bf16 v[240:255], v[52:55], v[184:187], v[240:255]
    v_mfma_f32_32x32x16_bf16 v[4:19], v[156:159], v[180:183], v[4:19]
    ds_read_b64_tr_b16 v[196:197], v214 offset:0
    ds_read_b64_tr_b16 v[198:199], v214 offset:512
    ds_read_b64_tr_b16 v[200:201], v218 offset:0
    ds_read_b64_tr_b16 v[202:203], v218 offset:512
    v_mfma_f32_32x32x16_bf16 v[20:35], v[156:159], v[184:187], v[20:35]
    ds_read_b64_tr_b16 v[172:173], v215 offset:0
    ds_read_b64_tr_b16 v[174:175], v215 offset:512
    ds_read_b64_tr_b16 v[176:177], v219 offset:0
    ds_read_b64_tr_b16 v[178:179], v219 offset:512
    s_waitcnt lgkmcnt(4)
    v_mfma_f32_32x32x16_bf16 v[4:19], v[144:147], v[188:191], v[4:19]
    ds_write_b32 v234, v36 offset:128
    ds_write_b32 v234, v240 offset:256
    ds_write_b32 v233, v226 offset:256
    ds_write_b32 v233, v228 offset:384
    v_mfma_f32_32x32x16_bf16 v[20:35], v[144:147], v[192:195], v[20:35]
    ds_read_b64_tr_b16 v[180:181], v213 offset:8192
    ds_read_b64_tr_b16 v[182:183], v213 offset:8704
    ds_read_b64_tr_b16 v[184:185], v217 offset:8192
    ds_read_b64_tr_b16 v[186:187], v217 offset:8704
    v_mfma_f32_32x32x16_bf16 v[4:19], v[148:151], v[196:199], v[4:19]
    s_waitcnt lgkmcnt(0)
    s_barrier
    ds_read_b64_tr_b16 v[188:189], v214 offset:8192
    ds_read_b64_tr_b16 v[190:191], v214 offset:8704
    v_mfma_f32_32x32x16_bf16 v[20:35], v[148:151], v[200:203], v[20:35]
    ds_read_b64_tr_b16 v[192:193], v218 offset:8192
    ds_read_b64_tr_b16 v[194:195], v218 offset:8704
    ds_read_b64_tr_b16 v[196:197], v215 offset:8192
    ds_read_b64_tr_b16 v[198:199], v215 offset:8704
    v_mfma_f32_32x32x16_bf16 v[4:19], v[152:155], v[172:175], v[4:19]
    ds_read_b64_tr_b16 v[200:201], v219 offset:8192
    ds_read_b64_tr_b16 v[202:203], v219 offset:8704
    ds_read_b32 v222, v235 offset:128
    ds_read_b32 v237, v235 offset:512
    ds_read_b32 v224, v235 offset:256
    ds_read_b32 v238, v235 offset:640
    v_mfma_f32_32x32x16_bf16 v[20:35], v[152:155], v[176:179], v[20:35]
    ds_read_b128 v[240:243], v204 offset:256
    ds_read_b128 v[36:39], v204 offset:384
    ds_read_b128 v[244:247], v204 offset:288
    ds_read_b128 v[40:43], v204 offset:416
    ds_read_b128 v[248:251], v204 offset:320
    ds_read_b128 v[44:47], v204 offset:448
    v_mfma_f32_32x32x16_bf16 v[4:19], v[160:163], v[180:183], v[4:19]
    ds_read_b128 v[252:255], v204 offset:352
    ds_read_b128 v[48:51], v204 offset:480
    s_waitcnt lgkmcnt(8)
    v_mfma_f32_32x32x16_bf16 v[20:35], v[160:163], v[184:187], v[20:35]
    v_mfma_f32_32x32x16_bf16 v[4:19], v[164:167], v[188:191], v[4:19]
    v_add_f32 v222, v222, v237
    v_add_f32 v224, v224, v238
    v_mov_b32 v236, v222
    s_nop 1
    v_permlane32_swap_b32 v222, v236
    v_add_f32 v222, v222, v236
    v_mov_b32 v237, v224
    s_nop 1
    v_permlane32_swap_b32 v224, v237
    v_add_f32 v224, v224, v237
    v_mfma_f32_32x32x16_bf16 v[20:35], v[164:167], v[192:195], v[20:35]
    v_cmp_eq_u32 vcc, 28, v231
    v_mov_b32 v0, s52
    s_nop 0
    v_cndmask_b32 v0, 0, v0, vcc
    v_cmp_lt_u32 vcc, 27, v231
    s_lshl_b32 s53, s26, 2
    s_add_u32 s53, s53, s3
    s_and_b32 s54, s25, 14
    s_lshl_b32 s54, s54, 6
    v_mfma_f32_32x32x16_bf16 v[4:19], v[168:171], v[196:199], v[4:19]
    s_add_u32 s53, s53, s54
    s_lshl_b32 s53, s53, 12
    s_add_u32 s54, s53, 262144
    v_mfma_f32_32x32x16_bf16 v[20:35], v[168:171], v[200:203], v[20:35]
    s_waitcnt lgkmcnt(0)
    s_nop 6
    v_pk_fma_f32 v[4:5], v[240:241], v[222:223], v[4:5] op_sel_hi:[1,0,1] neg_lo:[0,1,0] neg_hi:[0,1,0]
    v_pk_fma_f32 v[6:7], v[242:243], v[222:223], v[6:7] op_sel_hi:[1,0,1] neg_lo:[0,1,0] neg_hi:[0,1,0]
    v_pk_fma_f32 v[8:9], v[244:245], v[222:223], v[8:9] op_sel_hi:[1,0,1] neg_lo:[0,1,0] neg_hi:[0,1,0]
    v_pk_fma_f32 v[10:11], v[246:247], v[222:223], v[10:11] op_sel_hi:[1,0,1] neg_lo:[0,1,0] neg_hi:[0,1,0]
    v_pk_fma_f32 v[12:13], v[248:249], v[222:223], v[12:13] op_sel_hi:[1,0,1] neg_lo:[0,1,0] neg_hi:[0,1,0]
    v_pk_fma_f32 v[14:15], v[250:251], v[222:223], v[14:15] op_sel_hi:[1,0,1] neg_lo:[0,1,0] neg_hi:[0,1,0]
    v_pk_fma_f32 v[16:17], v[252:253], v[222:223], v[16:17] op_sel_hi:[1,0,1] neg_lo:[0,1,0] neg_hi:[0,1,0]
    v_pk_fma_f32 v[18:19], v[254:255], v[222:223], v[18:19] op_sel_hi:[1,0,1] neg_lo:[0,1,0] neg_hi:[0,1,0]
    v_pk_mul_f32 v[4:5], v[4:5], v[36:37]
    v_pk_mul_f32 v[6:7], v[6:7], v[38:39]
    v_pk_mul_f32 v[8:9], v[8:9], v[40:41]
    v_pk_mul_f32 v[10:11], v[10:11], v[42:43]
    v_pk_mul_f32 v[12:13], v[12:13], v[44:45]
    v_pk_mul_f32 v[14:15], v[14:15], v[46:47]
    v_pk_mul_f32 v[16:17], v[16:17], v[48:49]
    v_pk_mul_f32 v[18:19], v[18:19], v[50:51]
    v_cvt_pk_bf16_f32 v172, v4, v5
    v_cvt_pk_bf16_f32 v173, v6, v7
    v_cvt_pk_bf16_f32 v174, v8, v9
    v_cvt_pk_bf16_f32 v175, v10, v11
    v_cvt_pk_bf16_f32 v176, v12, v13
    v_cvt_pk_bf16_f32 v177, v14, v15
    v_cvt_pk_bf16_f32 v178, v16, v17
    v_cvt_pk_bf16_f32 v179, v18, v19
    v_cndmask_b32 v172, v172, v0, vcc
    v_cndmask_b32 v173, v173, v0, vcc
    v_cndmask_b32 v174, v174, v0, vcc
    v_cndmask_b32 v175, v175, v0, vcc
    v_cndmask_b32 v176, v176, v0, vcc
    v_cndmask_b32 v177, v177, v0, vcc
    v_cndmask_b32 v178, v178, v0, vcc
    v_cndmask_b32 v179, v179, v0, vcc
    buffer_store_dwordx4 v[172:175], v2, s[12:15], s53 offen offset:2048 sc1
    buffer_store_dwordx4 v[176:179], v2, s[12:15], s53 offen offset:3072 sc1
    v_pk_fma_f32 v[20:21], v[240:241], v[224:225], v[20:21] op_sel_hi:[1,0,1] neg_lo:[0,1,0] neg_hi:[0,1,0]
    v_pk_fma_f32 v[22:23], v[242:243], v[224:225], v[22:23] op_sel_hi:[1,0,1] neg_lo:[0,1,0] neg_hi:[0,1,0]
    v_pk_fma_f32 v[24:25], v[244:245], v[224:225], v[24:25] op_sel_hi:[1,0,1] neg_lo:[0,1,0] neg_hi:[0,1,0]
    v_pk_fma_f32 v[26:27], v[246:247], v[224:225], v[26:27] op_sel_hi:[1,0,1] neg_lo:[0,1,0] neg_hi:[0,1,0]
    v_pk_fma_f32 v[28:29], v[248:249], v[224:225], v[28:29] op_sel_hi:[1,0,1] neg_lo:[0,1,0] neg_hi:[0,1,0]
    v_pk_fma_f32 v[30:31], v[250:251], v[224:225], v[30:31] op_sel_hi:[1,0,1] neg_lo:[0,1,0] neg_hi:[0,1,0]
    v_pk_fma_f32 v[32:33], v[252:253], v[224:225], v[32:33] op_sel_hi:[1,0,1] neg_lo:[0,1,0] neg_hi:[0,1,0]
    v_pk_fma_f32 v[34:35], v[254:255], v[224:225], v[34:35] op_sel_hi:[1,0,1] neg_lo:[0,1,0] neg_hi:[0,1,0]
    v_pk_mul_f32 v[20:21], v[20:21], v[36:37]
    v_pk_mul_f32 v[22:23], v[22:23], v[38:39]
    v_pk_mul_f32 v[24:25], v[24:25], v[40:41]
    v_pk_mul_f32 v[26:27], v[26:27], v[42:43]
    v_pk_mul_f32 v[28:29], v[28:29], v[44:45]
    v_pk_mul_f32 v[30:31], v[30:31], v[46:47]
    v_pk_mul_f32 v[32:33], v[32:33], v[48:49]
    v_pk_mul_f32 v[34:35], v[34:35], v[50:51]
    v_cvt_pk_bf16_f32 v180, v20, v21
    v_cvt_pk_bf16_f32 v181, v22, v23
    v_cvt_pk_bf16_f32 v182, v24, v25
    v_cvt_pk_bf16_f32 v183, v26, v27
    v_cvt_pk_bf16_f32 v184, v28, v29
    v_cvt_pk_bf16_f32 v185, v30, v31
    v_cvt_pk_bf16_f32 v186, v32, v33
    v_cvt_pk_bf16_f32 v187, v34, v35
    v_cndmask_b32 v180, v180, v0, vcc
    v_cndmask_b32 v181, v181, v0, vcc
    v_cndmask_b32 v182, v182, v0, vcc
    v_cndmask_b32 v183, v183, v0, vcc
    v_cndmask_b32 v184, v184, v0, vcc
    v_cndmask_b32 v185, v185, v0, vcc
    v_cndmask_b32 v186, v186, v0, vcc
    v_cndmask_b32 v187, v187, v0, vcc
    buffer_store_dwordx4 v[180:183], v2, s[12:15], s54 offen offset:2048 sc1
    buffer_store_dwordx4 v[184:187], v2, s[12:15], s54 offen offset:3072 sc1
LAQ:
    s_add_u32 s53, s3, 0
    s_and_b32 s53, s53, 3
    s_lshl_b32 s53, s53, 10
    s_add_u32 s53, s53, 16384
    v_add_u32 v212, s53, v239
    s_add_u32 s53, s3, 1
    s_and_b32 s53, s53, 3
    s_lshl_b32 s53, s53, 10
    s_add_u32 s53, s53, 16384
    v_add_u32 v213, s53, v239
    s_add_u32 s53, s3, 2
    s_and_b32 s53, s53, 3
    s_lshl_b32 s53, s53, 10
    s_add_u32 s53, s53, 16384
    v_add_u32 v214, s53, v239
    s_add_u32 s53, s3, 3
    s_and_b32 s53, s53, 3
    s_lshl_b32 s53, s53, 10
    s_add_u32 s53, s53, 16384
    v_add_u32 v215, s53, v239
    s_lshr_b32 s54, s25, 1
    s_lshl_b32 s54, s54, 2
    s_add_u32 s54, s54, s3
    s_lshl_b32 s54, s54, 12
    s_add_u32 s58, s54, 16842752
    s_and_b32 s54, s25, 1
    s_lshl_b32 s54, s54, 4
    s_add_u32 s54, s54, s26
    s_lshl_b32 s54, s54, 7
    s_add_u32 s54, s58, s54
    s_waitcnt vmcnt(4)
    s_barrier
    ds_read_b64_tr_b16 v[4:5], v212 offset:0
    ds_read_b64_tr_b16 v[6:7], v212 offset:256
    ds_read_b64_tr_b16 v[8:9], v212 offset:4096
    ds_read_b64_tr_b16 v[10:11], v212 offset:4352
    ds_read_b64_tr_b16 v[12:13], v212 offset:8192
    ds_read_b64_tr_b16 v[14:15], v212 offset:8448
    ds_read_b64_tr_b16 v[16:17], v212 offset:12288
    ds_read_b64_tr_b16 v[18:19], v212 offset:12544
    ds_read_b64_tr_b16 v[20:21], v212 offset:16384
    ds_read_b64_tr_b16 v[22:23], v212 offset:16640
    s_waitcnt lgkmcnt(8)
    v_mfma_f32_32x32x16_bf16 v[240:255], v[52:55], v[4:7], 0
    v_mfma_f32_32x32x16_bf16 v[36:51], v[4:7], v[60:63], 0
    ds_read_b64_tr_b16 v[24:25], v212 offset:20480
    ds_read_b64_tr_b16 v[26:27], v212 offset:20736
    s_waitcnt lgkmcnt(8)
    v_mfma_f32_32x32x16_bf16 v[240:255], v[52:55], v[8:11], v[240:255]
    v_mfma_f32_32x32x16_bf16 v[36:51], v[8:11], v[76:79], v[36:51]
    ds_read_b64_tr_b16 v[28:29], v212 offset:24576
    ds_read_b64_tr_b16 v[30:31], v212 offset:24832
    s_waitcnt lgkmcnt(8)
    v_mfma_f32_32x32x16_bf16 v[240:255], v[52:55], v[12:15], v[240:255]
    v_mfma_f32_32x32x16_bf16 v[36:51], v[12:15], v[92:95], v[36:51]
    ds_read_b64_tr_b16 v[32:33], v213 offset:0
    ds_read_b64_tr_b16 v[34:35], v213 offset:256
    s_waitcnt lgkmcnt(8)
    v_mfma_f32_32x32x16_bf16 v[240:255], v[52:55], v[16:19], v[240:255]
    v_mfma_f32_32x32x16_bf16 v[36:51], v[16:19], v[108:111], v[36:51]
    ds_read_b64_tr_b16 v[4:5], v214 offset:0
    ds_read_b64_tr_b16 v[6:7], v214 offset:256
    s_waitcnt lgkmcnt(8)
    v_mfma_f32_32x32x16_bf16 v[240:255], v[52:55], v[20:23], v[240:255]
    v_mfma_f32_32x32x16_bf16 v[36:51], v[20:23], v[124:127], v[36:51]
    ds_read_b64_tr_b16 v[8:9], v215 offset:0
    ds_read_b64_tr_b16 v[10:11], v215 offset:256
    s_waitcnt lgkmcnt(8)
    v_mfma_f32_32x32x16_bf16 v[240:255], v[52:55], v[24:27], v[240:255]
    v_mfma_f32_32x32x16_bf16 v[36:51], v[24:27], v[140:143], v[36:51]
    ds_read_b64_tr_b16 v[12:13], v213 offset:4096
    ds_read_b64_tr_b16 v[14:15], v213 offset:4352
    s_waitcnt lgkmcnt(8)
    v_mfma_f32_32x32x16_bf16 v[240:255], v[52:55], v[28:31], v[240:255]
    v_mfma_f32_32x32x16_bf16 v[36:51], v[28:31], v[156:159], v[36:51]
    ds_read_b64_tr_b16 v[16:17], v214 offset:4096
    ds_read_b64_tr_b16 v[18:19], v214 offset:4352
    s_waitcnt lgkmcnt(8)
    v_mfma_f32_32x32x16_bf16 v[36:51], v[32:35], v[64:67], v[36:51]
    ds_read_b64_tr_b16 v[20:21], v215 offset:4096
    ds_read_b64_tr_b16 v[22:23], v215 offset:4352
    s_waitcnt lgkmcnt(8)
    v_mfma_f32_32x32x16_bf16 v[36:51], v[4:7], v[68:71], v[36:51]
    ds_read_b64_tr_b16 v[24:25], v213 offset:8192
    ds_read_b64_tr_b16 v[26:27], v213 offset:8448
    s_waitcnt lgkmcnt(4)
    v_mfma_f32_32x32x16_bf16 v[36:51], v[8:11], v[72:75], v[36:51]
    ds_read_b64_tr_b16 v[28:29], v214 offset:8192
    ds_read_b64_tr_b16 v[30:31], v214 offset:8448
    ds_write_b32 v234, v240
    s_waitcnt lgkmcnt(4)
    v_mfma_f32_32x32x16_bf16 v[36:51], v[12:15], v[80:83], v[36:51]
    ds_read_b64_tr_b16 v[32:33], v215 offset:8192
    ds_read_b64_tr_b16 v[34:35], v215 offset:8448
    s_waitcnt lgkmcnt(4)
    v_mfma_f32_32x32x16_bf16 v[36:51], v[16:19], v[84:87], v[36:51]
    ds_read_b64_tr_b16 v[4:5], v213 offset:12288
    ds_read_b64_tr_b16 v[6:7], v213 offset:12544
    s_waitcnt lgkmcnt(4)
    s_barrier
    ds_read_b32 v220, v235
    ds_read_b32 v237, v235 offset:384
    s_waitcnt lgkmcnt(4)
    v_mfma_f32_32x32x16_bf16 v[36:51], v[20:23], v[88:91], v[36:51]
    ds_read_b64_tr_b16 v[8:9], v214 offset:12288
    ds_read_b64_tr_b16 v[10:11], v214 offset:12544
    s_waitcnt lgkmcnt(4)
    v_mfma_f32_32x32x16_bf16 v[36:51], v[24:27], v[96:99], v[36:51]
    ds_read_b64_tr_b16 v[12:13], v215 offset:12288
    ds_read_b64_tr_b16 v[14:15], v215 offset:12544
    s_waitcnt lgkmcnt(4)
    v_mfma_f32_32x32x16_bf16 v[36:51], v[28:31], v[100:103], v[36:51]
    ds_read_b64_tr_b16 v[16:17], v213 offset:16384
    ds_read_b64_tr_b16 v[18:19], v213 offset:16640
    v_add_f32 v220, v220, v237
    v_mov_b32 v237, v220
    s_nop 1
    v_permlane32_swap_b32 v220, v237
    v_add_f32 v220, v220, v237
    ds_write_b32 v233, v220
    s_waitcnt lgkmcnt(4)
    v_mfma_f32_32x32x16_bf16 v[36:51], v[32:35], v[104:107], v[36:51]
    ds_read_b64_tr_b16 v[20:21], v214 offset:16384
    ds_read_b64_tr_b16 v[22:23], v214 offset:16640
    ds_read_b128 v[240:243], v204 offset:0
    ds_read_b128 v[244:247], v204 offset:32
    ds_read_b128 v[248:251], v204 offset:64
    ds_read_b128 v[252:255], v204 offset:96
    s_waitcnt vmcnt(0)
    v_mov_b32 v236, s24
    s_mov_b64 exec, 1
    buffer_store_dword v236, v2, s[12:15], s54 offen sc1
    s_mov_b64 exec, -1
    s_waitcnt lgkmcnt(4)
    v_mfma_f32_32x32x16_bf16 v[36:51], v[4:7], v[112:115], v[36:51]
    ds_read_b64_tr_b16 v[24:25], v215 offset:16384
    ds_read_b64_tr_b16 v[26:27], v215 offset:16640
    s_waitcnt lgkmcnt(8)
    v_mfma_f32_32x32x16_bf16 v[36:51], v[8:11], v[116:119], v[36:51]
    ds_read_b64_tr_b16 v[28:29], v213 offset:20480
    ds_read_b64_tr_b16 v[30:31], v213 offset:20736
    s_waitcnt lgkmcnt(8)
    v_mfma_f32_32x32x16_bf16 v[36:51], v[12:15], v[120:123], v[36:51]
    ds_read_b64_tr_b16 v[32:33], v214 offset:20480
    ds_read_b64_tr_b16 v[34:35], v214 offset:20736
    s_waitcnt lgkmcnt(8)
    v_mfma_f32_32x32x16_bf16 v[36:51], v[16:19], v[128:131], v[36:51]
    ds_read_b64_tr_b16 v[4:5], v215 offset:20480
    ds_read_b64_tr_b16 v[6:7], v215 offset:20736
    s_waitcnt lgkmcnt(8)
    v_mfma_f32_32x32x16_bf16 v[36:51], v[20:23], v[132:135], v[36:51]
    ds_read_b64_tr_b16 v[8:9], v213 offset:24576
    ds_read_b64_tr_b16 v[10:11], v213 offset:24832
    s_waitcnt lgkmcnt(8)
    v_mfma_f32_32x32x16_bf16 v[36:51], v[24:27], v[136:139], v[36:51]
    ds_read_b64_tr_b16 v[12:13], v214 offset:24576
    ds_read_b64_tr_b16 v[14:15], v214 offset:24832
    s_waitcnt lgkmcnt(8)
    v_mfma_f32_32x32x16_bf16 v[36:51], v[28:31], v[144:147], v[36:51]
    ds_read_b64_tr_b16 v[16:17], v215 offset:24576
    ds_read_b64_tr_b16 v[18:19], v215 offset:24832
    s_waitcnt lgkmcnt(8)
    v_mfma_f32_32x32x16_bf16 v[36:51], v[32:35], v[148:151], v[36:51]
    s_waitcnt lgkmcnt(6)
    v_mfma_f32_32x32x16_bf16 v[36:51], v[4:7], v[152:155], v[36:51]
    s_waitcnt lgkmcnt(4)
    v_mfma_f32_32x32x16_bf16 v[36:51], v[8:11], v[160:163], v[36:51]
    s_waitcnt lgkmcnt(2)
    v_mfma_f32_32x32x16_bf16 v[36:51], v[12:15], v[164:167], v[36:51]
    s_waitcnt lgkmcnt(0)
    v_mfma_f32_32x32x16_bf16 v[36:51], v[16:19], v[168:171], v[36:51]
    v_cmp_lt_u32 vcc, 31, v1
    s_waitcnt lgkmcnt(0)
    s_nop 9
    v_pk_fma_f32 v[36:37], v[240:241], v[226:227], v[36:37] op_sel_hi:[1,0,1] neg_lo:[0,1,0] neg_hi:[0,1,0]
    v_pk_fma_f32 v[38:39], v[242:243], v[226:227], v[38:39] op_sel_hi:[1,0,1] neg_lo:[0,1,0] neg_hi:[0,1,0]
    v_pk_fma_f32 v[40:41], v[244:245], v[226:227], v[40:41] op_sel_hi:[1,0,1] neg_lo:[0,1,0] neg_hi:[0,1,0]
    v_pk_fma_f32 v[42:43], v[246:247], v[226:227], v[42:43] op_sel_hi:[1,0,1] neg_lo:[0,1,0] neg_hi:[0,1,0]
    v_pk_fma_f32 v[44:45], v[248:249], v[226:227], v[44:45] op_sel_hi:[1,0,1] neg_lo:[0,1,0] neg_hi:[0,1,0]
    v_pk_fma_f32 v[46:47], v[250:251], v[226:227], v[46:47] op_sel_hi:[1,0,1] neg_lo:[0,1,0] neg_hi:[0,1,0]
    v_pk_fma_f32 v[48:49], v[252:253], v[226:227], v[48:49] op_sel_hi:[1,0,1] neg_lo:[0,1,0] neg_hi:[0,1,0]
    v_pk_fma_f32 v[50:51], v[254:255], v[226:227], v[50:51] op_sel_hi:[1,0,1] neg_lo:[0,1,0] neg_hi:[0,1,0]
    v_pk_mul_f32 v[36:37], v[36:37], v[230:231] op_sel_hi:[1,0]
    v_pk_mul_f32 v[38:39], v[38:39], v[230:231] op_sel_hi:[1,0]
    v_pk_mul_f32 v[40:41], v[40:41], v[230:231] op_sel_hi:[1,0]
    v_pk_mul_f32 v[42:43], v[42:43], v[230:231] op_sel_hi:[1,0]
    v_pk_mul_f32 v[44:45], v[44:45], v[230:231] op_sel_hi:[1,0]
    v_pk_mul_f32 v[46:47], v[46:47], v[230:231] op_sel_hi:[1,0]
    v_pk_mul_f32 v[48:49], v[48:49], v[230:231] op_sel_hi:[1,0]
    v_pk_mul_f32 v[50:51], v[50:51], v[230:231] op_sel_hi:[1,0]
    v_cvt_pk_bf16_f32 v52, v36, v37
    v_cvt_pk_bf16_f32 v53, v38, v39
    v_cvt_pk_bf16_f32 v54, v40, v41
    v_cvt_pk_bf16_f32 v55, v42, v43
    v_cvt_pk_bf16_f32 v56, v44, v45
    v_cvt_pk_bf16_f32 v57, v46, v47
    v_cvt_pk_bf16_f32 v58, v48, v49
    v_cvt_pk_bf16_f32 v59, v50, v51
    v_cndmask_b32_e64 v58, v58, 0, vcc
    v_cndmask_b32_e64 v59, v59, 0, vcc
    s_cmp_eq_u32 s25, 0
    s_cselect_b32 s53, 1.0, 0
    v_mul_f32 v216, s53, v226
    s_and_b32 s53, s30, 3
    s_cmp_eq_u32 s53, 2
    s_cselect_b32 s38, 2, 0
    s_cselect_b32 s39, 0, 5
    s_and_b32 s53, s31, 7
    s_lshr_b32 s54, s31, 3
    s_mul_i32 s54, s54, 7
    s_mul_i32 s53, s53, 1
    s_add_u32 s53, s53, s54
    s_mul_i32 s54, s53, 4682
    s_lshr_b32 s54, s54, 16
    s_mul_i32 s54, s54, 14
    s_sub_u32 s0, s53, s54
    s_lshl_b32 s59, s25, 6
    s_add_u32 s59, s59, s3
    s_lshl_b32 s59, s59, 12
    v_add_u32 v244, s59, v2
    s_lshl_b32 s55, s26, 14
    s_mov_b64 exec, 0
    s_cmp_eq_u32 s3, 0
    s_cbranch_scc1 Lpage5
    s_cmp_eq_u32 s3, 1
    s_cbranch_scc1 Lpage6
    s_cmp_eq_u32 s3, 2
    s_cbranch_scc1 Lpage7
    s_cmp_eq_u32 s3, 3
    s_cbranch_scc1 Lpage8
Lvis1:
    s_mov_b64 exec, -1
    v_accvgpr_read_b32 v164, a232
    v_accvgpr_read_b32 v165, a233
    v_accvgpr_read_b32 v166, a234
    v_accvgpr_read_b32 v167, a235
    v_mov_b32 v168, 0
    v_dot2c_f32_bf16 v168, s52, v164
    v_dot2c_f32_bf16 v168, s52, v165
    v_dot2c_f32_bf16 v168, s52, v166
    v_dot2c_f32_bf16 v168, s52, v167
    v_accvgpr_read_b32 v164, a236
    v_accvgpr_read_b32 v165, a237
    v_accvgpr_read_b32 v166, a238
    v_accvgpr_read_b32 v167, a239
    v_mov_b32 v169, 0
    v_dot2c_f32_bf16 v169, s52, v164
    v_dot2c_f32_bf16 v169, s52, v165
    v_dot2c_f32_bf16 v169, s52, v166
    v_dot2c_f32_bf16 v169, s52, v167
    v_accvgpr_read_b32 v164, a240
    v_accvgpr_read_b32 v165, a241
Lpage3:
    s_cbranch_execz Lvis0
    v_accvgpr_read_b32 v166, a242
    v_accvgpr_read_b32 v167, a243
    v_mov_b32 v170, 0
    v_dot2c_f32_bf16 v170, s52, v164
    v_dot2c_f32_bf16 v170, s52, v165
    v_dot2c_f32_bf16 v170, s52, v166
    v_dot2c_f32_bf16 v170, s52, v167
    v_accvgpr_read_b32 v164, a244
    v_accvgpr_read_b32 v165, a245
    v_accvgpr_read_b32 v166, a246
    v_accvgpr_read_b32 v167, a247
    v_mov_b32 v171, 0
    v_dot2c_f32_bf16 v171, s52, v164
    v_dot2c_f32_bf16 v171, s52, v165
    v_dot2c_f32_bf16 v171, s52, v166
    v_dot2c_f32_bf16 v171, s52, v167
    v_add_f32_dpp v168, v168, v168 row_shr:1 row_mask:0xf bank_mask:0xf bound_ctrl:1
    v_add_f32_dpp v169, v169, v169 row_shr:1 row_mask:0xf bank_mask:0xf bound_ctrl:1
    v_add_f32_dpp v170, v170, v170 row_shr:1 row_mask:0xf bank_mask:0xf bound_ctrl:1
    v_add_f32_dpp v171, v171, v171 row_shr:1 row_mask:0xf bank_mask:0xf bound_ctrl:1
    v_add_f32_dpp v168, v168, v168 row_shr:2 row_mask:0xf bank_mask:0xf bound_ctrl:1
    v_add_f32_dpp v169, v169, v169 row_shr:2 row_mask:0xf bank_mask:0xf bound_ctrl:1
    v_add_f32_dpp v170, v170, v170 row_shr:2 row_mask:0xf bank_mask:0xf bound_ctrl:1
    v_add_f32_dpp v171, v171, v171 row_shr:2 row_mask:0xf bank_mask:0xf bound_ctrl:1
    v_add_f32_dpp v168, v168, v168 row_shr:4 row_mask:0xf bank_mask:0xf bound_ctrl:1
    v_add_f32_dpp v169, v169, v169 row_shr:4 row_mask:0xf bank_mask:0xf bound_ctrl:1
    v_add_f32_dpp v170, v170, v170 row_shr:4 row_mask:0xf bank_mask:0xf bound_ctrl:1
    v_add_f32_dpp v171, v171, v171 row_shr:4 row_mask:0xf bank_mask:0xf bound_ctrl:1
    v_add_f32_dpp v168, v168, v168 row_shr:8 row_mask:0xf bank_mask:0xf bound_ctrl:1
    v_add_f32_dpp v169, v169, v169 row_shr:8 row_mask:0xf bank_mask:0xf bound_ctrl:1
    v_add_f32_dpp v170, v170, v170 row_shr:8 row_mask:0xf bank_mask:0xf bound_ctrl:1
    v_add_f32_dpp v171, v171, v171 row_shr:8 row_mask:0xf bank_mask:0xf bound_ctrl:1
    v_add_f32_dpp v168, v168, v168 row_bcast:15 row_mask:0xa bank_mask:0xf
    v_add_f32_dpp v169, v169, v169 row_bcast:15 row_mask:0xa bank_mask:0xf
    v_add_f32_dpp v170, v170, v170 row_bcast:15 row_mask:0xa bank_mask:0xf
    v_add_f32_dpp v171, v171, v171 row_bcast:15 row_mask:0xa bank_mask:0xf
    v_add_f32_dpp v168, v168, v168 row_bcast:31 row_mask:0xc bank_mask:0xf
    v_add_f32_dpp v169, v169, v169 row_bcast:31 row_mask:0xc bank_mask:0xf
    v_add_f32_dpp v170, v170, v170 row_bcast:31 row_mask:0xc bank_mask:0xf
    v_add_f32_dpp v171, v171, v171 row_bcast:31 row_mask:0xc bank_mask:0xf
    v_mul_f32 v168, 0x3b124925, v168
    v_mul_f32 v169, 0x3b124925, v169
    v_mul_f32 v170, 0x3b124925, v170
    v_mul_f32 v171, 0x3b124925, v171
    s_lshl_b32 s53, s32, 4
    s_add_u32 s53, s53, 8911888
    s_mov_b32 exec_lo, 0
    s_brev_b32 exec_hi, 1
    buffer_store_dwordx4 v[168:171], v2, s[12:15], s53 offen sc1
    s_mov_b64 exec, -1
    s_mov_b32 exec_lo, -1
    s_mov_b32 exec_hi, 0x0
    buffer_load_dword v196, v3, s[12:15], s58 offen sc1
    s_mov_b64 exec, -1
    s_mov_b32 exec_lo, -1
    s_mov_b32 exec_hi, 0x0
    s_mov_b32 s98, 0x200000
    s_waitcnt vmcnt(0)
    v_cmp_ne_u32 vcc, s24, v196
    s_nop 1
    s_cbranch_vccz Lpoll1d
Lpoll1:
    buffer_load_dword v196, v3, s[12:15], s58 offen sc1
    s_sub_u32 s98, s98, 1
    s_waitcnt vmcnt(0)
    s_cbranch_scc1 Lpoll1d
    v_cmp_ne_u32 vcc, s24, v196
    s_nop 1
    s_cbranch_vccnz Lpoll1
Lpoll1d:
    s_mov_b64 exec, -1
    buffer_load_dwordx4 v[4:7], v244, s[12:15], s55 offen offset:0 sc1
    buffer_load_dwordx4 v[8:11], v244, s[12:15], s55 offen offset:1024 sc1
    buffer_load_dwordx4 v[12:15], v244, s[12:15], s55 offen offset:2048 sc1
    buffer_load_dwordx4 v[16:19], v244, s[12:15], s55 offen offset:3072 sc1
    s_add_u32 s55, s55, 0x4000
    s_and_b32 s55, s55, 0x3c000
    s_add_u32 s53, s3, 0
    s_and_b32 s53, s53, 3
    s_lshl_b32 s53, s53, 11
    s_add_u32 s53, s53, 49152
    v_add_u32 v200, s53, v2
    s_add_u32 s53, s3, 1
    s_and_b32 s53, s53, 3
    s_lshl_b32 s53, s53, 11
    s_add_u32 s53, s53, 49152
    v_add_u32 v201, s53, v2
    s_add_u32 s53, s3, 2
    s_and_b32 s53, s53, 3
    s_lshl_b32 s53, s53, 11
    s_add_u32 s53, s53, 49152
    v_add_u32 v202, s53, v2
    s_add_u32 s53, s3, 3
    s_and_b32 s53, s53, 3
    s_lshl_b32 s53, s53, 11
    s_add_u32 s53, s53, 49152
    v_add_u32 v203, s53, v2
    ds_write_b128 v200, v[52:55]
    v_lshrrev_b32 v197, 3, v1
    v_lshrrev_b32 v198, 1, v1
    v_and_b32 v198, 4, v198
    v_and_b32 v199, 7, v1
    v_xor_b32 v198, v198, v199
    v_mul_u32_u24 v197, 1792, v197
    v_lshl_add_u32 v212, v198, 4, v197
    s_cmp_lt_u32 s3, 2
    s_cselect_b32 s20, s40, s42
    s_cselect_b32 s21, s41, s43
    s_mov_b32 s22, 1605632
    s_mov_b32 s23, 0x20000
    s_and_b32 s53, s3, 1
    s_mul_i32 s53, s53, 7
    s_add_u32 s53, s53, s0
    s_sub_u32 s1, s53, 14
    s_min_u32 s1, s1, s53
    s_mul_i32 s1, s1, 114688
    s_mul_i32 s56, s30, 224
    s_mul_i32 s57, s3, 14336
    s_lshl_b32 s53, s38, 5
    s_add_u32 s56, s56, s53
    s_and_b32 s53, s3, 2
    v_and_b32 v197, 3, v1
    v_xor_b32 v197, s53, v197
    v_lshrrev_b32 v198, 2, v1
    v_mul_u32_u24 v198, 3584, v198
    v_lshl_add_u32 v213, v197, 4, v198
    s_lshl_b32 s53, s53, 1
    v_lshrrev_b32 v197, 1, v1
    v_xor_b32 v197, s53, v197
    v_mul_u32_u24 v197, 3584, v197
    v_and_b32 v198, 1, v1
    v_lshl_add_u32 v223, v198, 4, v197
    v_add_u32 v245, 56320, v213
    s_waitcnt lgkmcnt(0)
    s_barrier
    s_add_u32 s53, s3, 0
    s_and_b32 s53, s53, 3
    s_mul_i32 s53, s53, 12288
    s_add_u32 s53, s53, 114688
    v_add_u32 v240, s53, v2
    s_add_u32 s53, s3, 1
    s_and_b32 s53, s53, 3
    s_mul_i32 s53, s53, 12288
    s_add_u32 s53, s53, 114688
    v_add_u32 v241, s53, v2
    s_add_u32 s53, s3, 2
    s_and_b32 s53, s53, 3
    s_mul_i32 s53, s53, 12288
    s_add_u32 s53, s53, 114688
    v_add_u32 v242, s53, v2
    s_add_u32 s53, s3, 3
    s_and_b32 s53, s53, 3
    s_mul_i32 s53, s53, 12288
    s_add_u32 s53, s53, 114688
    v_add_u32 v243, s53, v2
    s_and_b32 s59, s3, 1
    s_lshl_b32 s53, s27, 1
    s_add_u32 s59, s59, s53
    s_mul_i32 s59, s59, 28672
    s_lshr_b32 s53, s3, 1
    s_lshl_b32 s53, s53, 6
    s_add_u32 s59, s59, s53
    s_lshl_b32 s53, s28, 7
    s_add_u32 s59, s59, s53
    v_and_b32 v246, 31, v1
    v_lshrrev_b32 v197, 5, v1
    v_mul_u32_u24 v246, 896, v246
    v_lshl_add_u32 v246, v197, 4, v246
    ds_read_b128 v[60:63], v201
    ds_read_b128 v[68:71], v202
    ds_read_b128 v[76:79], v203
    s_lshl_b32 s48, s2, 2
    s_add_u32 s48, s48, s3
    s_mov_b32 s10, 1605632
    s_cmp_ge_u32 s48, 784
    s_cselect_b32 s8, s36, s44
    s_cselect_b32 s9, s37, s45
    s_cselect_b32 s10, 401408, s10
    s_cselect_b32 s49, 784, 0
    s_sub_u32 s48, s48, s49
    s_mul_i32 s48, s48, 2048
    s_min_u32 s48, s48, s10
    s_sub_u32 s10, s10, s48
    s_add_u32 s8, s8, s48
    s_addc_u32 s9, s9, 0
    s_mov_b32 s11, 0x20000
    buffer_load_dwordx4 v[20:23], v244, s[12:15], s55 offen offset:0 sc1
    buffer_load_dwordx4 v[24:27], v244, s[12:15], s55 offen offset:1024 sc1
    buffer_load_dwordx4 v[28:31], v244, s[12:15], s55 offen offset:2048 sc1
    buffer_load_dwordx4 v[32:35], v244, s[12:15], s55 offen offset:3072 sc1
    s_add_u32 s55, s55, 0x4000
    s_and_b32 s55, s55, 0x3c000
    buffer_load_dwordx4 v[36:39], v244, s[12:15], s55 offen offset:0 sc1
    buffer_load_dwordx4 v[40:43], v244, s[12:15], s55 offen offset:1024 sc1
    buffer_load_dwordx4 v[44:47], v244, s[12:15], s55 offen offset:2048 sc1
    buffer_load_dwordx4 v[48:51], v244, s[12:15], s55 offen offset:3072 sc1
    s_add_u32 s55, s55, 0x4000
    s_and_b32 s55, s55, 0x3c000
    v_lshrrev_b32 v219, 5, v1
    v_lshlrev_b32 v219, 4, v219
    s_waitcnt vmcnt(10)
    v_mfma_f32_32x32x16_bf16 v[148:163], v[4:7], v[52:55], 0
    v_mfma_f32_32x32x16_bf16 v[148:163], v[8:11], v[56:59], v[148:163]
    v_cmp_lt_u32 vcc, 31, v1
    s_nop 10
    v_max3_f32 v196, v148, v149, v150
    v_max3_f32 v197, v151, v152, v153
    v_max3_f32 v196, v196, v154, v155
    v_max3_f32 v197, v197, v156, v157
    v_max3_f32 v196, v196, v158, v159
    v_max3_f32 v197, v197, v160, v161
    v_max3_f32 v196, v196, v162, v163
    v_max_f32 v196, v196, v197
    v_mov_b32 v197, v196
    s_nop 1
    v_permlane32_swap_b32 v196, v197
    v_max_f32 v196, v196, v197
    v_cvt_pk_bf16_f32 v196, -v196, 0
    v_cndmask_b32 v58, v58, v196, vcc
    ds_write_b128 v200, v[56:59] offset:1024
    v_lshlrev_b32 v198, 16, v196
    v_pk_add_f32 v[148:149], v[148:149], v[198:199] op_sel_hi:[1,0]
    v_pk_add_f32 v[150:151], v[150:151], v[198:199] op_sel_hi:[1,0]
    v_pk_add_f32 v[152:153], v[152:153], v[198:199] op_sel_hi:[1,0]
    v_pk_add_f32 v[154:155], v[154:155], v[198:199] op_sel_hi:[1,0]
    v_pk_add_f32 v[156:157], v[156:157], v[198:199] op_sel_hi:[1,0]
    v_pk_add_f32 v[158:159], v[158:159], v[198:199] op_sel_hi:[1,0]
    v_pk_add_f32 v[160:161], v[160:161], v[198:199] op_sel_hi:[1,0]
    v_pk_add_f32 v[162:163], v[162:163], v[198:199] op_sel_hi:[1,0]
    v_mfma_f32_32x32x16_bf16 v[164:179], v[4:7], v[60:63], 0
    buffer_load_dwordx4 v[224:227], v244, s[12:15], s55 offen offset:0 sc1
    v_exp_f32 v148, v148
    v_exp_f32 v149, v149
    v_exp_f32 v150, v150
    v_cvt_pk_bf16_f32 v180, v148, v149
    v_exp_f32 v151, v151
    s_waitcnt lgkmcnt(0)
    s_barrier
    ds_read_b128 v[64:67], v201 offset:1024
    ds_read_b128 v[72:75], v202 offset:1024
    ds_read_b128 v[80:83], v203 offset:1024
    s_mov_b64 exec, 0x1ffffff
    buffer_load_dword a7, v3, s[16:19], 0 offen
    s_mov_b64 exec, -1
    v_exp_f32 v152, v152
    v_cvt_pk_bf16_f32 v181, v150, v151
    v_exp_f32 v153, v153
    v_exp_f32 v154, v154
    v_cvt_pk_bf16_f32 v182, v152, v153
    v_exp_f32 v155, v155
    v_exp_f32 v156, v156
    v_cvt_pk_bf16_f32 v183, v154, v155
    buffer_load_dwordx4 v[228:231], v244, s[12:15], s55 offen offset:1024 sc1
    s_waitcnt lgkmcnt(2)
    v_mfma_f32_32x32x16_bf16 v[164:179], v[8:11], v[64:67], v[164:179]
    s_waitcnt vmcnt(11)
    v_exp_f32 v157, v157
    v_exp_f32 v158, v158
    v_cvt_pk_bf16_f32 v184, v156, v157
    v_exp_f32 v159, v159
    v_exp_f32 v160, v160
    v_cvt_pk_bf16_f32 v185, v158, v159
    v_exp_f32 v161, v161
    v_exp_f32 v162, v162
    v_exp_f32 v163, v163
    v_cvt_pk_bf16_f32 v186, v160, v161
    s_waitcnt lgkmcnt(0)
    v_cvt_pk_bf16_f32 v187, v162, v163
    s_nop 3
    v_mfma_f32_32x32x16_bf16 v[148:163], v[4:7], v[68:71], 0
    buffer_load_dwordx4 v[232:235], v244, s[12:15], s55 offen offset:2048 sc1
    v_exp_f32 v164, v164
    v_exp_f32 v165, v165
    v_exp_f32 v166, v166
    v_cvt_pk_bf16_f32 v188, v164, v165
    v_exp_f32 v167, v167
    v_exp_f32 v168, v168
    v_mfma_f32_32x32x16_bf16 v[148:163], v[8:11], v[72:75], v[148:163]
    v_cvt_pk_bf16_f32 v189, v166, v167
    v_exp_f32 v169, v169
    v_exp_f32 v170, v170
    v_cvt_pk_bf16_f32 v190, v168, v169
    v_exp_f32 v171, v171
    v_exp_f32 v172, v172
    v_mfma_f32_32x32x16_bf16 v[84:99], v[12:15], v[180:183], 0
    buffer_load_dwordx4 v[236:239], v244, s[12:15], s55 offen offset:3072 sc1
    v_cvt_pk_bf16_f32 v191, v170, v171
    v_exp_f32 v173, v173
    v_exp_f32 v174, v174
    v_cvt_pk_bf16_f32 v192, v172, v173
    v_exp_f32 v175, v175
    v_exp_f32 v176, v176
    v_mfma_f32_32x32x16_bf16 v[84:99], v[16:19], v[184:187], v[84:99]
    v_cvt_pk_bf16_f32 v193, v174, v175
    v_exp_f32 v177, v177
    v_exp_f32 v178, v178
    v_exp_f32 v179, v179
    v_cvt_pk_bf16_f32 v194, v176, v177
    v_cvt_pk_bf16_f32 v195, v178, v179
    v_mfma_f32_32x32x16_bf16 v[164:179], v[4:7], v[76:79], 0
    s_add_u32 s55, s55, 0x4000
    v_exp_f32 v148, v148
    v_exp_f32 v149, v149
    v_exp_f32 v150, v150
    v_cvt_pk_bf16_f32 v180, v148, v149
    v_exp_f32 v151, v151
    v_exp_f32 v152, v152
    v_mfma_f32_32x32x16_bf16 v[164:179], v[8:11], v[80:83], v[164:179]
    v_cvt_pk_bf16_f32 v181, v150, v151
    v_exp_f32 v153, v153
    v_exp_f32 v154, v154
    v_cvt_pk_bf16_f32 v182, v152, v153
    v_exp_f32 v155, v155
    v_exp_f32 v156, v156
    v_mfma_f32_32x32x16_bf16 v[100:115], v[12:15], v[188:191], 0
    s_and_b32 s55, s55, 0x3c000
    v_cvt_pk_bf16_f32 v183, v154, v155
    v_exp_f32 v157, v157
    v_exp_f32 v158, v158
    v_cvt_pk_bf16_f32 v184, v156, v157
    v_exp_f32 v159, v159
    v_exp_f32 v160, v160
    v_mfma_f32_32x32x16_bf16 v[100:115], v[16:19], v[192:195], v[100:115]
    s_waitcnt vmcnt(9)
    v_cvt_pk_bf16_f32 v185, v158, v159
    v_exp_f32 v161, v161
    v_exp_f32 v162, v162
    v_exp_f32 v163, v163
    v_cvt_pk_bf16_f32 v186, v160, v161
    v_cvt_pk_bf16_f32 v187, v162, v163
    v_mfma_f32_32x32x16_bf16 v[148:163], v[20:23], v[52:55], 0
    v_exp_f32 v164, v164
    v_exp_f32 v165, v165
    v_exp_f32 v166, v166
    v_cvt_pk_bf16_f32 v188, v164, v165
    v_exp_f32 v167, v167
    v_exp_f32 v168, v168
    v_mfma_f32_32x32x16_bf16 v[148:163], v[24:27], v[56:59], v[148:163]
    v_cvt_pk_bf16_f32 v189, v166, v167
    v_exp_f32 v169, v169
    v_exp_f32 v170, v170
    v_cvt_pk_bf16_f32 v190, v168, v169
    v_exp_f32 v171, v171
    v_exp_f32 v172, v172
    v_mfma_f32_32x32x16_bf16 v[116:131], v[12:15], v[180:183], 0
    v_cvt_pk_bf16_f32 v191, v170, v171
    v_exp_f32 v173, v173
    v_exp_f32 v174, v174
    v_cvt_pk_bf16_f32 v192, v172, v173
    v_exp_f32 v175, v175
    v_exp_f32 v176, v176
    v_mfma_f32_32x32x16_bf16 v[116:131], v[16:19], v[184:187], v[116:131]
    v_cvt_pk_bf16_f32 v193, v174, v175
    v_exp_f32 v177, v177
    v_exp_f32 v178, v178
    v_exp_f32 v179, v179
    v_cvt_pk_bf16_f32 v194, v176, v177
    v_cvt_pk_bf16_f32 v195, v178, v179
    v_mfma_f32_32x32x16_bf16 v[164:179], v[20:23], v[60:63], 0
    v_exp_f32 v148, v148
    v_exp_f32 v149, v149
    v_exp_f32 v150, v150
    v_cvt_pk_bf16_f32 v180, v148, v149
    v_exp_f32 v151, v151
    v_exp_f32 v152, v152
    v_mfma_f32_32x32x16_bf16 v[164:179], v[24:27], v[64:67], v[164:179]
    v_cvt_pk_bf16_f32 v181, v150, v151
    v_exp_f32 v153, v153
    v_exp_f32 v154, v154
    v_cvt_pk_bf16_f32 v182, v152, v153
    v_exp_f32 v155, v155
    v_exp_f32 v156, v156
    v_mfma_f32_32x32x16_bf16 v[132:147], v[12:15], v[188:191], 0
    v_cvt_pk_bf16_f32 v183, v154, v155
    v_exp_f32 v157, v157
    v_exp_f32 v158, v158
    v_cvt_pk_bf16_f32 v184, v156, v157
    v_exp_f32 v159, v159
    v_exp_f32 v160, v160
    v_mfma_f32_32x32x16_bf16 v[132:147], v[16:19], v[192:195], v[132:147]
    buffer_load_dwordx4 v[4:7], v244, s[12:15], s55 offen offset:0 sc1
    v_cvt_pk_bf16_f32 v185, v158, v159
    v_exp_f32 v161, v161
    v_exp_f32 v162, v162
    v_exp_f32 v163, v163
    v_cvt_pk_bf16_f32 v186, v160, v161
    v_cvt_pk_bf16_f32 v187, v162, v163
    v_mfma_f32_32x32x16_bf16 v[148:163], v[20:23], v[68:71], 0
    v_exp_f32 v164, v164
    v_exp_f32 v165, v165
    v_exp_f32 v166, v166
    v_cvt_pk_bf16_f32 v188, v164, v165
    v_exp_f32 v167, v167
    v_exp_f32 v168, v168
    v_mfma_f32_32x32x16_bf16 v[148:163], v[24:27], v[72:75], v[148:163]
    buffer_load_dwordx4 v[8:11], v244, s[12:15], s55 offen offset:1024 sc1
    v_cvt_pk_bf16_f32 v189, v166, v167
    v_exp_f32 v169, v169
    v_exp_f32 v170, v170
    v_cvt_pk_bf16_f32 v190, v168, v169
    v_exp_f32 v171, v171
    v_exp_f32 v172, v172
    v_mfma_f32_32x32x16_bf16 v[84:99], v[28:31], v[180:183], v[84:99]
    s_lshl_b32 s54, s32, 7
    s_add_u32 s54, s54, 17629184
    v_mov_b32 v217, s24
    s_mov_b64 exec, 1
    buffer_store_dword v217, v2, s[12:15], s54 offen sc1
    s_mov_b64 exec, -1
    v_cvt_pk_bf16_f32 v191, v170, v171
    v_exp_f32 v173, v173
    v_exp_f32 v174, v174
    v_cvt_pk_bf16_f32 v192, v172, v173
    v_exp_f32 v175, v175
    v_exp_f32 v176, v176
    v_mfma_f32_32x32x16_bf16 v[84:99], v[32:35], v[184:187], v[84:99]
    buffer_load_dwordx4 v[12:15], v244, s[12:15], s55 offen offset:2048 sc1
    v_cvt_pk_bf16_f32 v193, v174, v175
    v_exp_f32 v177, v177
    v_exp_f32 v178, v178
    v_exp_f32 v179, v179
    v_cvt_pk_bf16_f32 v194, v176, v177
    v_cvt_pk_bf16_f32 v195, v178, v179
    v_mfma_f32_32x32x16_bf16 v[164:179], v[20:23], v[76:79], 0
    v_exp_f32 v148, v148
    v_exp_f32 v149, v149
    v_exp_f32 v150, v150
    v_cvt_pk_bf16_f32 v180, v148, v149
    v_exp_f32 v151, v151
    v_exp_f32 v152, v152
    v_mfma_f32_32x32x16_bf16 v[164:179], v[24:27], v[80:83], v[164:179]
    buffer_load_dwordx4 v[16:19], v244, s[12:15], s55 offen offset:3072 sc1
    v_cvt_pk_bf16_f32 v181, v150, v151
    v_exp_f32 v153, v153
    v_exp_f32 v154, v154
    v_cvt_pk_bf16_f32 v182, v152, v153
    v_exp_f32 v155, v155
    v_exp_f32 v156, v156
    v_mfma_f32_32x32x16_bf16 v[100:115], v[28:31], v[188:191], v[100:115]
    v_cvt_pk_bf16_f32 v183, v154, v155
    v_exp_f32 v157, v157
    v_exp_f32 v158, v158
    v_cvt_pk_bf16_f32 v184, v156, v157
    v_exp_f32 v159, v159
    v_exp_f32 v160, v160
    v_mfma_f32_32x32x16_bf16 v[100:115], v[32:35], v[192:195], v[100:115]
    s_waitcnt vmcnt(10)
    v_cvt_pk_bf16_f32 v185, v158, v159
    v_exp_f32 v161, v161
    v_exp_f32 v162, v162
    v_exp_f32 v163, v163
    v_cvt_pk_bf16_f32 v186, v160, v161
    v_cvt_pk_bf16_f32 v187, v162, v163
    v_mfma_f32_32x32x16_bf16 v[148:163], v[36:39], v[52:55], 0
    s_add_u32 s55, s55, 0x4000
    v_exp_f32 v164, v164
    v_exp_f32 v165, v165
    v_exp_f32 v166, v166
    v_cvt_pk_bf16_f32 v188, v164, v165
    v_exp_f32 v167, v167
    v_exp_f32 v168, v168
    v_mfma_f32_32x32x16_bf16 v[148:163], v[40:43], v[56:59], v[148:163]
    s_and_b32 s55, s55, 0x3c000
    v_cvt_pk_bf16_f32 v189, v166, v167
    v_exp_f32 v169, v169
    v_exp_f32 v170, v170
    v_cvt_pk_bf16_f32 v190, v168, v169
    v_exp_f32 v171, v171
    v_exp_f32 v172, v172
    v_mfma_f32_32x32x16_bf16 v[116:131], v[28:31], v[180:183], v[116:131]
    v_cvt_pk_bf16_f32 v191, v170, v171
    v_exp_f32 v173, v173
    v_exp_f32 v174, v174
    v_cvt_pk_bf16_f32 v192, v172, v173
    v_exp_f32 v175, v175
    v_exp_f32 v176, v176
    v_mfma_f32_32x32x16_bf16 v[116:131], v[32:35], v[184:187], v[116:131]
    v_cvt_pk_bf16_f32 v193, v174, v175
    v_exp_f32 v177, v177
    v_exp_f32 v178, v178
    v_exp_f32 v179, v179
    v_cvt_pk_bf16_f32 v194, v176, v177
    v_cvt_pk_bf16_f32 v195, v178, v179
    v_mfma_f32_32x32x16_bf16 v[164:179], v[36:39], v[60:63], 0
    v_exp_f32 v148, v148
    v_exp_f32 v149, v149
    v_exp_f32 v150, v150
    v_cvt_pk_bf16_f32 v180, v148, v149
    v_exp_f32 v151, v151
    v_exp_f32 v152, v152
    v_mfma_f32_32x32x16_bf16 v[164:179], v[40:43], v[64:67], v[164:179]
    v_cvt_pk_bf16_f32 v181, v150, v151
    v_exp_f32 v153, v153
    v_exp_f32 v154, v154
    v_cvt_pk_bf16_f32 v182, v152, v153
    v_exp_f32 v155, v155
    v_exp_f32 v156, v156
    v_mfma_f32_32x32x16_bf16 v[132:147], v[28:31], v[188:191], v[132:147]
    v_cvt_pk_bf16_f32 v183, v154, v155
    v_exp_f32 v157, v157
    v_exp_f32 v158, v158
    v_cvt_pk_bf16_f32 v184, v156, v157
    v_exp_f32 v159, v159
    v_exp_f32 v160, v160
    v_mfma_f32_32x32x16_bf16 v[132:147], v[32:35], v[192:195], v[132:147]
    buffer_load_dwordx4 v[20:23], v244, s[12:15], s55 offen offset:0 sc1
    v_cvt_pk_bf16_f32 v185, v158, v159
    v_exp_f32 v161, v161
    v_exp_f32 v162, v162
    v_exp_f32 v163, v163
    v_cvt_pk_bf16_f32 v186, v160, v161
    v_cvt_pk_bf16_f32 v187, v162, v163
    v_mfma_f32_32x32x16_bf16 v[148:163], v[36:39], v[68:71], 0
    v_exp_f32 v164, v164
    v_exp_f32 v165, v165
    v_exp_f32 v166, v166
    v_cvt_pk_bf16_f32 v188, v164, v165
    v_exp_f32 v167, v167
    v_exp_f32 v168, v168
    v_mfma_f32_32x32x16_bf16 v[148:163], v[40:43], v[72:75], v[148:163]
    buffer_load_dwordx4 v[24:27], v244, s[12:15], s55 offen offset:1024 sc1
    v_cvt_pk_bf16_f32 v189, v166, v167
    v_exp_f32 v169, v169
    v_exp_f32 v170, v170
    v_cvt_pk_bf16_f32 v190, v168, v169
    v_exp_f32 v171, v171
    v_exp_f32 v172, v172
    v_mfma_f32_32x32x16_bf16 v[84:99], v[44:47], v[180:183], v[84:99]
    v_cvt_pk_bf16_f32 v191, v170, v171
    v_exp_f32 v173, v173
    v_exp_f32 v174, v174
    v_cvt_pk_bf16_f32 v192, v172, v173
    v_exp_f32 v175, v175
    v_exp_f32 v176, v176
    v_mfma_f32_32x32x16_bf16 v[84:99], v[48:51], v[184:187], v[84:99]
    buffer_load_dwordx4 v[28:31], v244, s[12:15], s55 offen offset:2048 sc1
    v_cvt_pk_bf16_f32 v193, v174, v175
    v_exp_f32 v177, v177
    v_exp_f32 v178, v178
    v_exp_f32 v179, v179
    v_cvt_pk_bf16_f32 v194, v176, v177
    v_cvt_pk_bf16_f32 v195, v178, v179
    v_mfma_f32_32x32x16_bf16 v[164:179], v[36:39], v[76:79], 0
    buffer_load_dwordx4 v[204:207], v246, s[4:7], s59 offen
    v_exp_f32 v148, v148
    v_exp_f32 v149, v149
    v_exp_f32 v150, v150
    v_cvt_pk_bf16_f32 v180, v148, v149
    v_exp_f32 v151, v151
    v_exp_f32 v152, v152
    v_mfma_f32_32x32x16_bf16 v[164:179], v[40:43], v[80:83], v[164:179]
    buffer_load_dwordx4 v[32:35], v244, s[12:15], s55 offen offset:3072 sc1
    v_cvt_pk_bf16_f32 v181, v150, v151
    v_exp_f32 v153, v153
    v_exp_f32 v154, v154
    v_cvt_pk_bf16_f32 v182, v152, v153
    v_exp_f32 v155, v155
    v_exp_f32 v156, v156
    v_mfma_f32_32x32x16_bf16 v[100:115], v[44:47], v[188:191], v[100:115]
    s_mov_b64 exec, 0xffff
    buffer_load_dword a8, v3, s[8:11], 0 offen
    s_mov_b64 exec, -1
    v_cvt_pk_bf16_f32 v183, v154, v155
    v_exp_f32 v157, v157
    v_exp_f32 v158, v158
    v_cvt_pk_bf16_f32 v184, v156, v157
    v_exp_f32 v159, v159
    v_exp_f32 v160, v160
    v_mfma_f32_32x32x16_bf16 v[100:115], v[48:51], v[192:195], v[100:115]
    s_waitcnt vmcnt(11)
    v_cvt_pk_bf16_f32 v185, v158, v159
    v_exp_f32 v161, v161
    v_exp_f32 v162, v162
    v_exp_f32 v163, v163
    v_cvt_pk_bf16_f32 v186, v160, v161
    v_cvt_pk_bf16_f32 v187, v162, v163
    v_mfma_f32_32x32x16_bf16 v[148:163], v[224:227], v[52:55], 0
    s_add_u32 s55, s55, 0x4000
    v_exp_f32 v164, v164
    v_exp_f32 v165, v165
    v_exp_f32 v166, v166
    v_cvt_pk_bf16_f32 v188, v164, v165
    v_exp_f32 v167, v167
    v_exp_f32 v168, v168
    v_mfma_f32_32x32x16_bf16 v[148:163], v[228:231], v[56:59], v[148:163]
    s_and_b32 s55, s55, 0x3c000
    v_cvt_pk_bf16_f32 v189, v166, v167
    v_exp_f32 v169, v169
    v_exp_f32 v170, v170
    v_cvt_pk_bf16_f32 v190, v168, v169
    v_exp_f32 v171, v171
    v_exp_f32 v172, v172
    v_mfma_f32_32x32x16_bf16 v[116:131], v[44:47], v[180:183], v[116:131]
    buffer_load_dwordx4 v[208:211], v246, s[4:7], s59 offen offset:32
    v_cvt_pk_bf16_f32 v191, v170, v171
    v_exp_f32 v173, v173
    v_exp_f32 v174, v174
    v_cvt_pk_bf16_f32 v192, v172, v173
    v_exp_f32 v175, v175
    v_exp_f32 v176, v176
    v_mfma_f32_32x32x16_bf16 v[116:131], v[48:51], v[184:187], v[116:131]
    v_cvt_pk_bf16_f32 v193, v174, v175
    v_exp_f32 v177, v177
    v_exp_f32 v178, v178
    v_exp_f32 v179, v179
    v_cvt_pk_bf16_f32 v194, v176, v177
    v_cvt_pk_bf16_f32 v195, v178, v179
    v_mfma_f32_32x32x16_bf16 v[164:179], v[224:227], v[60:63], 0
    v_exp_f32 v148, v148
    v_exp_f32 v149, v149
    v_exp_f32 v150, v150
    v_cvt_pk_bf16_f32 v180, v148, v149
    v_exp_f32 v151, v151
    v_exp_f32 v152, v152
    v_mfma_f32_32x32x16_bf16 v[164:179], v[228:231], v[64:67], v[164:179]
    v_cvt_pk_bf16_f32 v181, v150, v151
    v_exp_f32 v153, v153
    v_exp_f32 v154, v154
    v_cvt_pk_bf16_f32 v182, v152, v153
    v_exp_f32 v155, v155
    v_exp_f32 v156, v156
    v_mfma_f32_32x32x16_bf16 v[132:147], v[44:47], v[188:191], v[132:147]
    v_cvt_pk_bf16_f32 v183, v154, v155
    v_exp_f32 v157, v157
    v_exp_f32 v158, v158
    v_cvt_pk_bf16_f32 v184, v156, v157
    v_exp_f32 v159, v159
    v_exp_f32 v160, v160
    v_mfma_f32_32x32x16_bf16 v[132:147], v[48:51], v[192:195], v[132:147]
    buffer_load_dwordx4 v[36:39], v244, s[12:15], s55 offen offset:0 sc1
    v_cvt_pk_bf16_f32 v185, v158, v159
    v_exp_f32 v161, v161
    v_exp_f32 v162, v162
    v_exp_f32 v163, v163
    v_cvt_pk_bf16_f32 v186, v160, v161
    v_cvt_pk_bf16_f32 v187, v162, v163
    v_mfma_f32_32x32x16_bf16 v[148:163], v[224:227], v[68:71], 0
    v_exp_f32 v164, v164
    v_exp_f32 v165, v165
    v_exp_f32 v166, v166
    v_cvt_pk_bf16_f32 v188, v164, v165
    v_exp_f32 v167, v167
    v_exp_f32 v168, v168
    v_mfma_f32_32x32x16_bf16 v[148:163], v[228:231], v[72:75], v[148:163]
    buffer_load_dwordx4 v[40:43], v244, s[12:15], s55 offen offset:1024 sc1
    v_cvt_pk_bf16_f32 v189, v166, v167
    v_exp_f32 v169, v169
    v_exp_f32 v170, v170
    v_cvt_pk_bf16_f32 v190, v168, v169
    v_exp_f32 v171, v171
    v_exp_f32 v172, v172
    v_mfma_f32_32x32x16_bf16 v[84:99], v[232:235], v[180:183], v[84:99]
    v_cvt_pk_bf16_f32 v191, v170, v171
    v_exp_f32 v173, v173
    v_exp_f32 v174, v174
    v_cvt_pk_bf16_f32 v192, v172, v173
    v_exp_f32 v175, v175
    v_exp_f32 v176, v176
    v_mfma_f32_32x32x16_bf16 v[84:99], v[236:239], v[184:187], v[84:99]
    buffer_load_dwordx4 v[44:47], v244, s[12:15], s55 offen offset:2048 sc1
    v_cvt_pk_bf16_f32 v193, v174, v175
    v_exp_f32 v177, v177
    v_exp_f32 v178, v178
    v_exp_f32 v179, v179
    v_cvt_pk_bf16_f32 v194, v176, v177
    v_cvt_pk_bf16_f32 v195, v178, v179
    v_mfma_f32_32x32x16_bf16 v[164:179], v[224:227], v[76:79], 0
    v_exp_f32 v148, v148
    v_exp_f32 v149, v149
    v_exp_f32 v150, v150
    v_cvt_pk_bf16_f32 v180, v148, v149
    v_exp_f32 v151, v151
    v_exp_f32 v152, v152
    v_mfma_f32_32x32x16_bf16 v[164:179], v[228:231], v[80:83], v[164:179]
    buffer_load_dwordx4 v[48:51], v244, s[12:15], s55 offen offset:3072 sc1
    v_cvt_pk_bf16_f32 v181, v150, v151
    v_exp_f32 v153, v153
    v_exp_f32 v154, v154
    v_cvt_pk_bf16_f32 v182, v152, v153
    v_exp_f32 v155, v155
    v_exp_f32 v156, v156
    v_mfma_f32_32x32x16_bf16 v[100:115], v[232:235], v[188:191], v[100:115]
    v_cvt_pk_bf16_f32 v183, v154, v155
    v_exp_f32 v157, v157
    v_exp_f32 v158, v158
    v_cvt_pk_bf16_f32 v184, v156, v157
    v_exp_f32 v159, v159
    v_exp_f32 v160, v160
    v_mfma_f32_32x32x16_bf16 v[100:115], v[236:239], v[192:195], v[100:115]
    s_waitcnt vmcnt(11)
    v_cvt_pk_bf16_f32 v185, v158, v159
    v_exp_f32 v161, v161
    v_exp_f32 v162, v162
    v_exp_f32 v163, v163
    v_cvt_pk_bf16_f32 v186, v160, v161
    v_cvt_pk_bf16_f32 v187, v162, v163
    v_mfma_f32_32x32x16_bf16 v[148:163], v[4:7], v[52:55], 0
    s_add_u32 s55, s55, 0x4000
Lpage4:
    s_cbranch_execz Lvis0
    v_exp_f32 v164, v164
    v_exp_f32 v165, v165
    v_exp_f32 v166, v166
    v_cvt_pk_bf16_f32 v188, v164, v165
    v_exp_f32 v167, v167
    v_exp_f32 v168, v168
    v_mfma_f32_32x32x16_bf16 v[148:163], v[8:11], v[56:59], v[148:163]
    s_and_b32 s55, s55, 0x3c000
    v_cvt_pk_bf16_f32 v189, v166, v167
    v_exp_f32 v169, v169
    v_exp_f32 v170, v170
    v_cvt_pk_bf16_f32 v190, v168, v169
    v_exp_f32 v171, v171
    v_exp_f32 v172, v172
    v_mfma_f32_32x32x16_bf16 v[116:131], v[232:235], v[180:183], v[116:131]
    v_cvt_pk_bf16_f32 v191, v170, v171
    v_exp_f32 v173, v173
    v_exp_f32 v174, v174
    v_cvt_pk_bf16_f32 v192, v172, v173
    v_exp_f32 v175, v175
    v_exp_f32 v176, v176
    v_mfma_f32_32x32x16_bf16 v[116:131], v[236:239], v[184:187], v[116:131]
    v_cvt_pk_bf16_f32 v193, v174, v175
    v_exp_f32 v177, v177
    v_exp_f32 v178, v178
    v_exp_f32 v179, v179
    v_cvt_pk_bf16_f32 v194, v176, v177
    v_cvt_pk_bf16_f32 v195, v178, v179
    v_mfma_f32_32x32x16_bf16 v[164:179], v[4:7], v[60:63], 0
    v_exp_f32 v148, v148
    v_exp_f32 v149, v149
    v_exp_f32 v150, v150
    v_cvt_pk_bf16_f32 v180, v148, v149
    v_exp_f32 v151, v151
    v_exp_f32 v152, v152
    v_mfma_f32_32x32x16_bf16 v[164:179], v[8:11], v[64:67], v[164:179]
    v_cvt_pk_bf16_f32 v181, v150, v151
    v_exp_f32 v153, v153
    v_exp_f32 v154, v154
    v_cvt_pk_bf16_f32 v182, v152, v153
    v_exp_f32 v155, v155
    v_exp_f32 v156, v156
    v_mfma_f32_32x32x16_bf16 v[132:147], v[232:235], v[188:191], v[132:147]
    v_cvt_pk_bf16_f32 v183, v154, v155
    v_exp_f32 v157, v157
    v_exp_f32 v158, v158
    v_cvt_pk_bf16_f32 v184, v156, v157
    v_exp_f32 v159, v159
    v_exp_f32 v160, v160
    v_mfma_f32_32x32x16_bf16 v[132:147], v[236:239], v[192:195], v[132:147]
    buffer_load_dwordx4 v[224:227], v244, s[12:15], s55 offen offset:0 sc1
    v_cvt_pk_bf16_f32 v185, v158, v159
    v_exp_f32 v161, v161
    v_exp_f32 v162, v162
    v_exp_f32 v163, v163
    v_cvt_pk_bf16_f32 v186, v160, v161
    v_cvt_pk_bf16_f32 v187, v162, v163
    v_mfma_f32_32x32x16_bf16 v[148:163], v[4:7], v[68:71], 0
    v_exp_f32 v164, v164
    v_exp_f32 v165, v165
    v_exp_f32 v166, v166
    v_cvt_pk_bf16_f32 v188, v164, v165
    v_exp_f32 v167, v167
    v_exp_f32 v168, v168
    v_mfma_f32_32x32x16_bf16 v[148:163], v[8:11], v[72:75], v[148:163]
    buffer_load_dwordx4 v[228:231], v244, s[12:15], s55 offen offset:1024 sc1
    v_cvt_pk_bf16_f32 v189, v166, v167
    v_exp_f32 v169, v169
    v_exp_f32 v170, v170
    v_cvt_pk_bf16_f32 v190, v168, v169
    v_exp_f32 v171, v171
    v_exp_f32 v172, v172
    v_mfma_f32_32x32x16_bf16 v[84:99], v[12:15], v[180:183], v[84:99]
    v_cvt_pk_bf16_f32 v191, v170, v171
    v_exp_f32 v173, v173
    v_exp_f32 v174, v174
    v_cvt_pk_bf16_f32 v192, v172, v173
    v_exp_f32 v175, v175
    v_exp_f32 v176, v176
    v_mfma_f32_32x32x16_bf16 v[84:99], v[16:19], v[184:187], v[84:99]
    buffer_load_dwordx4 v[232:235], v244, s[12:15], s55 offen offset:2048 sc1
    v_cvt_pk_bf16_f32 v193, v174, v175
    v_exp_f32 v177, v177
    v_exp_f32 v178, v178
    v_exp_f32 v179, v179
    v_cvt_pk_bf16_f32 v194, v176, v177
    v_cvt_pk_bf16_f32 v195, v178, v179
    v_mfma_f32_32x32x16_bf16 v[164:179], v[4:7], v[76:79], 0
    s_add_u32 s53, s56, s1
    v_exp_f32 v148, v148
    v_exp_f32 v149, v149
    v_exp_f32 v150, v150
    v_cvt_pk_bf16_f32 v180, v148, v149
    v_exp_f32 v151, v151
    v_exp_f32 v152, v152
    v_mfma_f32_32x32x16_bf16 v[164:179], v[8:11], v[80:83], v[164:179]
    buffer_load_dwordx4 v[236:239], v244, s[12:15], s55 offen offset:3072 sc1
    v_cvt_pk_bf16_f32 v181, v150, v151
    v_exp_f32 v153, v153
    v_exp_f32 v154, v154
    v_cvt_pk_bf16_f32 v182, v152, v153
    v_exp_f32 v155, v155
    v_exp_f32 v156, v156
    v_mfma_f32_32x32x16_bf16 v[100:115], v[12:15], v[188:191], v[100:115]
    s_add_u32 m0, s57, 0
    v_cvt_pk_bf16_f32 v183, v154, v155
    v_exp_f32 v157, v157
    v_exp_f32 v158, v158
    v_cvt_pk_bf16_f32 v184, v156, v157
    v_exp_f32 v159, v159
    v_exp_f32 v160, v160
    v_mfma_f32_32x32x16_bf16 v[100:115], v[16:19], v[192:195], v[100:115]
    s_waitcnt vmcnt(10)
    v_cvt_pk_bf16_f32 v185, v158, v159
    v_exp_f32 v161, v161
    v_exp_f32 v162, v162
    v_exp_f32 v163, v163
    v_cvt_pk_bf16_f32 v186, v160, v161
    v_cvt_pk_bf16_f32 v187, v162, v163
    v_mfma_f32_32x32x16_bf16 v[148:163], v[20:23], v[52:55], 0
    s_add_u32 s55, s55, 0x4000
    v_exp_f32 v164, v164
    v_exp_f32 v165, v165
    v_exp_f32 v166, v166
    v_cvt_pk_bf16_f32 v188, v164, v165
    v_exp_f32 v167, v167
    v_exp_f32 v168, v168
    v_mfma_f32_32x32x16_bf16 v[148:163], v[24:27], v[56:59], v[148:163]
    s_and_b32 s55, s55, 0x3c000
    v_cvt_pk_bf16_f32 v189, v166, v167
    v_exp_f32 v169, v169
    v_exp_f32 v170, v170
    v_cvt_pk_bf16_f32 v190, v168, v169
    v_exp_f32 v171, v171
    v_exp_f32 v172, v172
    v_mfma_f32_32x32x16_bf16 v[116:131], v[12:15], v[180:183], v[116:131]
    buffer_load_dwordx4 v213, s[20:23], s53 offen offset:0 lds
    v_cvt_pk_bf16_f32 v191, v170, v171
    v_exp_f32 v173, v173
    v_exp_f32 v174, v174
    v_cvt_pk_bf16_f32 v192, v172, v173
    v_exp_f32 v175, v175
    v_exp_f32 v176, v176
    v_mfma_f32_32x32x16_bf16 v[116:131], v[16:19], v[184:187], v[116:131]
    v_cvt_pk_bf16_f32 v193, v174, v175
    v_exp_f32 v177, v177
    v_exp_f32 v178, v178
    v_exp_f32 v179, v179
    v_cvt_pk_bf16_f32 v194, v176, v177
    v_cvt_pk_bf16_f32 v195, v178, v179
    v_mfma_f32_32x32x16_bf16 v[164:179], v[20:23], v[60:63], 0
    v_exp_f32 v148, v148
    v_exp_f32 v149, v149
    v_exp_f32 v150, v150
    v_cvt_pk_bf16_f32 v180, v148, v149
    v_exp_f32 v151, v151
    v_exp_f32 v152, v152
    v_mfma_f32_32x32x16_bf16 v[164:179], v[24:27], v[64:67], v[164:179]
    buffer_load_dwordx4 v245, s[20:23], s53 offen offset:1024 lds
    v_cvt_pk_bf16_f32 v181, v150, v151
    v_exp_f32 v153, v153
    v_exp_f32 v154, v154
    v_cvt_pk_bf16_f32 v182, v152, v153
    v_exp_f32 v155, v155
    v_exp_f32 v156, v156
    v_mfma_f32_32x32x16_bf16 v[132:147], v[12:15], v[188:191], v[132:147]
    s_add_u32 m0, s57, 57280
    v_cvt_pk_bf16_f32 v183, v154, v155
    v_exp_f32 v157, v157
    v_exp_f32 v158, v158
    v_cvt_pk_bf16_f32 v184, v156, v157
    v_exp_f32 v159, v159
    v_exp_f32 v160, v160
    v_mfma_f32_32x32x16_bf16 v[132:147], v[16:19], v[192:195], v[132:147]
    buffer_load_dwordx4 v[4:7], v244, s[12:15], s55 offen offset:0 sc1
    v_cvt_pk_bf16_f32 v185, v158, v159
    v_exp_f32 v161, v161
    v_exp_f32 v162, v162
    v_exp_f32 v163, v163
    v_cvt_pk_bf16_f32 v186, v160, v161
    v_cvt_pk_bf16_f32 v187, v162, v163
    v_mfma_f32_32x32x16_bf16 v[148:163], v[20:23], v[68:71], 0
    v_exp_f32 v164, v164
    v_exp_f32 v165, v165
    v_exp_f32 v166, v166
    v_cvt_pk_bf16_f32 v188, v164, v165
    v_exp_f32 v167, v167
    v_exp_f32 v168, v168
    v_mfma_f32_32x32x16_bf16 v[148:163], v[24:27], v[72:75], v[148:163]
    buffer_load_dwordx4 v[8:11], v244, s[12:15], s55 offen offset:1024 sc1
    v_cvt_pk_bf16_f32 v189, v166, v167
    v_exp_f32 v169, v169
    v_exp_f32 v170, v170
    v_cvt_pk_bf16_f32 v190, v168, v169
    v_exp_f32 v171, v171
    v_exp_f32 v172, v172
    v_mfma_f32_32x32x16_bf16 v[84:99], v[28:31], v[180:183], v[84:99]
    buffer_load_dwordx4 v213, s[20:23], s53 offen offset:64 lds
    v_cvt_pk_bf16_f32 v191, v170, v171
    v_exp_f32 v173, v173
    v_exp_f32 v174, v174
    v_cvt_pk_bf16_f32 v192, v172, v173
    v_exp_f32 v175, v175
    v_exp_f32 v176, v176
    v_mfma_f32_32x32x16_bf16 v[84:99], v[32:35], v[184:187], v[84:99]
    buffer_load_dwordx4 v[12:15], v244, s[12:15], s55 offen offset:2048 sc1
    v_cvt_pk_bf16_f32 v193, v174, v175
    v_exp_f32 v177, v177
    v_exp_f32 v178, v178
    v_exp_f32 v179, v179
    v_cvt_pk_bf16_f32 v194, v176, v177
    v_cvt_pk_bf16_f32 v195, v178, v179
    v_mfma_f32_32x32x16_bf16 v[164:179], v[20:23], v[76:79], 0
    v_exp_f32 v148, v148
    v_exp_f32 v149, v149
    v_exp_f32 v150, v150
    v_cvt_pk_bf16_f32 v180, v148, v149
    v_exp_f32 v151, v151
    v_exp_f32 v152, v152
    v_mfma_f32_32x32x16_bf16 v[164:179], v[24:27], v[80:83], v[164:179]
    buffer_load_dwordx4 v[16:19], v244, s[12:15], s55 offen offset:3072 sc1
    v_cvt_pk_bf16_f32 v181, v150, v151
    v_exp_f32 v153, v153
    v_exp_f32 v154, v154
    v_cvt_pk_bf16_f32 v182, v152, v153
    v_exp_f32 v155, v155
    v_exp_f32 v156, v156
    v_mfma_f32_32x32x16_bf16 v[100:115], v[28:31], v[188:191], v[100:115]
    v_cvt_pk_bf16_f32 v183, v154, v155
    v_exp_f32 v157, v157
    v_exp_f32 v158, v158
    v_cvt_pk_bf16_f32 v184, v156, v157
    v_exp_f32 v159, v159
    v_exp_f32 v160, v160
    v_mfma_f32_32x32x16_bf16 v[100:115], v[32:35], v[192:195], v[100:115]
    s_waitcnt vmcnt(11)
    v_cvt_pk_bf16_f32 v185, v158, v159
    v_exp_f32 v161, v161
    v_exp_f32 v162, v162
    v_exp_f32 v163, v163
    v_cvt_pk_bf16_f32 v186, v160, v161
    v_cvt_pk_bf16_f32 v187, v162, v163
    v_mfma_f32_32x32x16_bf16 v[148:163], v[36:39], v[52:55], 0
    s_add_u32 s55, s55, 0x4000
    v_exp_f32 v164, v164
    v_exp_f32 v165, v165
    v_exp_f32 v166, v166
    v_cvt_pk_bf16_f32 v188, v164, v165
    v_exp_f32 v167, v167
    v_exp_f32 v168, v168
    v_mfma_f32_32x32x16_bf16 v[148:163], v[40:43], v[56:59], v[148:163]
    s_and_b32 s55, s55, 0x3c000
    v_cvt_pk_bf16_f32 v189, v166, v167
    v_exp_f32 v169, v169
    v_exp_f32 v170, v170
    v_cvt_pk_bf16_f32 v190, v168, v169
    v_exp_f32 v171, v171
    v_exp_f32 v172, v172
    v_mfma_f32_32x32x16_bf16 v[116:131], v[28:31], v[180:183], v[116:131]
    buffer_load_dwordx4 v245, s[20:23], s53 offen offset:1088 lds
    v_cvt_pk_bf16_f32 v191, v170, v171
    v_exp_f32 v173, v173
    v_exp_f32 v174, v174
    v_cvt_pk_bf16_f32 v192, v172, v173
    v_exp_f32 v175, v175
    v_exp_f32 v176, v176
    v_mfma_f32_32x32x16_bf16 v[116:131], v[32:35], v[184:187], v[116:131]
    v_cvt_pk_bf16_f32 v193, v174, v175
    v_exp_f32 v177, v177
    v_exp_f32 v178, v178
    v_exp_f32 v179, v179
    v_cvt_pk_bf16_f32 v194, v176, v177
    v_cvt_pk_bf16_f32 v195, v178, v179
    v_mfma_f32_32x32x16_bf16 v[164:179], v[36:39], v[60:63], 0
    buffer_load_dwordx4 a[196:199], v223, s[20:23], s53 offen offset:128
    v_exp_f32 v148, v148
    v_exp_f32 v149, v149
    v_exp_f32 v150, v150
    v_cvt_pk_bf16_f32 v180, v148, v149
    v_exp_f32 v151, v151
    v_exp_f32 v152, v152
    v_mfma_f32_32x32x16_bf16 v[164:179], v[40:43], v[64:67], v[164:179]
    s_add_u32 s1, s1, 114688
    v_cvt_pk_bf16_f32 v181, v150, v151
    v_exp_f32 v153, v153
    v_exp_f32 v154, v154
    v_cvt_pk_bf16_f32 v182, v152, v153
    v_exp_f32 v155, v155
    v_exp_f32 v156, v156
    v_mfma_f32_32x32x16_bf16 v[132:147], v[28:31], v[188:191], v[132:147]
    s_sub_u32 s53, s1, 1605632
    v_cvt_pk_bf16_f32 v183, v154, v155
    v_exp_f32 v157, v157
    v_exp_f32 v158, v158
    v_cvt_pk_bf16_f32 v184, v156, v157
    v_exp_f32 v159, v159
    v_exp_f32 v160, v160
    v_mfma_f32_32x32x16_bf16 v[132:147], v[32:35], v[192:195], v[132:147]
    buffer_load_dwordx4 v[20:23], v244, s[12:15], s55 offen offset:0 sc1
    v_cvt_pk_bf16_f32 v185, v158, v159
    v_exp_f32 v161, v161
    v_exp_f32 v162, v162
    v_exp_f32 v163, v163
    v_cvt_pk_bf16_f32 v186, v160, v161
    v_cvt_pk_bf16_f32 v187, v162, v163
    v_mfma_f32_32x32x16_bf16 v[148:163], v[36:39], v[68:71], 0
    s_min_u32 s1, s1, s53
    v_exp_f32 v164, v164
    v_exp_f32 v165, v165
    v_exp_f32 v166, v166
    v_cvt_pk_bf16_f32 v188, v164, v165
    v_exp_f32 v167, v167
    v_exp_f32 v168, v168
    v_mfma_f32_32x32x16_bf16 v[148:163], v[40:43], v[72:75], v[148:163]
    buffer_load_dwordx4 v[24:27], v244, s[12:15], s55 offen offset:1024 sc1
    v_cvt_pk_bf16_f32 v189, v166, v167
    v_exp_f32 v169, v169
    v_exp_f32 v170, v170
    v_cvt_pk_bf16_f32 v190, v168, v169
    v_exp_f32 v171, v171
    v_exp_f32 v172, v172
    v_mfma_f32_32x32x16_bf16 v[84:99], v[44:47], v[180:183], v[84:99]
    s_add_u32 s53, s56, s1
    v_cvt_pk_bf16_f32 v191, v170, v171
    v_exp_f32 v173, v173
    v_exp_f32 v174, v174
    v_cvt_pk_bf16_f32 v192, v172, v173
    v_exp_f32 v175, v175
    v_exp_f32 v176, v176
    v_mfma_f32_32x32x16_bf16 v[84:99], v[48:51], v[184:187], v[84:99]
    buffer_load_dwordx4 v[28:31], v244, s[12:15], s55 offen offset:2048 sc1
    v_cvt_pk_bf16_f32 v193, v174, v175
    v_exp_f32 v177, v177
    v_exp_f32 v178, v178
    v_exp_f32 v179, v179
    v_cvt_pk_bf16_f32 v194, v176, v177
    v_cvt_pk_bf16_f32 v195, v178, v179
    v_mfma_f32_32x32x16_bf16 v[164:179], v[36:39], v[76:79], 0
    s_add_u32 m0, s57, 2048
    v_exp_f32 v148, v148
    v_exp_f32 v149, v149
    v_exp_f32 v150, v150
    v_cvt_pk_bf16_f32 v180, v148, v149
    v_exp_f32 v151, v151
    v_exp_f32 v152, v152
    v_mfma_f32_32x32x16_bf16 v[164:179], v[40:43], v[80:83], v[164:179]
    buffer_load_dwordx4 v[32:35], v244, s[12:15], s55 offen offset:3072 sc1
    v_cvt_pk_bf16_f32 v181, v150, v151
    v_exp_f32 v153, v153
    v_exp_f32 v154, v154
    v_cvt_pk_bf16_f32 v182, v152, v153
    v_exp_f32 v155, v155
    v_exp_f32 v156, v156
    v_mfma_f32_32x32x16_bf16 v[100:115], v[44:47], v[188:191], v[100:115]
    buffer_load_dwordx4 v213, s[20:23], s53 offen offset:0 lds
    v_cvt_pk_bf16_f32 v183, v154, v155
    v_exp_f32 v157, v157
    v_exp_f32 v158, v158
    v_cvt_pk_bf16_f32 v184, v156, v157
    v_exp_f32 v159, v159
    v_exp_f32 v160, v160
    v_mfma_f32_32x32x16_bf16 v[100:115], v[48:51], v[192:195], v[100:115]
    s_waitcnt vmcnt(14)
    v_cvt_pk_bf16_f32 v185, v158, v159
    v_exp_f32 v161, v161
    v_exp_f32 v162, v162
    v_exp_f32 v163, v163
    v_cvt_pk_bf16_f32 v186, v160, v161
    v_cvt_pk_bf16_f32 v187, v162, v163
    v_mfma_f32_32x32x16_bf16 v[148:163], v[224:227], v[52:55], 0
    s_add_u32 s55, s55, 0x4000
    v_exp_f32 v164, v164
    v_exp_f32 v165, v165
    v_exp_f32 v166, v166
    v_cvt_pk_bf16_f32 v188, v164, v165
    v_exp_f32 v167, v167
    v_exp_f32 v168, v168
    v_mfma_f32_32x32x16_bf16 v[148:163], v[228:231], v[56:59], v[148:163]
    s_and_b32 s55, s55, 0x3c000
    v_cvt_pk_bf16_f32 v189, v166, v167
    v_exp_f32 v169, v169
    v_exp_f32 v170, v170
    v_cvt_pk_bf16_f32 v190, v168, v169
    v_exp_f32 v171, v171
    v_exp_f32 v172, v172
    v_mfma_f32_32x32x16_bf16 v[116:131], v[44:47], v[180:183], v[116:131]
    buffer_load_dwordx4 v245, s[20:23], s53 offen offset:1024 lds
    v_cvt_pk_bf16_f32 v191, v170, v171
    v_exp_f32 v173, v173
    v_exp_f32 v174, v174
    v_cvt_pk_bf16_f32 v192, v172, v173
    v_exp_f32 v175, v175
    v_exp_f32 v176, v176
    v_mfma_f32_32x32x16_bf16 v[116:131], v[48:51], v[184:187], v[116:131]
    s_add_u32 m0, s57, 59328
    v_cvt_pk_bf16_f32 v193, v174, v175
    v_exp_f32 v177, v177
    v_exp_f32 v178, v178
    v_exp_f32 v179, v179
    v_cvt_pk_bf16_f32 v194, v176, v177
    v_cvt_pk_bf16_f32 v195, v178, v179
    v_mfma_f32_32x32x16_bf16 v[164:179], v[224:227], v[60:63], 0
    buffer_load_dwordx4 v213, s[20:23], s53 offen offset:64 lds
    v_exp_f32 v148, v148
    v_exp_f32 v149, v149
    v_exp_f32 v150, v150
    v_cvt_pk_bf16_f32 v180, v148, v149
    v_exp_f32 v151, v151
    v_exp_f32 v152, v152
    v_mfma_f32_32x32x16_bf16 v[164:179], v[228:231], v[64:67], v[164:179]
    v_cvt_pk_bf16_f32 v181, v150, v151
    v_exp_f32 v153, v153
    v_exp_f32 v154, v154
    v_cvt_pk_bf16_f32 v182, v152, v153
    v_exp_f32 v155, v155
    v_exp_f32 v156, v156
    v_mfma_f32_32x32x16_bf16 v[132:147], v[44:47], v[188:191], v[132:147]
    v_cvt_pk_bf16_f32 v183, v154, v155
    v_exp_f32 v157, v157
    v_exp_f32 v158, v158
    v_cvt_pk_bf16_f32 v184, v156, v157
    v_exp_f32 v159, v159
    v_exp_f32 v160, v160
    v_mfma_f32_32x32x16_bf16 v[132:147], v[48:51], v[192:195], v[132:147]
    buffer_load_dwordx4 v[36:39], v244, s[12:15], s55 offen offset:0 sc1
    v_cvt_pk_bf16_f32 v185, v158, v159
    v_exp_f32 v161, v161
    v_exp_f32 v162, v162
    v_exp_f32 v163, v163
    v_cvt_pk_bf16_f32 v186, v160, v161
    v_cvt_pk_bf16_f32 v187, v162, v163
    v_mfma_f32_32x32x16_bf16 v[148:163], v[224:227], v[68:71], 0
    buffer_load_dwordx4 v245, s[20:23], s53 offen offset:1088 lds
    v_exp_f32 v164, v164
    v_exp_f32 v165, v165
    v_exp_f32 v166, v166
    v_cvt_pk_bf16_f32 v188, v164, v165
    v_exp_f32 v167, v167
    v_exp_f32 v168, v168
    v_mfma_f32_32x32x16_bf16 v[148:163], v[228:231], v[72:75], v[148:163]
    buffer_load_dwordx4 v[40:43], v244, s[12:15], s55 offen offset:1024 sc1
    v_cvt_pk_bf16_f32 v189, v166, v167
    v_exp_f32 v169, v169
    v_exp_f32 v170, v170
    v_cvt_pk_bf16_f32 v190, v168, v169
    v_exp_f32 v171, v171
    v_exp_f32 v172, v172
    v_mfma_f32_32x32x16_bf16 v[84:99], v[232:235], v[180:183], v[84:99]
    v_cvt_pk_bf16_f32 v191, v170, v171
    v_exp_f32 v173, v173
    v_exp_f32 v174, v174
    v_cvt_pk_bf16_f32 v192, v172, v173
    v_exp_f32 v175, v175
    v_exp_f32 v176, v176
    v_mfma_f32_32x32x16_bf16 v[84:99], v[236:239], v[184:187], v[84:99]
    buffer_load_dwordx4 v[44:47], v244, s[12:15], s55 offen offset:2048 sc1
    v_cvt_pk_bf16_f32 v193, v174, v175
    v_exp_f32 v177, v177
    v_exp_f32 v178, v178
    v_exp_f32 v179, v179
    v_cvt_pk_bf16_f32 v194, v176, v177
    v_cvt_pk_bf16_f32 v195, v178, v179
    v_mfma_f32_32x32x16_bf16 v[164:179], v[224:227], v[76:79], 0
    v_exp_f32 v148, v148
    v_exp_f32 v149, v149
    v_exp_f32 v150, v150
    v_cvt_pk_bf16_f32 v180, v148, v149
    v_exp_f32 v151, v151
    v_exp_f32 v152, v152
    v_mfma_f32_32x32x16_bf16 v[164:179], v[228:231], v[80:83], v[164:179]
    buffer_load_dwordx4 v[48:51], v244, s[12:15], s55 offen offset:3072 sc1
    v_cvt_pk_bf16_f32 v181, v150, v151
    v_exp_f32 v153, v153
    v_exp_f32 v154, v154
    v_cvt_pk_bf16_f32 v182, v152, v153
    v_exp_f32 v155, v155
    v_exp_f32 v156, v156
    v_mfma_f32_32x32x16_bf16 v[100:115], v[232:235], v[188:191], v[100:115]
    buffer_load_dwordx4 a[200:203], v223, s[20:23], s53 offen offset:128
    v_cvt_pk_bf16_f32 v183, v154, v155
    v_exp_f32 v157, v157
    v_exp_f32 v158, v158
    v_cvt_pk_bf16_f32 v184, v156, v157
    v_exp_f32 v159, v159
    v_exp_f32 v160, v160
    v_mfma_f32_32x32x16_bf16 v[100:115], v[236:239], v[192:195], v[100:115]
    s_waitcnt vmcnt(15)
    v_cvt_pk_bf16_f32 v185, v158, v159
    v_exp_f32 v161, v161
    v_exp_f32 v162, v162
    v_exp_f32 v163, v163
    v_cvt_pk_bf16_f32 v186, v160, v161
    v_cvt_pk_bf16_f32 v187, v162, v163
    v_mfma_f32_32x32x16_bf16 v[148:163], v[4:7], v[52:55], 0
    s_add_u32 s55, s55, 0x4000
    v_exp_f32 v164, v164
    v_exp_f32 v165, v165
    v_exp_f32 v166, v166
    v_cvt_pk_bf16_f32 v188, v164, v165
    v_exp_f32 v167, v167
    v_exp_f32 v168, v168
    v_mfma_f32_32x32x16_bf16 v[148:163], v[8:11], v[56:59], v[148:163]
    s_and_b32 s55, s55, 0x3c000
    v_cvt_pk_bf16_f32 v189, v166, v167
    v_exp_f32 v169, v169
    v_exp_f32 v170, v170
    v_cvt_pk_bf16_f32 v190, v168, v169
    v_exp_f32 v171, v171
    v_exp_f32 v172, v172
    v_mfma_f32_32x32x16_bf16 v[116:131], v[232:235], v[180:183], v[116:131]
    s_add_u32 s1, s1, 114688
    v_cvt_pk_bf16_f32 v191, v170, v171
    v_exp_f32 v173, v173
    v_exp_f32 v174, v174
    v_cvt_pk_bf16_f32 v192, v172, v173
    v_exp_f32 v175, v175
    v_exp_f32 v176, v176
    v_mfma_f32_32x32x16_bf16 v[116:131], v[236:239], v[184:187], v[116:131]
    s_sub_u32 s53, s1, 1605632
    v_cvt_pk_bf16_f32 v193, v174, v175
    v_exp_f32 v177, v177
    v_exp_f32 v178, v178
    v_exp_f32 v179, v179
    v_cvt_pk_bf16_f32 v194, v176, v177
    v_cvt_pk_bf16_f32 v195, v178, v179
    v_mfma_f32_32x32x16_bf16 v[164:179], v[4:7], v[60:63], 0
    s_min_u32 s1, s1, s53
    v_exp_f32 v148, v148
    v_exp_f32 v149, v149
    v_exp_f32 v150, v150
    v_cvt_pk_bf16_f32 v180, v148, v149
    v_exp_f32 v151, v151
    v_exp_f32 v152, v152
    v_mfma_f32_32x32x16_bf16 v[164:179], v[8:11], v[64:67], v[164:179]
    s_add_u32 s53, s56, s1
    v_cvt_pk_bf16_f32 v181, v150, v151
    v_exp_f32 v153, v153
    v_exp_f32 v154, v154
    v_cvt_pk_bf16_f32 v182, v152, v153
    v_exp_f32 v155, v155
    v_exp_f32 v156, v156
    v_mfma_f32_32x32x16_bf16 v[132:147], v[232:235], v[188:191], v[132:147]
    s_add_u32 m0, s57, 4096
    v_cvt_pk_bf16_f32 v183, v154, v155
    v_exp_f32 v157, v157
    v_exp_f32 v158, v158
    v_cvt_pk_bf16_f32 v184, v156, v157
    v_exp_f32 v159, v159
    v_exp_f32 v160, v160
    v_mfma_f32_32x32x16_bf16 v[132:147], v[236:239], v[192:195], v[132:147]
    buffer_load_dwordx4 v[224:227], v244, s[12:15], s55 offen offset:0 sc1
    v_cvt_pk_bf16_f32 v185, v158, v159
    v_exp_f32 v161, v161
    v_exp_f32 v162, v162
    v_exp_f32 v163, v163
    v_cvt_pk_bf16_f32 v186, v160, v161
    v_cvt_pk_bf16_f32 v187, v162, v163
    v_mfma_f32_32x32x16_bf16 v[148:163], v[4:7], v[68:71], 0
    buffer_load_dwordx4 v213, s[20:23], s53 offen offset:0 lds
    v_exp_f32 v164, v164
    v_exp_f32 v165, v165
    v_exp_f32 v166, v166
    v_cvt_pk_bf16_f32 v188, v164, v165
    v_exp_f32 v167, v167
    v_exp_f32 v168, v168
    v_mfma_f32_32x32x16_bf16 v[148:163], v[8:11], v[72:75], v[148:163]
    buffer_load_dwordx4 v[228:231], v244, s[12:15], s55 offen offset:1024 sc1
    v_cvt_pk_bf16_f32 v189, v166, v167
    v_exp_f32 v169, v169
    v_exp_f32 v170, v170
    v_cvt_pk_bf16_f32 v190, v168, v169
    v_exp_f32 v171, v171
    v_exp_f32 v172, v172
    v_mfma_f32_32x32x16_bf16 v[84:99], v[12:15], v[180:183], v[84:99]
    buffer_load_dwordx4 v245, s[20:23], s53 offen offset:1024 lds
    v_cvt_pk_bf16_f32 v191, v170, v171
    v_exp_f32 v173, v173
    v_exp_f32 v174, v174
    v_cvt_pk_bf16_f32 v192, v172, v173
    v_exp_f32 v175, v175
    v_exp_f32 v176, v176
    v_mfma_f32_32x32x16_bf16 v[84:99], v[16:19], v[184:187], v[84:99]
    buffer_load_dwordx4 v[232:235], v244, s[12:15], s55 offen offset:2048 sc1
    v_cvt_pk_bf16_f32 v193, v174, v175
    v_exp_f32 v177, v177
    v_exp_f32 v178, v178
    v_exp_f32 v179, v179
    v_cvt_pk_bf16_f32 v194, v176, v177
    v_cvt_pk_bf16_f32 v195, v178, v179
    v_mfma_f32_32x32x16_bf16 v[164:179], v[4:7], v[76:79], 0
    s_add_u32 m0, s57, 61376
    v_exp_f32 v148, v148
    v_exp_f32 v149, v149
    v_exp_f32 v150, v150
    v_cvt_pk_bf16_f32 v180, v148, v149
    v_exp_f32 v151, v151
    v_exp_f32 v152, v152
    v_mfma_f32_32x32x16_bf16 v[164:179], v[8:11], v[80:83], v[164:179]
    buffer_load_dwordx4 v[236:239], v244, s[12:15], s55 offen offset:3072 sc1
    v_cvt_pk_bf16_f32 v181, v150, v151
    v_exp_f32 v153, v153
    v_exp_f32 v154, v154
    v_cvt_pk_bf16_f32 v182, v152, v153
    v_exp_f32 v155, v155
    v_exp_f32 v156, v156
    v_mfma_f32_32x32x16_bf16 v[100:115], v[12:15], v[188:191], v[100:115]
    buffer_load_dwordx4 v213, s[20:23], s53 offen offset:64 lds
    v_cvt_pk_bf16_f32 v183, v154, v155
    v_exp_f32 v157, v157
    v_exp_f32 v158, v158
    v_cvt_pk_bf16_f32 v184, v156, v157
    v_exp_f32 v159, v159
    v_exp_f32 v160, v160
    v_mfma_f32_32x32x16_bf16 v[100:115], v[16:19], v[192:195], v[100:115]
    s_waitcnt vmcnt(16)
    v_cvt_pk_bf16_f32 v185, v158, v159
    v_exp_f32 v161, v161
    v_exp_f32 v162, v162
    v_exp_f32 v163, v163
    v_cvt_pk_bf16_f32 v186, v160, v161
    v_cvt_pk_bf16_f32 v187, v162, v163
    v_mfma_f32_32x32x16_bf16 v[148:163], v[20:23], v[52:55], 0
    s_add_u32 s55, s55, 0x4000
    v_exp_f32 v164, v164
    v_exp_f32 v165, v165
    v_exp_f32 v166, v166
    v_cvt_pk_bf16_f32 v188, v164, v165
    v_exp_f32 v167, v167
    v_exp_f32 v168, v168
    v_mfma_f32_32x32x16_bf16 v[148:163], v[24:27], v[56:59], v[148:163]
    s_and_b32 s55, s55, 0x3c000
    v_cvt_pk_bf16_f32 v189, v166, v167
    v_exp_f32 v169, v169
    v_exp_f32 v170, v170
    v_cvt_pk_bf16_f32 v190, v168, v169
    v_exp_f32 v171, v171
    v_exp_f32 v172, v172
    v_mfma_f32_32x32x16_bf16 v[116:131], v[12:15], v[180:183], v[116:131]
    buffer_load_dwordx4 v245, s[20:23], s53 offen offset:1088 lds
    v_cvt_pk_bf16_f32 v191, v170, v171
    v_exp_f32 v173, v173
    v_exp_f32 v174, v174
    v_cvt_pk_bf16_f32 v192, v172, v173
    v_exp_f32 v175, v175
    v_exp_f32 v176, v176
    v_mfma_f32_32x32x16_bf16 v[116:131], v[16:19], v[184:187], v[116:131]
    v_cvt_pk_bf16_f32 v193, v174, v175
    v_exp_f32 v177, v177
    v_exp_f32 v178, v178
    v_exp_f32 v179, v179
    v_cvt_pk_bf16_f32 v194, v176, v177
    v_cvt_pk_bf16_f32 v195, v178, v179
    v_mfma_f32_32x32x16_bf16 v[164:179], v[20:23], v[60:63], 0
    v_exp_f32 v148, v148
    v_exp_f32 v149, v149
    v_exp_f32 v150, v150
    v_cvt_pk_bf16_f32 v180, v148, v149
    v_exp_f32 v151, v151
    v_exp_f32 v152, v152
    v_mfma_f32_32x32x16_bf16 v[164:179], v[24:27], v[64:67], v[164:179]
    v_cvt_pk_bf16_f32 v181, v150, v151
    v_exp_f32 v153, v153
    v_exp_f32 v154, v154
    v_cvt_pk_bf16_f32 v182, v152, v153
    v_exp_f32 v155, v155
    v_exp_f32 v156, v156
    v_mfma_f32_32x32x16_bf16 v[132:147], v[12:15], v[188:191], v[132:147]
    buffer_load_dwordx4 a[204:207], v223, s[20:23], s53 offen offset:128
    v_cvt_pk_bf16_f32 v183, v154, v155
    v_exp_f32 v157, v157
    v_exp_f32 v158, v158
    v_cvt_pk_bf16_f32 v184, v156, v157
    v_exp_f32 v159, v159
    v_exp_f32 v160, v160
    v_mfma_f32_32x32x16_bf16 v[132:147], v[16:19], v[192:195], v[132:147]
    buffer_load_dwordx4 v[4:7], v244, s[12:15], s55 offen offset:0 sc1
    v_cvt_pk_bf16_f32 v185, v158, v159
    v_exp_f32 v161, v161
    v_exp_f32 v162, v162
    v_exp_f32 v163, v163
    v_cvt_pk_bf16_f32 v186, v160, v161
    v_cvt_pk_bf16_f32 v187, v162, v163
    v_mfma_f32_32x32x16_bf16 v[148:163], v[20:23], v[68:71], 0
    s_add_u32 s1, s1, 114688
    v_exp_f32 v164, v164
    v_exp_f32 v165, v165
    v_exp_f32 v166, v166
    v_cvt_pk_bf16_f32 v188, v164, v165
    v_exp_f32 v167, v167
    v_exp_f32 v168, v168
    v_mfma_f32_32x32x16_bf16 v[148:163], v[24:27], v[72:75], v[148:163]
    buffer_load_dwordx4 v[8:11], v244, s[12:15], s55 offen offset:1024 sc1
    v_cvt_pk_bf16_f32 v189, v166, v167
    v_exp_f32 v169, v169
    v_exp_f32 v170, v170
    v_cvt_pk_bf16_f32 v190, v168, v169
    v_exp_f32 v171, v171
Lpage5:
    s_cbranch_execz Lvis1
    v_exp_f32 v172, v172
    v_mfma_f32_32x32x16_bf16 v[84:99], v[28:31], v[180:183], v[84:99]
    s_sub_u32 s53, s1, 1605632
    v_cvt_pk_bf16_f32 v191, v170, v171
    v_exp_f32 v173, v173
    v_exp_f32 v174, v174
    v_cvt_pk_bf16_f32 v192, v172, v173
    v_exp_f32 v175, v175
    v_exp_f32 v176, v176
    v_mfma_f32_32x32x16_bf16 v[84:99], v[32:35], v[184:187], v[84:99]
    buffer_load_dwordx4 v[12:15], v244, s[12:15], s55 offen offset:2048 sc1
    v_cvt_pk_bf16_f32 v193, v174, v175
    v_exp_f32 v177, v177
    v_exp_f32 v178, v178
    v_exp_f32 v179, v179
    v_cvt_pk_bf16_f32 v194, v176, v177
    v_cvt_pk_bf16_f32 v195, v178, v179
    v_mfma_f32_32x32x16_bf16 v[164:179], v[20:23], v[76:79], 0
    s_min_u32 s1, s1, s53
    v_exp_f32 v148, v148
    v_exp_f32 v149, v149
    v_exp_f32 v150, v150
    v_cvt_pk_bf16_f32 v180, v148, v149
    v_exp_f32 v151, v151
    v_exp_f32 v152, v152
    v_mfma_f32_32x32x16_bf16 v[164:179], v[24:27], v[80:83], v[164:179]
    buffer_load_dwordx4 v[16:19], v244, s[12:15], s55 offen offset:3072 sc1
    v_cvt_pk_bf16_f32 v181, v150, v151
    v_exp_f32 v153, v153
    v_exp_f32 v154, v154
    v_cvt_pk_bf16_f32 v182, v152, v153
    v_exp_f32 v155, v155
    v_exp_f32 v156, v156
    v_mfma_f32_32x32x16_bf16 v[100:115], v[28:31], v[188:191], v[100:115]
    s_add_u32 s53, s56, s1
    v_cvt_pk_bf16_f32 v183, v154, v155
    v_exp_f32 v157, v157
    v_exp_f32 v158, v158
    v_cvt_pk_bf16_f32 v184, v156, v157
    v_exp_f32 v159, v159
    v_exp_f32 v160, v160
    v_mfma_f32_32x32x16_bf16 v[100:115], v[32:35], v[192:195], v[100:115]
    s_waitcnt vmcnt(14)
    v_cvt_pk_bf16_f32 v185, v158, v159
    v_exp_f32 v161, v161
    v_exp_f32 v162, v162
    v_exp_f32 v163, v163
    v_cvt_pk_bf16_f32 v186, v160, v161
    v_cvt_pk_bf16_f32 v187, v162, v163
    v_mfma_f32_32x32x16_bf16 v[148:163], v[36:39], v[52:55], 0
    s_add_u32 s55, s55, 0x4000
    v_exp_f32 v164, v164
    v_exp_f32 v165, v165
    v_exp_f32 v166, v166
    v_cvt_pk_bf16_f32 v188, v164, v165
    v_exp_f32 v167, v167
    v_exp_f32 v168, v168
    v_mfma_f32_32x32x16_bf16 v[148:163], v[40:43], v[56:59], v[148:163]
    s_and_b32 s55, s55, 0x3c000
    v_cvt_pk_bf16_f32 v189, v166, v167
    v_exp_f32 v169, v169
    v_exp_f32 v170, v170
    v_cvt_pk_bf16_f32 v190, v168, v169
    v_exp_f32 v171, v171
    v_exp_f32 v172, v172
    v_mfma_f32_32x32x16_bf16 v[116:131], v[28:31], v[180:183], v[116:131]
    s_add_u32 m0, s57, 6144
    v_cvt_pk_bf16_f32 v191, v170, v171
    v_exp_f32 v173, v173
    v_exp_f32 v174, v174
    v_cvt_pk_bf16_f32 v192, v172, v173
    v_exp_f32 v175, v175
    v_exp_f32 v176, v176
    v_mfma_f32_32x32x16_bf16 v[116:131], v[32:35], v[184:187], v[116:131]
    buffer_load_dwordx4 v213, s[20:23], s53 offen offset:0 lds
    v_cvt_pk_bf16_f32 v193, v174, v175
    v_exp_f32 v177, v177
    v_exp_f32 v178, v178
    v_exp_f32 v179, v179
    v_cvt_pk_bf16_f32 v194, v176, v177
    v_cvt_pk_bf16_f32 v195, v178, v179
    v_mfma_f32_32x32x16_bf16 v[164:179], v[36:39], v[60:63], 0
    buffer_load_dwordx4 v245, s[20:23], s53 offen offset:1024 lds
    v_exp_f32 v148, v148
    v_exp_f32 v149, v149
    v_exp_f32 v150, v150
    v_cvt_pk_bf16_f32 v180, v148, v149
    v_exp_f32 v151, v151
    v_exp_f32 v152, v152
    v_mfma_f32_32x32x16_bf16 v[164:179], v[40:43], v[64:67], v[164:179]
    s_add_u32 m0, s57, 63424
    v_cvt_pk_bf16_f32 v181, v150, v151
    v_exp_f32 v153, v153
    v_exp_f32 v154, v154
    v_cvt_pk_bf16_f32 v182, v152, v153
    v_exp_f32 v155, v155
    v_exp_f32 v156, v156
    v_mfma_f32_32x32x16_bf16 v[132:147], v[28:31], v[188:191], v[132:147]
    buffer_load_dwordx4 v213, s[20:23], s53 offen offset:64 lds
    v_cvt_pk_bf16_f32 v183, v154, v155
    v_exp_f32 v157, v157
    v_exp_f32 v158, v158
    v_cvt_pk_bf16_f32 v184, v156, v157
    v_exp_f32 v159, v159
    v_exp_f32 v160, v160
    v_mfma_f32_32x32x16_bf16 v[132:147], v[32:35], v[192:195], v[132:147]
    buffer_load_dwordx4 v[20:23], v244, s[12:15], s55 offen offset:0 sc1
    v_cvt_pk_bf16_f32 v185, v158, v159
    v_exp_f32 v161, v161
    v_exp_f32 v162, v162
    v_exp_f32 v163, v163
    v_cvt_pk_bf16_f32 v186, v160, v161
    v_cvt_pk_bf16_f32 v187, v162, v163
    v_mfma_f32_32x32x16_bf16 v[148:163], v[36:39], v[68:71], 0
    v_exp_f32 v164, v164
    v_exp_f32 v165, v165
    v_exp_f32 v166, v166
    v_cvt_pk_bf16_f32 v188, v164, v165
    v_exp_f32 v167, v167
    v_exp_f32 v168, v168
    v_mfma_f32_32x32x16_bf16 v[148:163], v[40:43], v[72:75], v[148:163]
    buffer_load_dwordx4 v[24:27], v244, s[12:15], s55 offen offset:1024 sc1
    v_cvt_pk_bf16_f32 v189, v166, v167
    v_exp_f32 v169, v169
    v_exp_f32 v170, v170
    v_cvt_pk_bf16_f32 v190, v168, v169
    v_exp_f32 v171, v171
    v_exp_f32 v172, v172
    v_mfma_f32_32x32x16_bf16 v[84:99], v[44:47], v[180:183], v[84:99]
    buffer_load_dwordx4 v245, s[20:23], s53 offen offset:1088 lds
    v_cvt_pk_bf16_f32 v191, v170, v171
    v_exp_f32 v173, v173
    v_exp_f32 v174, v174
    v_cvt_pk_bf16_f32 v192, v172, v173
    v_exp_f32 v175, v175
    v_exp_f32 v176, v176
    v_mfma_f32_32x32x16_bf16 v[84:99], v[48:51], v[184:187], v[84:99]
    buffer_load_dwordx4 v[28:31], v244, s[12:15], s55 offen offset:2048 sc1
    v_cvt_pk_bf16_f32 v193, v174, v175
    v_exp_f32 v177, v177
    v_exp_f32 v178, v178
    v_exp_f32 v179, v179
    v_cvt_pk_bf16_f32 v194, v176, v177
    v_cvt_pk_bf16_f32 v195, v178, v179
    v_mfma_f32_32x32x16_bf16 v[164:179], v[36:39], v[76:79], 0
    v_exp_f32 v148, v148
    v_exp_f32 v149, v149
    v_exp_f32 v150, v150
    v_cvt_pk_bf16_f32 v180, v148, v149
    v_exp_f32 v151, v151
    v_exp_f32 v152, v152
    v_mfma_f32_32x32x16_bf16 v[164:179], v[40:43], v[80:83], v[164:179]
    buffer_load_dwordx4 v[32:35], v244, s[12:15], s55 offen offset:3072 sc1
    v_cvt_pk_bf16_f32 v181, v150, v151
    v_exp_f32 v153, v153
    v_exp_f32 v154, v154
    v_cvt_pk_bf16_f32 v182, v152, v153
    v_exp_f32 v155, v155
    v_exp_f32 v156, v156
    v_mfma_f32_32x32x16_bf16 v[100:115], v[44:47], v[188:191], v[100:115]
    v_cvt_pk_bf16_f32 v183, v154, v155
    v_exp_f32 v157, v157
    v_exp_f32 v158, v158
    v_cvt_pk_bf16_f32 v184, v156, v157
    v_exp_f32 v159, v159
    v_exp_f32 v160, v160
    v_mfma_f32_32x32x16_bf16 v[100:115], v[48:51], v[192:195], v[100:115]
    s_waitcnt vmcnt(15)
    v_cvt_pk_bf16_f32 v185, v158, v159
    v_exp_f32 v161, v161
    v_exp_f32 v162, v162
    v_exp_f32 v163, v163
    v_cvt_pk_bf16_f32 v186, v160, v161
    v_cvt_pk_bf16_f32 v187, v162, v163
    v_mfma_f32_32x32x16_bf16 v[148:163], v[224:227], v[52:55], 0
    s_add_u32 s55, s55, 0x4000
    v_exp_f32 v164, v164
    v_exp_f32 v165, v165
    v_exp_f32 v166, v166
    v_cvt_pk_bf16_f32 v188, v164, v165
    v_exp_f32 v167, v167
    v_exp_f32 v168, v168
    v_mfma_f32_32x32x16_bf16 v[148:163], v[228:231], v[56:59], v[148:163]
    s_and_b32 s55, s55, 0x3c000
    v_cvt_pk_bf16_f32 v189, v166, v167
    v_exp_f32 v169, v169
    v_exp_f32 v170, v170
    v_cvt_pk_bf16_f32 v190, v168, v169
    v_exp_f32 v171, v171
    v_exp_f32 v172, v172
    v_mfma_f32_32x32x16_bf16 v[116:131], v[44:47], v[180:183], v[116:131]
    buffer_load_dwordx4 a[208:211], v223, s[20:23], s53 offen offset:128
    v_cvt_pk_bf16_f32 v191, v170, v171
    v_exp_f32 v173, v173
    v_exp_f32 v174, v174
    v_cvt_pk_bf16_f32 v192, v172, v173
    v_exp_f32 v175, v175
    v_exp_f32 v176, v176
    v_mfma_f32_32x32x16_bf16 v[116:131], v[48:51], v[184:187], v[116:131]
    s_add_u32 s1, s1, 114688
    v_cvt_pk_bf16_f32 v193, v174, v175
    v_exp_f32 v177, v177
    v_exp_f32 v178, v178
    v_exp_f32 v179, v179
    v_cvt_pk_bf16_f32 v194, v176, v177
    v_cvt_pk_bf16_f32 v195, v178, v179
    v_mfma_f32_32x32x16_bf16 v[164:179], v[224:227], v[60:63], 0
    s_sub_u32 s53, s1, 1605632
    v_exp_f32 v148, v148
    v_exp_f32 v149, v149
    v_exp_f32 v150, v150
    v_cvt_pk_bf16_f32 v180, v148, v149
    v_exp_f32 v151, v151
    v_exp_f32 v152, v152
    v_mfma_f32_32x32x16_bf16 v[164:179], v[228:231], v[64:67], v[164:179]
    s_min_u32 s1, s1, s53
    v_cvt_pk_bf16_f32 v181, v150, v151
    v_exp_f32 v153, v153
    v_exp_f32 v154, v154
    v_cvt_pk_bf16_f32 v182, v152, v153
    v_exp_f32 v155, v155
    v_exp_f32 v156, v156
    v_mfma_f32_32x32x16_bf16 v[132:147], v[44:47], v[188:191], v[132:147]
    s_add_u32 s53, s56, s1
    v_cvt_pk_bf16_f32 v183, v154, v155
    v_exp_f32 v157, v157
    v_exp_f32 v158, v158
    v_cvt_pk_bf16_f32 v184, v156, v157
    v_exp_f32 v159, v159
    v_exp_f32 v160, v160
    v_mfma_f32_32x32x16_bf16 v[132:147], v[48:51], v[192:195], v[132:147]
    buffer_load_dwordx4 v[36:39], v244, s[12:15], s55 offen offset:0 sc1
    v_cvt_pk_bf16_f32 v185, v158, v159
    v_exp_f32 v161, v161
    v_exp_f32 v162, v162
    v_exp_f32 v163, v163
    v_cvt_pk_bf16_f32 v186, v160, v161
    v_cvt_pk_bf16_f32 v187, v162, v163
    v_mfma_f32_32x32x16_bf16 v[148:163], v[224:227], v[68:71], 0
    s_add_u32 m0, s57, 8192
    v_exp_f32 v164, v164
    v_exp_f32 v165, v165
    v_exp_f32 v166, v166
    v_cvt_pk_bf16_f32 v188, v164, v165
    v_exp_f32 v167, v167
    v_exp_f32 v168, v168
    v_mfma_f32_32x32x16_bf16 v[148:163], v[228:231], v[72:75], v[148:163]
    buffer_load_dwordx4 v[40:43], v244, s[12:15], s55 offen offset:1024 sc1
    v_cvt_pk_bf16_f32 v189, v166, v167
    v_exp_f32 v169, v169
    v_exp_f32 v170, v170
    v_cvt_pk_bf16_f32 v190, v168, v169
    v_exp_f32 v171, v171
    v_exp_f32 v172, v172
    v_mfma_f32_32x32x16_bf16 v[84:99], v[232:235], v[180:183], v[84:99]
    buffer_load_dwordx4 v213, s[20:23], s53 offen offset:0 lds
    v_cvt_pk_bf16_f32 v191, v170, v171
    v_exp_f32 v173, v173
    v_exp_f32 v174, v174
    v_cvt_pk_bf16_f32 v192, v172, v173
    v_exp_f32 v175, v175
    v_exp_f32 v176, v176
    v_mfma_f32_32x32x16_bf16 v[84:99], v[236:239], v[184:187], v[84:99]
    buffer_load_dwordx4 v[44:47], v244, s[12:15], s55 offen offset:2048 sc1
    v_cvt_pk_bf16_f32 v193, v174, v175
    v_exp_f32 v177, v177
    v_exp_f32 v178, v178
    v_exp_f32 v179, v179
    v_cvt_pk_bf16_f32 v194, v176, v177
    v_cvt_pk_bf16_f32 v195, v178, v179
    v_mfma_f32_32x32x16_bf16 v[164:179], v[224:227], v[76:79], 0
    buffer_load_dwordx4 v245, s[20:23], s53 offen offset:1024 lds
    v_exp_f32 v148, v148
    v_exp_f32 v149, v149
    v_exp_f32 v150, v150
    v_cvt_pk_bf16_f32 v180, v148, v149
    v_exp_f32 v151, v151
    v_exp_f32 v152, v152
    v_mfma_f32_32x32x16_bf16 v[164:179], v[228:231], v[80:83], v[164:179]
    buffer_load_dwordx4 v[48:51], v244, s[12:15], s55 offen offset:3072 sc1
    v_cvt_pk_bf16_f32 v181, v150, v151
    v_exp_f32 v153, v153
    v_exp_f32 v154, v154
    v_cvt_pk_bf16_f32 v182, v152, v153
    v_exp_f32 v155, v155
    v_exp_f32 v156, v156
    v_mfma_f32_32x32x16_bf16 v[100:115], v[232:235], v[188:191], v[100:115]
    s_add_u32 m0, s57, 65472
    v_cvt_pk_bf16_f32 v183, v154, v155
    v_exp_f32 v157, v157
    v_exp_f32 v158, v158
    v_cvt_pk_bf16_f32 v184, v156, v157
    v_exp_f32 v159, v159
    v_exp_f32 v160, v160
    v_mfma_f32_32x32x16_bf16 v[100:115], v[236:239], v[192:195], v[100:115]
    s_waitcnt vmcnt(15)
    v_cvt_pk_bf16_f32 v185, v158, v159
    v_exp_f32 v161, v161
    v_exp_f32 v162, v162
    v_exp_f32 v163, v163
    v_cvt_pk_bf16_f32 v186, v160, v161
    v_cvt_pk_bf16_f32 v187, v162, v163
    v_mfma_f32_32x32x16_bf16 v[148:163], v[4:7], v[52:55], 0
    s_add_u32 s55, s55, 0x4000
    v_exp_f32 v164, v164
    v_exp_f32 v165, v165
    v_exp_f32 v166, v166
    v_cvt_pk_bf16_f32 v188, v164, v165
    v_exp_f32 v167, v167
    v_exp_f32 v168, v168
    v_mfma_f32_32x32x16_bf16 v[148:163], v[8:11], v[56:59], v[148:163]
    s_and_b32 s55, s55, 0x3c000
    v_cvt_pk_bf16_f32 v189, v166, v167
    v_exp_f32 v169, v169
    v_exp_f32 v170, v170
    v_cvt_pk_bf16_f32 v190, v168, v169
    v_exp_f32 v171, v171
    v_exp_f32 v172, v172
    v_mfma_f32_32x32x16_bf16 v[116:131], v[232:235], v[180:183], v[116:131]
    buffer_load_dwordx4 v213, s[20:23], s53 offen offset:64 lds
    v_cvt_pk_bf16_f32 v191, v170, v171
    v_exp_f32 v173, v173
    v_exp_f32 v174, v174
    v_cvt_pk_bf16_f32 v192, v172, v173
    v_exp_f32 v175, v175
    v_exp_f32 v176, v176
    v_mfma_f32_32x32x16_bf16 v[116:131], v[236:239], v[184:187], v[116:131]
    buffer_load_dwordx4 v245, s[20:23], s53 offen offset:1088 lds
    v_cvt_pk_bf16_f32 v193, v174, v175
    v_exp_f32 v177, v177
    v_exp_f32 v178, v178
    v_exp_f32 v179, v179
    v_cvt_pk_bf16_f32 v194, v176, v177
    v_cvt_pk_bf16_f32 v195, v178, v179
    v_mfma_f32_32x32x16_bf16 v[164:179], v[4:7], v[60:63], 0
    v_exp_f32 v148, v148
    v_exp_f32 v149, v149
    v_exp_f32 v150, v150
    v_cvt_pk_bf16_f32 v180, v148, v149
    v_exp_f32 v151, v151
    v_exp_f32 v152, v152
    v_mfma_f32_32x32x16_bf16 v[164:179], v[8:11], v[64:67], v[164:179]
    v_cvt_pk_bf16_f32 v181, v150, v151
    v_exp_f32 v153, v153
    v_exp_f32 v154, v154
    v_cvt_pk_bf16_f32 v182, v152, v153
    v_exp_f32 v155, v155
    v_exp_f32 v156, v156
    v_mfma_f32_32x32x16_bf16 v[132:147], v[232:235], v[188:191], v[132:147]
    v_cvt_pk_bf16_f32 v183, v154, v155
    v_exp_f32 v157, v157
    v_exp_f32 v158, v158
    v_cvt_pk_bf16_f32 v184, v156, v157
    v_exp_f32 v159, v159
    v_exp_f32 v160, v160
    v_mfma_f32_32x32x16_bf16 v[132:147], v[236:239], v[192:195], v[132:147]
    buffer_load_dwordx4 v[224:227], v244, s[12:15], s55 offen offset:0 sc1
    v_cvt_pk_bf16_f32 v185, v158, v159
    v_exp_f32 v161, v161
    v_exp_f32 v162, v162
    v_exp_f32 v163, v163
    v_cvt_pk_bf16_f32 v186, v160, v161
    v_cvt_pk_bf16_f32 v187, v162, v163
    v_mfma_f32_32x32x16_bf16 v[148:163], v[4:7], v[68:71], 0
    buffer_load_dwordx4 a[212:215], v223, s[20:23], s53 offen offset:128
    v_exp_f32 v164, v164
    v_exp_f32 v165, v165
    v_exp_f32 v166, v166
    v_cvt_pk_bf16_f32 v188, v164, v165
    v_exp_f32 v167, v167
    v_exp_f32 v168, v168
    v_mfma_f32_32x32x16_bf16 v[148:163], v[8:11], v[72:75], v[148:163]
    buffer_load_dwordx4 v[228:231], v244, s[12:15], s55 offen offset:1024 sc1
    v_cvt_pk_bf16_f32 v189, v166, v167
    v_exp_f32 v169, v169
    v_exp_f32 v170, v170
    v_cvt_pk_bf16_f32 v190, v168, v169
    v_exp_f32 v171, v171
    v_exp_f32 v172, v172
    v_mfma_f32_32x32x16_bf16 v[84:99], v[12:15], v[180:183], v[84:99]
    s_add_u32 s1, s1, 114688
    v_cvt_pk_bf16_f32 v191, v170, v171
    v_exp_f32 v173, v173
    v_exp_f32 v174, v174
    v_cvt_pk_bf16_f32 v192, v172, v173
    v_exp_f32 v175, v175
    v_exp_f32 v176, v176
    v_mfma_f32_32x32x16_bf16 v[84:99], v[16:19], v[184:187], v[84:99]
    buffer_load_dwordx4 v[232:235], v244, s[12:15], s55 offen offset:2048 sc1
    v_cvt_pk_bf16_f32 v193, v174, v175
    v_exp_f32 v177, v177
    v_exp_f32 v178, v178
    v_exp_f32 v179, v179
    v_cvt_pk_bf16_f32 v194, v176, v177
    v_cvt_pk_bf16_f32 v195, v178, v179
    v_mfma_f32_32x32x16_bf16 v[164:179], v[4:7], v[76:79], 0
    s_sub_u32 s53, s1, 1605632
    v_exp_f32 v148, v148
    v_exp_f32 v149, v149
    v_exp_f32 v150, v150
    v_cvt_pk_bf16_f32 v180, v148, v149
    v_exp_f32 v151, v151
    v_exp_f32 v152, v152
    v_mfma_f32_32x32x16_bf16 v[164:179], v[8:11], v[80:83], v[164:179]
    buffer_load_dwordx4 v[236:239], v244, s[12:15], s55 offen offset:3072 sc1
    v_cvt_pk_bf16_f32 v181, v150, v151
    v_exp_f32 v153, v153
    v_exp_f32 v154, v154
    v_cvt_pk_bf16_f32 v182, v152, v153
    v_exp_f32 v155, v155
    v_exp_f32 v156, v156
    v_mfma_f32_32x32x16_bf16 v[100:115], v[12:15], v[188:191], v[100:115]
    s_min_u32 s1, s1, s53
    v_cvt_pk_bf16_f32 v183, v154, v155
    v_exp_f32 v157, v157
    v_exp_f32 v158, v158
    v_cvt_pk_bf16_f32 v184, v156, v157
    v_exp_f32 v159, v159
    v_exp_f32 v160, v160
    v_mfma_f32_32x32x16_bf16 v[100:115], v[16:19], v[192:195], v[100:115]
    s_waitcnt vmcnt(14)
    v_cvt_pk_bf16_f32 v185, v158, v159
    v_exp_f32 v161, v161
    v_exp_f32 v162, v162
    v_exp_f32 v163, v163
    v_cvt_pk_bf16_f32 v186, v160, v161
    v_cvt_pk_bf16_f32 v187, v162, v163
    v_mfma_f32_32x32x16_bf16 v[148:163], v[20:23], v[52:55], 0
    s_add_u32 s55, s55, 0x4000
    v_exp_f32 v164, v164
    v_exp_f32 v165, v165
    v_exp_f32 v166, v166
    v_cvt_pk_bf16_f32 v188, v164, v165
    v_exp_f32 v167, v167
    v_exp_f32 v168, v168
    v_mfma_f32_32x32x16_bf16 v[148:163], v[24:27], v[56:59], v[148:163]
    s_and_b32 s55, s55, 0x3c000
    v_cvt_pk_bf16_f32 v189, v166, v167
    v_exp_f32 v169, v169
    v_exp_f32 v170, v170
    v_cvt_pk_bf16_f32 v190, v168, v169
    v_exp_f32 v171, v171
    v_exp_f32 v172, v172
    v_mfma_f32_32x32x16_bf16 v[116:131], v[12:15], v[180:183], v[116:131]
    s_add_u32 s53, s56, s1
    v_cvt_pk_bf16_f32 v191, v170, v171
    v_exp_f32 v173, v173
    v_exp_f32 v174, v174
    v_cvt_pk_bf16_f32 v192, v172, v173
    v_exp_f32 v175, v175
    v_exp_f32 v176, v176
    v_mfma_f32_32x32x16_bf16 v[116:131], v[16:19], v[184:187], v[116:131]
    s_add_u32 m0, s57, 10240
    v_cvt_pk_bf16_f32 v193, v174, v175
    v_exp_f32 v177, v177
    v_exp_f32 v178, v178
    v_exp_f32 v179, v179
    v_cvt_pk_bf16_f32 v194, v176, v177
    v_cvt_pk_bf16_f32 v195, v178, v179
    v_mfma_f32_32x32x16_bf16 v[164:179], v[20:23], v[60:63], 0
    buffer_load_dwordx4 v213, s[20:23], s53 offen offset:0 lds
    v_exp_f32 v148, v148
    v_exp_f32 v149, v149
    v_exp_f32 v150, v150
    v_cvt_pk_bf16_f32 v180, v148, v149
    v_exp_f32 v151, v151
    v_exp_f32 v152, v152
    v_mfma_f32_32x32x16_bf16 v[164:179], v[24:27], v[64:67], v[164:179]
    buffer_load_dwordx4 v245, s[20:23], s53 offen offset:1024 lds
    v_cvt_pk_bf16_f32 v181, v150, v151
    v_exp_f32 v153, v153
    v_exp_f32 v154, v154
    v_cvt_pk_bf16_f32 v182, v152, v153
    v_exp_f32 v155, v155
    v_exp_f32 v156, v156
    v_mfma_f32_32x32x16_bf16 v[132:147], v[12:15], v[188:191], v[132:147]
    s_add_u32 m0, s57, 67520
    v_cvt_pk_bf16_f32 v183, v154, v155
    v_exp_f32 v157, v157
    v_exp_f32 v158, v158
    v_cvt_pk_bf16_f32 v184, v156, v157
    v_exp_f32 v159, v159
    v_exp_f32 v160, v160
    v_mfma_f32_32x32x16_bf16 v[132:147], v[16:19], v[192:195], v[132:147]
    buffer_load_dwordx4 v213, s[20:23], s53 offen offset:64 lds
    v_cvt_pk_bf16_f32 v185, v158, v159
    v_exp_f32 v161, v161
    v_exp_f32 v162, v162
    v_exp_f32 v163, v163
    v_cvt_pk_bf16_f32 v186, v160, v161
    v_cvt_pk_bf16_f32 v187, v162, v163
    v_mfma_f32_32x32x16_bf16 v[148:163], v[20:23], v[68:71], 0
    s_mul_i32 s54, s25, 896
    s_add_u32 s54, s54, 17629184
    s_mov_b64 exec, 0x7f
    buffer_load_dword v218, v3, s[12:15], s54 offen sc1
    s_mov_b64 exec, -1
    v_exp_f32 v164, v164
    v_exp_f32 v165, v165
    v_exp_f32 v166, v166
    v_cvt_pk_bf16_f32 v188, v164, v165
    v_exp_f32 v167, v167
    v_exp_f32 v168, v168
    v_mfma_f32_32x32x16_bf16 v[148:163], v[24:27], v[72:75], v[148:163]
    v_cvt_pk_bf16_f32 v189, v166, v167
    v_exp_f32 v169, v169
    v_exp_f32 v170, v170
    v_cvt_pk_bf16_f32 v190, v168, v169
    v_exp_f32 v171, v171
    v_exp_f32 v172, v172
    v_mfma_f32_32x32x16_bf16 v[84:99], v[28:31], v[180:183], v[84:99]
    v_cvt_pk_bf16_f32 v191, v170, v171
    v_exp_f32 v173, v173
    v_exp_f32 v174, v174
    v_cvt_pk_bf16_f32 v192, v172, v173
    v_exp_f32 v175, v175
    v_exp_f32 v176, v176
    v_mfma_f32_32x32x16_bf16 v[84:99], v[32:35], v[184:187], v[84:99]
    v_cvt_pk_bf16_f32 v193, v174, v175
    v_exp_f32 v177, v177
    v_exp_f32 v178, v178
    v_exp_f32 v179, v179
    v_cvt_pk_bf16_f32 v194, v176, v177
    v_cvt_pk_bf16_f32 v195, v178, v179
    v_mfma_f32_32x32x16_bf16 v[164:179], v[20:23], v[76:79], 0
    buffer_load_dwordx4 v245, s[20:23], s53 offen offset:1088 lds
    v_exp_f32 v148, v148
    v_exp_f32 v149, v149
    v_exp_f32 v150, v150
    v_cvt_pk_bf16_f32 v180, v148, v149
    v_exp_f32 v151, v151
    v_exp_f32 v152, v152
    v_mfma_f32_32x32x16_bf16 v[164:179], v[24:27], v[80:83], v[164:179]
    v_cvt_pk_bf16_f32 v181, v150, v151
    v_exp_f32 v153, v153
    v_exp_f32 v154, v154
    v_cvt_pk_bf16_f32 v182, v152, v153
    v_exp_f32 v155, v155
    v_exp_f32 v156, v156
    v_mfma_f32_32x32x16_bf16 v[100:115], v[28:31], v[188:191], v[100:115]
    v_cvt_pk_bf16_f32 v183, v154, v155
    v_exp_f32 v157, v157
    v_exp_f32 v158, v158
    v_cvt_pk_bf16_f32 v184, v156, v157
    v_exp_f32 v159, v159
    v_exp_f32 v160, v160
    v_mfma_f32_32x32x16_bf16 v[100:115], v[32:35], v[192:195], v[100:115]
    s_waitcnt vmcnt(12)
    v_cvt_pk_bf16_f32 v185, v158, v159
    v_exp_f32 v161, v161
    v_exp_f32 v162, v162
    v_exp_f32 v163, v163
    v_cvt_pk_bf16_f32 v186, v160, v161
    v_cvt_pk_bf16_f32 v187, v162, v163
    v_mfma_f32_32x32x16_bf16 v[148:163], v[36:39], v[52:55], 0
    v_exp_f32 v164, v164
    v_exp_f32 v165, v165
    v_exp_f32 v166, v166
    v_cvt_pk_bf16_f32 v188, v164, v165
    v_exp_f32 v167, v167
    v_exp_f32 v168, v168
    v_mfma_f32_32x32x16_bf16 v[148:163], v[40:43], v[56:59], v[148:163]
    buffer_load_dwordx4 a[216:219], v223, s[20:23], s53 offen offset:128
    v_cvt_pk_bf16_f32 v189, v166, v167
    v_exp_f32 v169, v169
    v_exp_f32 v170, v170
    v_cvt_pk_bf16_f32 v190, v168, v169
    v_exp_f32 v171, v171
    v_exp_f32 v172, v172
    v_mfma_f32_32x32x16_bf16 v[116:131], v[28:31], v[180:183], v[116:131]
    s_add_u32 s1, s1, 114688
    v_cvt_pk_bf16_f32 v191, v170, v171
    v_exp_f32 v173, v173
    v_exp_f32 v174, v174
    v_cvt_pk_bf16_f32 v192, v172, v173
    v_exp_f32 v175, v175
    v_exp_f32 v176, v176
    v_mfma_f32_32x32x16_bf16 v[116:131], v[32:35], v[184:187], v[116:131]
    s_sub_u32 s53, s1, 1605632
    v_cvt_pk_bf16_f32 v193, v174, v175
    v_exp_f32 v177, v177
    v_exp_f32 v178, v178
    v_exp_f32 v179, v179
    v_cvt_pk_bf16_f32 v194, v176, v177
    v_cvt_pk_bf16_f32 v195, v178, v179
    v_mfma_f32_32x32x16_bf16 v[164:179], v[36:39], v[60:63], 0
    s_min_u32 s1, s1, s53
    v_exp_f32 v148, v148
    v_exp_f32 v149, v149
    v_exp_f32 v150, v150
    v_cvt_pk_bf16_f32 v180, v148, v149
    v_exp_f32 v151, v151
    v_exp_f32 v152, v152
    v_mfma_f32_32x32x16_bf16 v[164:179], v[40:43], v[64:67], v[164:179]
    s_add_u32 s53, s56, s1
    v_cvt_pk_bf16_f32 v181, v150, v151
    v_exp_f32 v153, v153
    v_exp_f32 v154, v154
    v_cvt_pk_bf16_f32 v182, v152, v153
    v_exp_f32 v155, v155
    v_exp_f32 v156, v156
    v_mfma_f32_32x32x16_bf16 v[132:147], v[28:31], v[188:191], v[132:147]
    s_add_u32 m0, s57, 12288
    v_cvt_pk_bf16_f32 v183, v154, v155
    v_exp_f32 v157, v157
    v_exp_f32 v158, v158
    v_cvt_pk_bf16_f32 v184, v156, v157
    v_exp_f32 v159, v159
    v_exp_f32 v160, v160
    v_mfma_f32_32x32x16_bf16 v[132:147], v[32:35], v[192:195], v[132:147]
    buffer_load_dwordx4 v213, s[20:23], s53 offen offset:0 lds
    v_cvt_pk_bf16_f32 v185, v158, v159
    v_exp_f32 v161, v161
    v_exp_f32 v162, v162
    v_exp_f32 v163, v163
    v_cvt_pk_bf16_f32 v186, v160, v161
    v_cvt_pk_bf16_f32 v187, v162, v163
    v_mfma_f32_32x32x16_bf16 v[148:163], v[36:39], v[68:71], 0
    v_exp_f32 v164, v164
    v_exp_f32 v165, v165
    v_exp_f32 v166, v166
    v_cvt_pk_bf16_f32 v188, v164, v165
    v_exp_f32 v167, v167
    v_exp_f32 v168, v168
    v_mfma_f32_32x32x16_bf16 v[148:163], v[40:43], v[72:75], v[148:163]
    s_mov_b64 exec, 0x7f
    s_mov_b32 s98, 0x200000
    s_waitcnt vmcnt(3)
    v_cmp_ne_u32 vcc, s24, v218
    s_nop 1
    s_cbranch_vccz Lpoll2d
Lpoll2:
    buffer_load_dword v218, v3, s[12:15], s54 offen sc1
    s_sub_u32 s98, s98, 1
    s_waitcnt vmcnt(0)
    s_cbranch_scc1 Lpoll2d
    v_cmp_ne_u32 vcc, s24, v218
    s_nop 1
    s_cbranch_vccnz Lpoll2
Lpoll2d:
    s_mov_b64 exec, -1
    v_cvt_pk_bf16_f32 v189, v166, v167
    v_exp_f32 v169, v169
    v_exp_f32 v170, v170
    v_cvt_pk_bf16_f32 v190, v168, v169
    v_exp_f32 v171, v171
    v_exp_f32 v172, v172
    v_mfma_f32_32x32x16_bf16 v[84:99], v[44:47], v[180:183], v[84:99]
    s_mul_i32 s54, s25, 112
    v_cvt_pk_bf16_f32 v191, v170, v171
    v_exp_f32 v173, v173
    v_exp_f32 v174, v174
    v_cvt_pk_bf16_f32 v192, v172, v173
    v_exp_f32 v175, v175
    v_exp_f32 v176, v176
    v_mfma_f32_32x32x16_bf16 v[84:99], v[48:51], v[184:187], v[84:99]
    buffer_load_dwordx4 v245, s[20:23], s53 offen offset:1024 lds
    v_cvt_pk_bf16_f32 v193, v174, v175
    v_exp_f32 v177, v177
    v_exp_f32 v178, v178
    v_exp_f32 v179, v179
    v_cvt_pk_bf16_f32 v194, v176, v177
    v_cvt_pk_bf16_f32 v195, v178, v179
    v_mfma_f32_32x32x16_bf16 v[164:179], v[36:39], v[76:79], 0
    s_add_u32 m0, s57, 69568
    v_exp_f32 v148, v148
    v_exp_f32 v149, v149
    v_exp_f32 v150, v150
    v_cvt_pk_bf16_f32 v180, v148, v149
    v_exp_f32 v151, v151
    v_exp_f32 v152, v152
    v_mfma_f32_32x32x16_bf16 v[164:179], v[40:43], v[80:83], v[164:179]
    s_add_u32 s54, s54, 8912896
    v_cvt_pk_bf16_f32 v181, v150, v151
    v_exp_f32 v153, v153
    v_exp_f32 v154, v154
    v_cvt_pk_bf16_f32 v182, v152, v153
    v_exp_f32 v155, v155
    v_exp_f32 v156, v156
    v_mfma_f32_32x32x16_bf16 v[100:115], v[44:47], v[188:191], v[100:115]
    buffer_load_dwordx4 v[20:23], v219, s[12:15], s54 offen offset:0 sc1
    v_cvt_pk_bf16_f32 v183, v154, v155
    v_exp_f32 v157, v157
    v_exp_f32 v158, v158
    v_cvt_pk_bf16_f32 v184, v156, v157
    v_exp_f32 v159, v159
    v_exp_f32 v160, v160
    v_mfma_f32_32x32x16_bf16 v[100:115], v[48:51], v[192:195], v[100:115]
    v_cvt_pk_bf16_f32 v185, v158, v159
    v_exp_f32 v161, v161
    v_exp_f32 v162, v162
    v_exp_f32 v163, v163
    v_cvt_pk_bf16_f32 v186, v160, v161
    v_cvt_pk_bf16_f32 v187, v162, v163
    v_mfma_f32_32x32x16_bf16 v[148:163], v[224:227], v[52:55], 0
    buffer_load_dwordx4 v213, s[20:23], s53 offen offset:64 lds
    v_exp_f32 v164, v164
    v_exp_f32 v165, v165
    v_exp_f32 v166, v166
    v_cvt_pk_bf16_f32 v188, v164, v165
Lpage6:
    s_cbranch_execz Lvis1
    v_exp_f32 v167, v167
    v_exp_f32 v168, v168
    v_mfma_f32_32x32x16_bf16 v[148:163], v[228:231], v[56:59], v[148:163]
    buffer_load_dwordx4 v[24:27], v219, s[12:15], s54 offen offset:32 sc1
    v_cvt_pk_bf16_f32 v189, v166, v167
    v_exp_f32 v169, v169
    v_exp_f32 v170, v170
    v_cvt_pk_bf16_f32 v190, v168, v169
    v_exp_f32 v171, v171
    v_exp_f32 v172, v172
    v_mfma_f32_32x32x16_bf16 v[116:131], v[44:47], v[180:183], v[116:131]
    buffer_load_dwordx4 v[28:31], v219, s[12:15], s54 offen offset:64 sc1
    v_cvt_pk_bf16_f32 v191, v170, v171
    v_exp_f32 v173, v173
    v_exp_f32 v174, v174
    v_cvt_pk_bf16_f32 v192, v172, v173
    v_exp_f32 v175, v175
    v_exp_f32 v176, v176
    v_mfma_f32_32x32x16_bf16 v[116:131], v[48:51], v[184:187], v[116:131]
    buffer_load_dwordx4 v[32:35], v219, s[12:15], s54 offen offset:96 sc1
    v_cvt_pk_bf16_f32 v193, v174, v175
    v_exp_f32 v177, v177
    v_exp_f32 v178, v178
    v_exp_f32 v179, v179
    v_cvt_pk_bf16_f32 v194, v176, v177
    v_cvt_pk_bf16_f32 v195, v178, v179
    v_mfma_f32_32x32x16_bf16 v[164:179], v[224:227], v[60:63], 0
    v_exp_f32 v148, v148
    v_exp_f32 v149, v149
    v_exp_f32 v150, v150
    v_cvt_pk_bf16_f32 v180, v148, v149
    v_exp_f32 v151, v151
    v_exp_f32 v152, v152
    v_mfma_f32_32x32x16_bf16 v[164:179], v[228:231], v[64:67], v[164:179]
    buffer_load_dwordx4 v245, s[20:23], s53 offen offset:1088 lds
    v_cvt_pk_bf16_f32 v181, v150, v151
    v_exp_f32 v153, v153
    v_exp_f32 v154, v154
    v_cvt_pk_bf16_f32 v182, v152, v153
    v_exp_f32 v155, v155
    v_exp_f32 v156, v156
    v_mfma_f32_32x32x16_bf16 v[132:147], v[44:47], v[188:191], v[132:147]
    s_lshl_b32 s55, s26, 2
    v_cvt_pk_bf16_f32 v183, v154, v155
    v_exp_f32 v157, v157
    v_exp_f32 v158, v158
    v_cvt_pk_bf16_f32 v184, v156, v157
    v_exp_f32 v159, v159
    v_exp_f32 v160, v160
    v_mfma_f32_32x32x16_bf16 v[132:147], v[48:51], v[192:195], v[132:147]
    s_add_u32 s55, s55, s3
    v_cvt_pk_bf16_f32 v185, v158, v159
    v_exp_f32 v161, v161
    v_exp_f32 v162, v162
    v_exp_f32 v163, v163
    v_cvt_pk_bf16_f32 v186, v160, v161
    v_cvt_pk_bf16_f32 v187, v162, v163
    v_mfma_f32_32x32x16_bf16 v[148:163], v[224:227], v[68:71], 0
    s_lshl_b32 s55, s55, 4
    v_exp_f32 v164, v164
    v_exp_f32 v165, v165
    v_exp_f32 v166, v166
    v_cvt_pk_bf16_f32 v188, v164, v165
    v_exp_f32 v167, v167
    v_exp_f32 v168, v168
    v_mfma_f32_32x32x16_bf16 v[148:163], v[228:231], v[72:75], v[148:163]
    s_add_u32 s55, s55, s25
    v_cvt_pk_bf16_f32 v189, v166, v167
    v_exp_f32 v169, v169
    v_exp_f32 v170, v170
    v_cvt_pk_bf16_f32 v190, v168, v169
    v_exp_f32 v171, v171
    v_exp_f32 v172, v172
    v_mfma_f32_32x32x16_bf16 v[84:99], v[232:235], v[180:183], v[84:99]
    buffer_load_dwordx4 a[220:223], v223, s[20:23], s53 offen offset:128
    v_cvt_pk_bf16_f32 v191, v170, v171
    v_exp_f32 v173, v173
    v_exp_f32 v174, v174
    v_cvt_pk_bf16_f32 v192, v172, v173
    v_exp_f32 v175, v175
    v_exp_f32 v176, v176
    v_mfma_f32_32x32x16_bf16 v[84:99], v[236:239], v[184:187], v[84:99]
    s_lshl_b32 s58, s55, 7
    v_cvt_pk_bf16_f32 v193, v174, v175
    v_exp_f32 v177, v177
    v_exp_f32 v178, v178
    v_exp_f32 v179, v179
    v_cvt_pk_bf16_f32 v194, v176, v177
    v_cvt_pk_bf16_f32 v195, v178, v179
    v_mfma_f32_32x32x16_bf16 v[164:179], v[224:227], v[76:79], 0
    s_add_u32 s58, s58, 16973824
    v_exp_f32 v148, v148
    v_exp_f32 v149, v149
    v_exp_f32 v150, v150
    v_cvt_pk_bf16_f32 v180, v148, v149
    v_exp_f32 v151, v151
    v_exp_f32 v152, v152
    v_mfma_f32_32x32x16_bf16 v[164:179], v[228:231], v[80:83], v[164:179]
    s_lshl_b32 s55, s55, 11
    v_cvt_pk_bf16_f32 v181, v150, v151
    v_exp_f32 v153, v153
    v_exp_f32 v154, v154
    v_cvt_pk_bf16_f32 v182, v152, v153
    v_exp_f32 v155, v155
    v_exp_f32 v156, v156
    v_mfma_f32_32x32x16_bf16 v[100:115], v[232:235], v[188:191], v[100:115]
    s_add_u32 s59, s55, 4194304
    v_cvt_pk_bf16_f32 v183, v154, v155
    v_exp_f32 v157, v157
    v_exp_f32 v158, v158
    v_cvt_pk_bf16_f32 v184, v156, v157
    v_exp_f32 v159, v159
    v_exp_f32 v160, v160
    v_mfma_f32_32x32x16_bf16 v[100:115], v[236:239], v[192:195], v[100:115]
    v_cvt_pk_bf16_f32 v185, v158, v159
    v_exp_f32 v161, v161
    v_exp_f32 v162, v162
    v_exp_f32 v163, v163
    v_cvt_pk_bf16_f32 v186, v160, v161
    v_cvt_pk_bf16_f32 v187, v162, v163
    v_exp_f32 v164, v164
    v_exp_f32 v165, v165
    v_exp_f32 v166, v166
    v_cvt_pk_bf16_f32 v188, v164, v165
    v_exp_f32 v167, v167
    v_exp_f32 v168, v168
    v_cvt_pk_bf16_f32 v189, v166, v167
    v_exp_f32 v169, v169
    v_exp_f32 v170, v170
    v_cvt_pk_bf16_f32 v190, v168, v169
    v_exp_f32 v171, v171
    v_exp_f32 v172, v172
    v_mfma_f32_32x32x16_bf16 v[116:131], v[232:235], v[180:183], v[116:131]
    v_cvt_pk_bf16_f32 v191, v170, v171
    v_exp_f32 v173, v173
    v_exp_f32 v174, v174
    v_cvt_pk_bf16_f32 v192, v172, v173
    v_exp_f32 v175, v175
    v_exp_f32 v176, v176
    v_mfma_f32_32x32x16_bf16 v[116:131], v[236:239], v[184:187], v[116:131]
    v_cvt_pk_bf16_f32 v193, v174, v175
    v_exp_f32 v177, v177
    v_exp_f32 v178, v178
    v_exp_f32 v179, v179
    v_cvt_pk_bf16_f32 v194, v176, v177
    v_cvt_pk_bf16_f32 v195, v178, v179
    v_mfma_f32_32x32x16_bf16 v[132:147], v[232:235], v[188:191], v[132:147]
    s_nop 0
    v_mfma_f32_32x32x16_bf16 v[132:147], v[236:239], v[192:195], v[132:147]
    ds_write_b128 v241, v[100:103] offset:0
    s_mov_b32 s16, s36
    s_mov_b32 s17, s37
    s_mov_b32 s18, 401408
    s_mov_b32 s19, 0x20000
    s_mul_i32 s48, s3, 100352
    s_lshl_b32 s49, s28, 7
    s_add_u32 s48, s48, s49
    s_add_u32 s49, s48, 0
    buffer_load_dwordx4 a[224:227], v212, s[16:19], s49 offen offset:0
    ds_write_b128 v241, v[104:107] offset:1024
    buffer_load_dwordx4 a[228:231], v212, s[16:19], s49 offen offset:896
    ds_write_b128 v241, v[108:111] offset:2048
    s_add_u32 s49, s48, 14336
    buffer_load_dwordx4 a[232:235], v212, s[16:19], s49 offen offset:0
    ds_write_b128 v241, v[112:115] offset:3072
    buffer_load_dwordx4 a[236:239], v212, s[16:19], s49 offen offset:896
    ds_write_b128 v242, v[116:119] offset:4096
    s_add_u32 s49, s48, 25088
    buffer_load_dwordx4 a[240:243], v212, s[16:19], s49 offen offset:0
    ds_write_b128 v242, v[120:123] offset:5120
    buffer_load_dwordx4 a[244:247], v212, s[16:19], s49 offen offset:896
    ds_write_b128 v242, v[124:127] offset:6144
    s_add_u32 s49, s48, 39424
    buffer_load_dwordx4 a[248:251], v212, s[16:19], s49 offen offset:0
    ds_write_b128 v242, v[128:131] offset:7168
    buffer_load_dwordx4 a[252:255], v212, s[16:19], s49 offen offset:896
    ds_write_b128 v243, v[132:135] offset:8192
    s_add_u32 s49, s48, 50176
    buffer_load_dwordx4 v[224:227], v212, s[16:19], s49 offen offset:0
    ds_write_b128 v243, v[136:139] offset:9216
    buffer_load_dwordx4 v[228:231], v212, s[16:19], s49 offen offset:896
    ds_write_b128 v243, v[140:143] offset:10240
    s_add_u32 s49, s48, 64512
    buffer_load_dwordx4 v[232:235], v212, s[16:19], s49 offen offset:0
    ds_write_b128 v243, v[144:147] offset:11264
    buffer_load_dwordx4 v[236:239], v212, s[16:19], s49 offen offset:896
    s_waitcnt vmcnt(14)
    s_mov_b32 exec_lo, 0
    v_mov_b32 v32, 0
    v_mov_b32 v33, 0
    v_mov_b32 v34, 0
    v_mov_b32 v35, 0
    s_mov_b64 exec, -1
    v_mov_b32 v200, 0x5f800000
    v_mov_b32 v201, 0x1f800000
    s_waitcnt lgkmcnt(0)
    s_barrier
    ds_read_b128 v[100:103], v240 offset:0
    ds_read_b128 v[104:107], v240 offset:1024
    ds_read_b128 v[108:111], v240 offset:2048
    ds_read_b128 v[112:115], v240 offset:3072
    ds_read_b128 v[116:119], v240 offset:4096
    ds_read_b128 v[120:123], v240 offset:5120
    ds_read_b128 v[124:127], v240 offset:6144
    ds_read_b128 v[128:131], v240 offset:7168
    ds_read_b128 v[132:135], v240 offset:8192
    ds_read_b128 v[136:139], v240 offset:9216
    ds_read_b128 v[140:143], v240 offset:10240
    ds_read_b128 v[144:147], v240 offset:11264
    s_add_u32 s49, s48, 75264
    buffer_load_dwordx4 v[240:243], v212, s[16:19], s49 offen offset:0
    buffer_load_dwordx4 v[244:247], v212, s[16:19], s49 offen offset:896
    s_add_u32 s49, s48, 89600
    buffer_load_dwordx4 v[248:251], v212, s[16:19], s49 offen offset:0
    buffer_load_dwordx4 v[252:255], v212, s[16:19], s49 offen offset:896
    s_waitcnt lgkmcnt(8)
    v_pk_add_f32 v[84:85], v[84:85], v[100:101]
    v_pk_add_f32 v[86:87], v[86:87], v[102:103]
    v_pk_add_f32 v[88:89], v[88:89], v[104:105]
    v_pk_add_f32 v[90:91], v[90:91], v[106:107]
    v_pk_add_f32 v[92:93], v[92:93], v[108:109]
    v_pk_add_f32 v[94:95], v[94:95], v[110:111]
    v_pk_add_f32 v[96:97], v[96:97], v[112:113]
    v_pk_add_f32 v[98:99], v[98:99], v[114:115]
    s_waitcnt lgkmcnt(4)
    v_pk_add_f32 v[84:85], v[84:85], v[116:117]
    v_pk_add_f32 v[86:87], v[86:87], v[118:119]
    v_pk_add_f32 v[88:89], v[88:89], v[120:121]
    v_pk_add_f32 v[90:91], v[90:91], v[122:123]
    v_pk_add_f32 v[92:93], v[92:93], v[124:125]
    v_pk_add_f32 v[94:95], v[94:95], v[126:127]
    v_pk_add_f32 v[96:97], v[96:97], v[128:129]
    v_pk_add_f32 v[98:99], v[98:99], v[130:131]
    s_waitcnt lgkmcnt(0)
    v_pk_add_f32 v[84:85], v[84:85], v[132:133]
    v_pk_add_f32 v[86:87], v[86:87], v[134:135]
    v_pk_add_f32 v[88:89], v[88:89], v[136:137]
    v_pk_add_f32 v[90:91], v[90:91], v[138:139]
    v_pk_add_f32 v[92:93], v[92:93], v[140:141]
    v_pk_add_f32 v[94:95], v[94:95], v[142:143]
    v_pk_add_f32 v[96:97], v[96:97], v[144:145]
    v_pk_add_f32 v[98:99], v[98:99], v[146:147]
    v_mov_b32 v196, v96
    v_mov_b32 v197, v96
    s_nop 1
    v_permlane32_swap_b32 v196, v197
    v_med3_f32 v199, v197, v200, v201
    v_cmp_neq_f32 vcc, v199, v197
    v_rcp_f32 v198, v197
    s_nop 0
    s_cbranch_vccnz Lfb
Lfb_ret:
    v_cmp_lt_u32 vcc, 31, v1
    v_pk_mul_f32 v[84:85], v[84:85], v[198:199] op_sel_hi:[1,0]
    v_pk_mul_f32 v[86:87], v[86:87], v[198:199] op_sel_hi:[1,0]
    v_pk_mul_f32 v[88:89], v[88:89], v[198:199] op_sel_hi:[1,0]
    v_pk_mul_f32 v[90:91], v[90:91], v[198:199] op_sel_hi:[1,0]
    v_pk_mul_f32 v[92:93], v[92:93], v[198:199] op_sel_hi:[1,0]
    v_pk_mul_f32 v[94:95], v[94:95], v[198:199] op_sel_hi:[1,0]
    v_pk_mul_f32 v[96:97], v[96:97], v[198:199] op_sel_hi:[1,0]
    v_pk_mul_f32 v[98:99], v[98:99], v[198:199] op_sel_hi:[1,0]
    v_cvt_pk_bf16_f32 v180, v84, v85
    v_cvt_pk_bf16_f32 v181, v86, v87
    v_cvt_pk_bf16_f32 v182, v88, v89
    v_cvt_pk_bf16_f32 v183, v90, v91
    v_cvt_pk_bf16_f32 v184, v92, v93
    v_cvt_pk_bf16_f32 v185, v94, v95
    v_cvt_pk_bf16_f32 v186, v96, v97
    v_cvt_pk_bf16_f32 v187, v98, v99
    v_cndmask_b32_e64 v186, v186, 0, vcc
    v_cndmask_b32_e64 v187, v187, 0, vcc
    buffer_store_dwordx4 v[180:183], v2, s[12:15], s59 offen offset:0 sc1
    buffer_store_dwordx4 v[184:187], v2, s[12:15], s59 offen offset:1024 sc1
    v_pk_mul_f32 v[196:197], v[84:85], v[20:21]
    v_pk_mul_f32 v[198:199], v[86:87], v[22:23]
    v_pk_fma_f32 v[196:197], v[88:89], v[24:25], v[196:197]
    v_pk_fma_f32 v[198:199], v[90:91], v[26:27], v[198:199]
    v_pk_fma_f32 v[196:197], v[92:93], v[28:29], v[196:197]
    v_pk_fma_f32 v[198:199], v[94:95], v[30:31], v[198:199]
    v_pk_fma_f32 v[196:197], v[96:97], v[32:33], v[196:197]
    v_pk_fma_f32 v[198:199], v[98:99], v[34:35], v[198:199]
    v_pk_add_f32 v[196:197], v[196:197], v[198:199]
    v_add_f32 v196, v196, v197
    v_mov_b32 v197, v196
    s_nop 1
    v_permlane32_swap_b32 v196, v197
    v_add_f32 v196, v196, v197
    v_add_f32 v196, v196, v216
    v_lshlrev_b32 v197, 2, v1
    s_add_u32 s53, s58, 4286971904
    s_mov_b32 exec_lo, -1
    s_mov_b32 exec_hi, 0x0
    buffer_store_dword v196, v197, s[12:15], s53 offen sc1
    s_mov_b64 exec, -1
    s_cmp_ge_u32 s31, 28
    s_cbranch_scc1 LnoC
    v_lshrrev_b32 v132, 5, v1
    v_bfe_u32 v133, v1, 2, 2
    v_lshl_add_u32 v132, v132, 2, v133
    v_lshlrev_b32 v132, 7, v132
    v_bfe_u32 v133, v1, 4, 1
    v_lshl_add_u32 v132, v133, 5, v132
    v_and_b32 v133, 3, v1
    v_lshl_add_u32 v132, v133, 3, v132
    v_bfe_u32 v133, v1, 3, 1
    s_lshr_b32 s53, s3, 1
    v_xor_b32 v133, s53, v133
    v_lshl_add_u32 v132, v133, 6, v132
    s_lshl_b32 s53, s3, 12
    s_add_u32 s53, s53, 114688
    v_add_u32 v214, s53, v132
    v_xor_b32 v215, 64, v214
    v_lshrrev_b32 v132, 3, v1
    v_lshlrev_b32 v132, 7, v132
    v_add3_u32 v141, s53, v2, v132
    s_and_b32 s54, s3, 1
    s_lshl_b32 s53, s27, 1
    s_add_u32 s54, s54, s53
    s_lshr_b32 s55, s3, 1
    s_lshl_b32 s53, s28, 1
    s_add_u32 s55, s55, s53
    s_xor_b32 s53, s54, 0
    s_lshl_b32 s53, s53, 2
    s_add_u32 s53, s53, s3
    s_lshl_b32 s53, s53, 13
    s_add_u32 s56, s53, 4194304
    s_xor_b32 s53, s54, 1
    s_lshl_b32 s53, s53, 2
    s_add_u32 s53, s53, s3
    s_lshl_b32 s53, s53, 13
    s_add_u32 s57, s53, 4194304
    v_permlane32_swap_b32 v204, v206
    v_permlane32_swap_b32 v205, v207
    v_permlane32_swap_b32 v208, v210
    v_permlane32_swap_b32 v209, v211
    v_lshlrev_b32 v4, 16, v204
    v_and_b32 v5, 0xffff0000, v204
    v_lshlrev_b32 v6, 16, v205
    v_and_b32 v7, 0xffff0000, v205
    v_lshlrev_b32 v8, 16, v206
    v_and_b32 v9, 0xffff0000, v206
    v_lshlrev_b32 v10, 16, v207
    v_and_b32 v11, 0xffff0000, v207
    v_lshlrev_b32 v12, 16, v208
    v_and_b32 v13, 0xffff0000, v208
    v_lshlrev_b32 v14, 16, v209
    v_and_b32 v15, 0xffff0000, v209
    v_lshlrev_b32 v16, 16, v210
    v_and_b32 v17, 0xffff0000, v210
    v_lshlrev_b32 v18, 16, v211
    v_and_b32 v19, 0xffff0000, v211
    s_barrier
    s_waitcnt vmcnt(15)
    ds_write_b128 v141, a[224:227] offset:0
    ds_write_b128 v141, a[228:231] offset:128
    ds_write_b128 v141, a[232:235] offset:2048
    ds_write_b128 v141, a[236:239] offset:2176
    ds_read_b64_tr_b16 a[224:225], v214 offset:0
    ds_read_b64_tr_b16 a[226:227], v214 offset:1024
    ds_read_b64_tr_b16 a[228:229], v215 offset:0
    ds_read_b64_tr_b16 a[230:231], v215 offset:1024
    ds_read_b64_tr_b16 a[232:233], v214 offset:2048
    ds_read_b64_tr_b16 a[234:235], v214 offset:3072
    ds_read_b64_tr_b16 a[236:237], v215 offset:2048
    ds_read_b64_tr_b16 a[238:239], v215 offset:3072
    s_waitcnt vmcnt(0)
    v_mov_b32 v135, s24
    s_mov_b64 exec, 1
    buffer_store_dword v135, v2, s[12:15], s58 offen sc1
    s_mov_b64 exec, -1
    s_mov_b64 exec, 0
    s_cmp_eq_u32 s3, 0
    s_cbranch_scc1 Lpage9
    s_cmp_eq_u32 s3, 1
    s_cbranch_scc1 Lpage10
    s_cmp_eq_u32 s3, 2
    s_cbranch_scc1 Lpage11
    s_cmp_eq_u32 s3, 3
    s_cbranch_scc1 Lpage12
Lvis2:
    s_mov_b64 exec, -1
    v_lshrrev_b32 v132, 2, v1
    v_lshlrev_b32 v132, 11, v132
    v_and_b32 v133, 3, v1
    v_lshl_add_u32 v140, v133, 7, v132
    s_lshl_b32 s53, s27, 3
    s_add_u32 s53, s53, s3
    s_lshl_b32 s58, s53, 9
    s_add_u32 s58, s58, 16973824
    s_mov_b32 s16, s44
    s_mov_b32 s17, s45
    s_mov_b32 s18, 1605632
    s_mov_b32 s19, 0x20000
    s_mul_i32 s48, s3, 401408
    s_lshl_b32 s49, s28, 7
    s_add_u32 s48, s48, s49
    s_add_u32 s49, s48, 0
    buffer_load_dwordx4 a[0:3], v212, s[16:19], s49 offen offset:0
    buffer_load_dwordx4 a[4:7], v212, s[16:19], s49 offen offset:896
    s_add_u32 s49, s48, 14336
    buffer_load_dwordx4 a[8:11], v212, s[16:19], s49 offen offset:0
    buffer_load_dwordx4 a[12:15], v212, s[16:19], s49 offen offset:896
    s_add_u32 s49, s48, 28672
    buffer_load_dwordx4 a[16:19], v212, s[16:19], s49 offen offset:0
    buffer_load_dwordx4 a[20:23], v212, s[16:19], s49 offen offset:896
    s_add_u32 s49, s48, 43008
    buffer_load_dwordx4 a[24:27], v212, s[16:19], s49 offen offset:0
    buffer_load_dwordx4 a[28:31], v212, s[16:19], s49 offen offset:896
    s_add_u32 s49, s48, 57344
    buffer_load_dwordx4 a[32:35], v212, s[16:19], s49 offen offset:0
    buffer_load_dwordx4 a[36:39], v212, s[16:19], s49 offen offset:896
    s_add_u32 s49, s48, 71680
    buffer_load_dwordx4 a[40:43], v212, s[16:19], s49 offen offset:0
    buffer_load_dwordx4 a[44:47], v212, s[16:19], s49 offen offset:896
    ds_write_b128 v141, a[240:243] offset:0
    ds_write_b128 v141, a[244:247] offset:128
    ds_write_b128 v141, a[248:251] offset:2048
    ds_write_b128 v141, a[252:255] offset:2176
    ds_read_b64_tr_b16 a[240:241], v214 offset:0
    ds_read_b64_tr_b16 a[242:243], v214 offset:1024
    ds_read_b64_tr_b16 a[244:245], v215 offset:0
    ds_read_b64_tr_b16 a[246:247], v215 offset:1024
    ds_read_b64_tr_b16 a[248:249], v214 offset:2048
    ds_read_b64_tr_b16 a[250:251], v214 offset:3072
    ds_read_b64_tr_b16 a[252:253], v215 offset:2048
    ds_read_b64_tr_b16 a[254:255], v215 offset:3072
    ds_write_b128 v141, v[224:227] offset:0
    ds_write_b128 v141, v[228:231] offset:128
    ds_write_b128 v141, v[232:235] offset:2048
    ds_write_b128 v141, v[236:239] offset:2176
    ds_read_b64_tr_b16 v[224:225], v214 offset:0
    ds_read_b64_tr_b16 v[226:227], v214 offset:1024
    ds_read_b64_tr_b16 v[228:229], v215 offset:0
    ds_read_b64_tr_b16 v[230:231], v215 offset:1024
    ds_read_b64_tr_b16 v[232:233], v214 offset:2048
    ds_read_b64_tr_b16 v[234:235], v214 offset:3072
    ds_read_b64_tr_b16 v[236:237], v215 offset:2048
    ds_read_b64_tr_b16 v[238:239], v215 offset:3072
    ds_write_b128 v141, v[240:243] offset:0
    ds_write_b128 v141, v[244:247] offset:128
    ds_write_b128 v141, v[248:251] offset:2048
    ds_write_b128 v141, v[252:255] offset:2176
    ds_read_b64_tr_b16 v[240:241], v214 offset:0
    ds_read_b64_tr_b16 v[242:243], v214 offset:1024
    ds_read_b64_tr_b16 v[244:245], v215 offset:0
    ds_read_b64_tr_b16 v[246:247], v215 offset:1024
    ds_read_b64_tr_b16 v[248:249], v214 offset:2048
    ds_read_b64_tr_b16 v[250:251], v214 offset:3072
    ds_read_b64_tr_b16 v[252:253], v215 offset:2048
    ds_read_b64_tr_b16 v[254:255], v215 offset:3072
    s_mov_b64 exec, 0xff
    buffer_load_dword v142, v140, s[12:15], s58 offen sc1
    s_mov_b64 exec, -1
    s_waitcnt vmcnt(9)
    ds_write_b128 v141, a[0:3] offset:0
    ds_write_b128 v141, a[4:7] offset:128
    ds_write_b128 v141, a[8:11] offset:2048
    ds_write_b128 v141, a[12:15] offset:2176
    ds_read_b64_tr_b16 a[0:1], v214 offset:0
    ds_read_b64_tr_b16 a[2:3], v214 offset:1024
    ds_read_b64_tr_b16 a[4:5], v215 offset:0
    ds_read_b64_tr_b16 a[6:7], v215 offset:1024
    ds_read_b64_tr_b16 a[8:9], v214 offset:2048
    ds_read_b64_tr_b16 a[10:11], v214 offset:3072
    ds_read_b64_tr_b16 a[12:13], v215 offset:2048
    ds_read_b64_tr_b16 a[14:15], v215 offset:3072
    s_waitcnt vmcnt(5)
    ds_write_b128 v141, a[16:19] offset:0
    ds_write_b128 v141, a[20:23] offset:128
    ds_write_b128 v141, a[24:27] offset:2048
    ds_write_b128 v141, a[28:31] offset:2176
    ds_read_b64_tr_b16 a[16:17], v214 offset:0
    ds_read_b64_tr_b16 a[18:19], v214 offset:1024
    ds_read_b64_tr_b16 a[20:21], v215 offset:0
    ds_read_b64_tr_b16 a[22:23], v215 offset:1024
    ds_read_b64_tr_b16 a[24:25], v214 offset:2048
    ds_read_b64_tr_b16 a[26:27], v214 offset:3072
    ds_read_b64_tr_b16 a[28:29], v215 offset:2048
    ds_read_b64_tr_b16 a[30:31], v215 offset:3072
    s_mov_b64 exec, 0xff
    s_mov_b32 s98, 0x200000
    s_waitcnt vmcnt(0)
    v_cmp_ne_u32 vcc, s24, v142
    s_nop 1
    s_cbranch_vccz Lpoll3d
Lpoll3:
    buffer_load_dword v142, v140, s[12:15], s58 offen sc1
    s_sub_u32 s98, s98, 1
    s_waitcnt vmcnt(0)
    s_cbranch_scc1 Lpoll3d
    v_cmp_ne_u32 vcc, s24, v142
    s_nop 1
    s_cbranch_vccnz Lpoll3
Lpoll3d:
    s_mov_b64 exec, -1
    buffer_load_dwordx4 v[68:71], v2, s[12:15], s56 offen offset:0 sc1
    buffer_load_dwordx4 v[100:103], v2, s[12:15], s57 offen offset:0 sc1
    buffer_load_dwordx4 v[72:75], v2, s[12:15], s56 offen offset:1024 sc1
    buffer_load_dwordx4 v[104:107], v2, s[12:15], s57 offen offset:1024 sc1
    buffer_load_dwordx4 v[76:79], v2, s[12:15], s56 offen offset:2048 sc1
    buffer_load_dwordx4 v[108:111], v2, s[12:15], s57 offen offset:2048 sc1
    buffer_load_dwordx4 v[80:83], v2, s[12:15], s56 offen offset:3072 sc1
    buffer_load_dwordx4 v[112:115], v2, s[12:15], s57 offen offset:3072 sc1
    s_add_u32 s56, s56, 4096
    s_add_u32 s57, s57, 4096
    buffer_load_dwordx4 v[84:87], v2, s[12:15], s56 offen offset:0 sc1
    buffer_load_dwordx4 v[116:119], v2, s[12:15], s57 offen offset:0 sc1
    buffer_load_dwordx4 v[88:91], v2, s[12:15], s56 offen offset:1024 sc1
    buffer_load_dwordx4 v[120:123], v2, s[12:15], s57 offen offset:1024 sc1
    ds_write_b128 v141, a[32:35] offset:0
    ds_write_b128 v141, a[36:39] offset:128
    ds_write_b128 v141, a[40:43] offset:2048
    ds_write_b128 v141, a[44:47] offset:2176
    ds_read_b64_tr_b16 a[32:33], v214 offset:0
    ds_read_b64_tr_b16 a[34:35], v214 offset:1024
    ds_read_b64_tr_b16 a[36:37], v215 offset:0
    ds_read_b64_tr_b16 a[38:39], v215 offset:1024
    ds_read_b64_tr_b16 a[40:41], v214 offset:2048
    ds_read_b64_tr_b16 a[42:43], v214 offset:3072
    ds_read_b64_tr_b16 a[44:45], v215 offset:2048
    ds_read_b64_tr_b16 a[46:47], v215 offset:3072
    s_xor_b32 s53, s3, 0
    s_mul_i32 s53, s53, 12288
    s_add_u32 s53, s53, 114688
    v_add_u32 v132, s53, v2
    s_xor_b32 s53, s3, 1
    s_mul_i32 s53, s53, 12288
    s_add_u32 s53, s53, 114688
    v_add_u32 v133, s53, v2
    s_xor_b32 s53, s3, 2
    s_mul_i32 s53, s53, 12288
    s_add_u32 s53, s53, 114688
    v_add_u32 v134, s53, v2
    s_xor_b32 s53, s3, 3
    s_mul_i32 s53, s53, 12288
    s_add_u32 s53, s53, 114688
    v_add_u32 v135, s53, v2
    s_mul_i32 s59, s54, 14
    s_add_u32 s59, s59, s55
    s_lshl_b32 s58, s54, 4
    s_add_u32 s58, s58, s55
    s_lshl_b32 s58, s58, 7
    s_add_u32 s58, s58, 17104896
    s_waitcnt lgkmcnt(0)
    s_barrier
    s_lshl_b32 s53, s54, 11
    s_add_u32 s99, s53, 8978432
    v_lshlrev_b32 v140, 2, v1
    s_waitcnt vmcnt(10)
    v_mfma_f32_32x32x16_bf16 v[4:19], a[224:227], v[68:71], v[4:19]
    buffer_load_dwordx4 v[92:95], v2, s[12:15], s56 offen offset:2048 sc1
    v_mfma_f32_32x32x16_bf16 v[20:35], a[224:227], v[100:103], 0
    v_mfma_f32_32x32x16_bf16 v[36:51], a[228:231], v[68:71], 0
    buffer_load_dwordx4 v[124:127], v2, s[12:15], s57 offen offset:2048 sc1
    v_mfma_f32_32x32x16_bf16 v[52:67], a[228:231], v[100:103], 0
    s_waitcnt vmcnt(10)
    v_mfma_f32_32x32x16_bf16 v[4:19], a[232:235], v[72:75], v[4:19]
    buffer_load_dwordx4 v[96:99], v2, s[12:15], s56 offen offset:3072 sc1
    v_mfma_f32_32x32x16_bf16 v[20:35], a[232:235], v[104:107], v[20:35]
    v_mfma_f32_32x32x16_bf16 v[36:51], a[236:239], v[72:75], v[36:51]
    buffer_load_dwordx4 v[128:131], v2, s[12:15], s57 offen offset:3072 sc1
    v_mfma_f32_32x32x16_bf16 v[52:67], a[236:239], v[104:107], v[52:67]
    buffer_load_dword v144, v140, s[12:15], s99 offen offset:0 sc1
    s_waitcnt vmcnt(11)
    v_mfma_f32_32x32x16_bf16 v[4:19], a[240:243], v[76:79], v[4:19]
    buffer_load_dword v145, v140, s[12:15], s99 offen offset:256 sc1
    v_mfma_f32_32x32x16_bf16 v[20:35], a[240:243], v[108:111], v[20:35]
    buffer_load_dword v146, v140, s[12:15], s99 offen offset:512 sc1
    v_mfma_f32_32x32x16_bf16 v[36:51], a[244:247], v[76:79], v[36:51]
    buffer_load_dword v147, v140, s[12:15], s99 offen offset:768 sc1
    v_mfma_f32_32x32x16_bf16 v[52:67], a[244:247], v[108:111], v[52:67]
    buffer_load_dword v148, v140, s[12:15], s99 offen offset:1024 sc1
    s_waitcnt vmcnt(13)
    v_mfma_f32_32x32x16_bf16 v[4:19], a[248:251], v[80:83], v[4:19]
    buffer_load_dword v149, v140, s[12:15], s99 offen offset:1280 sc1
    v_mfma_f32_32x32x16_bf16 v[20:35], a[248:251], v[112:115], v[20:35]
    buffer_load_dword v150, v140, s[12:15], s99 offen offset:1536 sc1
    v_mfma_f32_32x32x16_bf16 v[36:51], a[252:255], v[80:83], v[36:51]
    buffer_load_dword v151, v140, s[12:15], s99 offen offset:1792 sc1
    v_mfma_f32_32x32x16_bf16 v[52:67], a[252:255], v[112:115], v[52:67]
    s_waitcnt vmcnt(14)
    v_mfma_f32_32x32x16_bf16 v[4:19], v[224:227], v[84:87], v[4:19]
    v_mfma_f32_32x32x16_bf16 v[20:35], v[224:227], v[116:119], v[20:35]
    v_mfma_f32_32x32x16_bf16 v[36:51], v[228:231], v[84:87], v[36:51]
    v_mfma_f32_32x32x16_bf16 v[52:67], v[228:231], v[116:119], v[52:67]
    s_waitcnt vmcnt(12)
    v_mfma_f32_32x32x16_bf16 v[20:35], v[232:235], v[120:123], v[20:35]
    s_waitcnt vmcnt(10)
    v_mfma_f32_32x32x16_bf16 v[20:35], v[240:243], v[124:127], v[20:35]
    s_waitcnt vmcnt(8)
    v_mfma_f32_32x32x16_bf16 v[20:35], v[248:251], v[128:131], v[20:35]
    v_mfma_f32_32x32x16_bf16 v[36:51], v[236:239], v[88:91], v[36:51]
    v_mfma_f32_32x32x16_bf16 v[36:51], v[244:247], v[92:95], v[36:51]
    v_mfma_f32_32x32x16_bf16 v[36:51], v[252:255], v[96:99], v[36:51]
    s_nop 8
    ds_write_b128 v133, v[20:23] offset:0
    s_add_u32 s49, s48, 86016
    buffer_load_dwordx4 a[48:51], v212, s[16:19], s49 offen offset:0
    ds_write_b128 v133, v[24:27] offset:1024
    buffer_load_dwordx4 a[52:55], v212, s[16:19], s49 offen offset:896
    ds_write_b128 v133, v[28:31] offset:2048
    s_add_u32 s49, s48, 100352
    buffer_load_dwordx4 a[56:59], v212, s[16:19], s49 offen offset:0
    ds_write_b128 v133, v[32:35] offset:3072
    buffer_load_dwordx4 a[60:63], v212, s[16:19], s49 offen offset:896
    v_mfma_f32_32x32x16_bf16 v[52:67], v[236:239], v[120:123], v[52:67]
    v_mfma_f32_32x32x16_bf16 v[52:67], v[244:247], v[124:127], v[52:67]
    v_mfma_f32_32x32x16_bf16 v[52:67], v[252:255], v[128:131], v[52:67]
    ds_write_b128 v134, v[36:39] offset:4096
    s_add_u32 s49, s48, 114688
    buffer_load_dwordx4 a[64:67], v212, s[16:19], s49 offen offset:0
    ds_write_b128 v134, v[40:43] offset:5120
    buffer_load_dwordx4 a[68:71], v212, s[16:19], s49 offen offset:896
    ds_write_b128 v134, v[44:47] offset:6144
    s_add_u32 s49, s48, 129024
    buffer_load_dwordx4 a[72:75], v212, s[16:19], s49 offen offset:0
    ds_write_b128 v134, v[48:51] offset:7168
    buffer_load_dwordx4 a[76:79], v212, s[16:19], s49 offen offset:896
    v_mfma_f32_32x32x16_bf16 v[4:19], v[232:235], v[88:91], v[4:19]
    v_mfma_f32_32x32x16_bf16 v[4:19], v[240:243], v[92:95], v[4:19]
    v_mfma_f32_32x32x16_bf16 v[4:19], v[248:251], v[96:99], v[4:19]
    ds_write_b128 v135, v[52:55] offset:8192
    s_add_u32 s49, s48, 143360
    buffer_load_dwordx4 a[80:83], v212, s[16:19], s49 offen offset:0
    ds_write_b128 v135, v[56:59] offset:9216
    buffer_load_dwordx4 a[84:87], v212, s[16:19], s49 offen offset:896
    ds_write_b128 v135, v[60:63] offset:10240
    s_add_u32 s49, s48, 157696
Lpage7:
    s_cbranch_execz Lvis1
    buffer_load_dwordx4 a[88:91], v212, s[16:19], s49 offen offset:0
    ds_write_b128 v135, v[64:67] offset:11264
    buffer_load_dwordx4 a[92:95], v212, s[16:19], s49 offen offset:896
    s_waitcnt vmcnt(12)
    v_pk_add_f32 v[144:145], v[144:145], v[146:147]
    v_pk_add_f32 v[148:149], v[148:149], v[150:151]
    v_pk_add_f32 v[144:145], v[144:145], v[148:149]
    v_add_f32 v144, v144, v145
    v_mov_b32 v145, v144
    s_nop 1
    v_permlane32_swap_b32 v144, v145
    v_add_f32 v144, v144, v145
    s_waitcnt lgkmcnt(0)
    s_barrier
    ds_read_b128 v[20:23], v132 offset:0
    ds_read_b128 v[24:27], v132 offset:1024
    ds_read_b128 v[28:31], v132 offset:2048
    ds_read_b128 v[32:35], v132 offset:3072
    ds_read_b128 v[36:39], v132 offset:4096
    ds_read_b128 v[40:43], v132 offset:5120
    ds_read_b128 v[44:47], v132 offset:6144
    ds_read_b128 v[48:51], v132 offset:7168
    ds_read_b128 v[52:55], v132 offset:8192
    ds_read_b128 v[56:59], v132 offset:9216
    ds_read_b128 v[60:63], v132 offset:10240
    ds_read_b128 v[64:67], v132 offset:11264
    s_add_u32 s49, s48, 172032
    buffer_load_dwordx4 a[96:99], v212, s[16:19], s49 offen offset:0
    buffer_load_dwordx4 a[100:103], v212, s[16:19], s49 offen offset:896
    s_add_u32 s49, s48, 186368
    buffer_load_dwordx4 a[104:107], v212, s[16:19], s49 offen offset:0
    buffer_load_dwordx4 a[108:111], v212, s[16:19], s49 offen offset:896
    s_waitcnt lgkmcnt(8)
    v_pk_add_f32 v[4:5], v[4:5], v[20:21]
    v_pk_add_f32 v[6:7], v[6:7], v[22:23]
    v_pk_add_f32 v[8:9], v[8:9], v[24:25]
    v_pk_add_f32 v[10:11], v[10:11], v[26:27]
    v_pk_add_f32 v[12:13], v[12:13], v[28:29]
    v_pk_add_f32 v[14:15], v[14:15], v[30:31]
    v_pk_add_f32 v[16:17], v[16:17], v[32:33]
    v_pk_add_f32 v[18:19], v[18:19], v[34:35]
    s_waitcnt lgkmcnt(4)
    v_pk_add_f32 v[4:5], v[4:5], v[36:37]
    v_pk_add_f32 v[6:7], v[6:7], v[38:39]
    v_pk_add_f32 v[8:9], v[8:9], v[40:41]
    v_pk_add_f32 v[10:11], v[10:11], v[42:43]
    v_pk_add_f32 v[12:13], v[12:13], v[44:45]
    v_pk_add_f32 v[14:15], v[14:15], v[46:47]
    v_pk_add_f32 v[16:17], v[16:17], v[48:49]
    v_pk_add_f32 v[18:19], v[18:19], v[50:51]
    s_waitcnt lgkmcnt(0)
    v_pk_add_f32 v[4:5], v[4:5], v[52:53]
    v_pk_add_f32 v[6:7], v[6:7], v[54:55]
    v_pk_add_f32 v[8:9], v[8:9], v[56:57]
    v_pk_add_f32 v[10:11], v[10:11], v[58:59]
    v_pk_add_f32 v[12:13], v[12:13], v[60:61]
    v_pk_add_f32 v[14:15], v[14:15], v[62:63]
    v_pk_add_f32 v[16:17], v[16:17], v[64:65]
    v_pk_add_f32 v[18:19], v[18:19], v[66:67]
    v_pk_add_f32 v[20:21], v[4:5], v[144:145] op_sel_hi:[1,0] neg_lo:[0,1] neg_hi:[0,1]
    v_pk_add_f32 v[22:23], v[6:7], v[144:145] op_sel_hi:[1,0] neg_lo:[0,1] neg_hi:[0,1]
    v_pk_add_f32 v[24:25], v[8:9], v[144:145] op_sel_hi:[1,0] neg_lo:[0,1] neg_hi:[0,1]
    v_pk_add_f32 v[26:27], v[10:11], v[144:145] op_sel_hi:[1,0] neg_lo:[0,1] neg_hi:[0,1]
    v_pk_add_f32 v[28:29], v[12:13], v[144:145] op_sel_hi:[1,0] neg_lo:[0,1] neg_hi:[0,1]
    v_pk_add_f32 v[30:31], v[14:15], v[144:145] op_sel_hi:[1,0] neg_lo:[0,1] neg_hi:[0,1]
    v_pk_add_f32 v[32:33], v[16:17], v[144:145] op_sel_hi:[1,0] neg_lo:[0,1] neg_hi:[0,1]
    v_pk_add_f32 v[34:35], v[18:19], v[144:145] op_sel_hi:[1,0] neg_lo:[0,1] neg_hi:[0,1]
    v_cvt_pk_bf16_f32 v152, v20, v21
    v_cvt_pk_bf16_f32 v153, v22, v23
    v_cvt_pk_bf16_f32 v154, v24, v25
    v_cvt_pk_bf16_f32 v155, v26, v27
    v_cvt_pk_bf16_f32 v156, v28, v29
    v_cvt_pk_bf16_f32 v157, v30, v31
    v_cvt_pk_bf16_f32 v158, v32, v33
    v_cvt_pk_bf16_f32 v159, v34, v35
    s_lshl_b32 s53, s59, 11
    s_add_u32 s53, s53, 6291456
    buffer_store_dwordx4 v[152:155], v2, s[12:15], s53 offen offset:0 sc1
    buffer_store_dwordx4 v[156:159], v2, s[12:15], s53 offen offset:1024 sc1
    v_mov_b32 v136, 0
    v_mov_b32 v137, 0
    v_mov_b32 v138, 0
    v_mov_b32 v139, 0
    v_dot2c_f32_bf16 v136, s52, v152
    v_dot2c_f32_bf16 v138, v152, v152
    v_dot2c_f32_bf16 v137, s52, v153
    v_dot2c_f32_bf16 v139, v153, v153
    v_dot2c_f32_bf16 v136, s52, v154
    v_dot2c_f32_bf16 v138, v154, v154
    v_dot2c_f32_bf16 v137, s52, v155
    v_dot2c_f32_bf16 v139, v155, v155
    v_dot2c_f32_bf16 v136, s52, v156
    v_dot2c_f32_bf16 v138, v156, v156
    v_dot2c_f32_bf16 v137, s52, v157
    v_dot2c_f32_bf16 v139, v157, v157
    v_dot2c_f32_bf16 v136, s52, v158
    v_dot2c_f32_bf16 v138, v158, v158
    v_dot2c_f32_bf16 v137, s52, v159
    v_dot2c_f32_bf16 v139, v159, v159
    s_nop 1
    v_add_f32 v136, v136, v137
    v_add_f32 v138, v138, v139
    s_nop 1
    v_permlane32_swap_b32 v136, v138
    v_add_f32 v136, v136, v138
    v_and_b32 v137, 31, v1
    v_lshrrev_b32 v138, 5, v1
    v_lshlrev_b32 v138, 2, v138
    v_lshl_add_u32 v137, v137, 3, v138
    s_lshl_b32 s53, s59, 8
    s_add_u32 s53, s53, 8388608
    buffer_store_dword v136, v137, s[12:15], s53 offen sc1
    v_cvt_pk_bf16_f32 v216, v4, v5
    v_cvt_pk_bf16_f32 v217, v6, v7
    v_cvt_pk_bf16_f32 v218, v8, v9
    v_cvt_pk_bf16_f32 v219, v10, v11
    v_cvt_pk_bf16_f32 v220, v12, v13
    v_cvt_pk_bf16_f32 v221, v14, v15
    v_cvt_pk_bf16_f32 v222, v16, v17
    v_cvt_pk_bf16_f32 v223, v18, v19
    s_barrier
    s_mul_i32 s53, s3, 7168
    s_add_u32 s53, s53, 131072
    v_add_u32 v132, s53, v2
    ds_write_b128 v132, a[196:199] offset:0
    ds_write_b128 v132, a[200:203] offset:1024
    ds_write_b128 v132, a[204:207] offset:2048
    ds_write_b128 v132, a[208:211] offset:3072
    ds_write_b128 v132, a[212:215] offset:4096
    ds_write_b128 v132, a[216:219] offset:5120
    ds_write_b128 v132, a[220:223] offset:6144
    s_waitcnt vmcnt(0)
    v_mov_b32 v135, s24
    s_mov_b64 exec, 1
    buffer_store_dword v135, v2, s[12:15], s58 offen sc1
    s_mov_b64 exec, -1
    s_add_u32 s49, s48, 200704
    buffer_load_dwordx4 a[112:115], v212, s[16:19], s49 offen offset:0
    buffer_load_dwordx4 a[116:119], v212, s[16:19], s49 offen offset:896
    s_add_u32 s49, s48, 215040
    buffer_load_dwordx4 a[120:123], v212, s[16:19], s49 offen offset:0
    buffer_load_dwordx4 a[124:127], v212, s[16:19], s49 offen offset:896
    ds_write_b128 v141, a[48:51] offset:0
    ds_write_b128 v141, a[52:55] offset:128
    ds_write_b128 v141, a[56:59] offset:2048
    ds_write_b128 v141, a[60:63] offset:2176
    ds_read_b64_tr_b16 a[48:49], v214 offset:0
    ds_read_b64_tr_b16 a[50:51], v214 offset:1024
    ds_read_b64_tr_b16 a[52:53], v215 offset:0
    ds_read_b64_tr_b16 a[54:55], v215 offset:1024
    ds_read_b64_tr_b16 a[56:57], v214 offset:2048
    ds_read_b64_tr_b16 a[58:59], v214 offset:3072
    ds_read_b64_tr_b16 a[60:61], v215 offset:2048
    ds_read_b64_tr_b16 a[62:63], v215 offset:3072
    ds_write_b128 v141, a[64:67] offset:0
    ds_write_b128 v141, a[68:71] offset:128
    ds_write_b128 v141, a[72:75] offset:2048
    ds_write_b128 v141, a[76:79] offset:2176
    ds_read_b64_tr_b16 a[64:65], v214 offset:0
    ds_read_b64_tr_b16 a[66:67], v214 offset:1024
    ds_read_b64_tr_b16 a[68:69], v215 offset:0
    ds_read_b64_tr_b16 a[70:71], v215 offset:1024
    ds_read_b64_tr_b16 a[72:73], v214 offset:2048
    ds_read_b64_tr_b16 a[74:75], v214 offset:3072
    ds_read_b64_tr_b16 a[76:77], v215 offset:2048
    ds_read_b64_tr_b16 a[78:79], v215 offset:3072
    ds_write_b128 v141, a[80:83] offset:0
    ds_write_b128 v141, a[84:87] offset:128
    ds_write_b128 v141, a[88:91] offset:2048
    ds_write_b128 v141, a[92:95] offset:2176
    ds_read_b64_tr_b16 a[80:81], v214 offset:0
    ds_read_b64_tr_b16 a[82:83], v214 offset:1024
    ds_read_b64_tr_b16 a[84:85], v215 offset:0
    ds_read_b64_tr_b16 a[86:87], v215 offset:1024
    ds_read_b64_tr_b16 a[88:89], v214 offset:2048
    ds_read_b64_tr_b16 a[90:91], v214 offset:3072
    ds_read_b64_tr_b16 a[92:93], v215 offset:2048
    ds_read_b64_tr_b16 a[94:95], v215 offset:3072
    s_branch LD
LnoC:
    s_waitcnt vmcnt(0)
    v_mov_b32 v4, s24
    s_mov_b64 exec, 1
    buffer_store_dword v4, v2, s[12:15], s58 offen sc1
    s_mov_b64 exec, -1
    s_barrier
    s_mul_i32 s53, s3, 7168
    s_add_u32 s53, s53, 131072
    v_add_u32 v5, s53, v2
    ds_write_b128 v5, a[196:199] offset:0
    ds_write_b128 v5, a[200:203] offset:1024
    ds_write_b128 v5, a[204:207] offset:2048
    ds_write_b128 v5, a[208:211] offset:3072
    ds_write_b128 v5, a[212:215] offset:4096
    ds_write_b128 v5, a[216:219] offset:5120
    ds_write_b128 v5, a[220:223] offset:6144
LD:
    s_cmp_lt_u32 s3, 2
    s_cselect_b32 s20, s40, s42
    s_cselect_b32 s21, s41, s43
    s_mov_b32 s22, 1605632
    s_mov_b32 s23, 0x20000
    s_and_b32 s53, s3, 1
    s_mul_i32 s53, s53, 7
    s_add_u32 s53, s53, s0
    s_sub_u32 s1, s53, 14
    s_min_u32 s1, s1, s53
    s_mul_i32 s1, s1, 114688
    s_mul_i32 s56, s30, 224
    s_mul_i32 s57, s3, 14336
    s_lshl_b32 s53, s39, 5
    s_add_u32 s56, s56, s53
    s_lshl_b32 s59, s29, 2
    s_add_u32 s59, s59, s3
    s_lshl_b32 s55, s59, 11
    s_add_u32 s55, s55, 17104896
    v_bfe_u32 v184, v1, 4, 1
    v_lshrrev_b32 v186, 5, v1
    v_bfe_u32 v190, v1, 2, 2
    v_and_b32 v192, 3, v1
    v_lshlrev_b32 v192, 3, v192
    v_xor_b32 v188, v184, v186
    v_lshl_add_u32 v188, v188, 2, v190
    v_lshl_add_u32 v188, v188, 5, v192
    v_mul_u32_u24 v198, 14336, v184
    v_add_u32 v198, v198, v188
    v_add_u32 v198, 131072, v198
    v_lshl_add_u32 v188, v186, 2, v190
    v_lshl_add_u32 v188, v188, 6, v192
    v_mul_u32_u24 v184, 28704, v184
    v_add_u32 v194, v184, v188
    v_xor_b32 v195, 32, v194
    v_add_u32 v196, 57344, v194
    v_add_u32 v197, 57344, v195
    v_and_b32 v184, 31, v1
    v_mul_u32_u24 v186, 1792, v186
    v_lshl_add_u32 v201, v184, 3, v186
    s_mul_i32 s54, s59, 3584
    s_add_u32 s54, s54, 8388608
    s_mul_i32 s58, s59, 28672
    s_add_u32 s58, s58, 6291456
    v_lshrrev_b32 v184, 3, v1
    v_lshrrev_b32 v186, 2, v1
    v_and_b32 v186, 4, v186
    v_and_b32 v188, 7, v1
    v_xor_b32 v186, v186, v188
    v_mul_u32_u24 v184, 896, v184
    v_lshl_add_u32 v0, v186, 4, v184
    s_mul_i32 s100, s3, 401408
    s_lshl_b32 s53, s28, 7
    s_add_u32 s100, s100, s53
    s_mov_b64 exec, 0x3fff
    buffer_load_dword v200, v3, s[12:15], s55 offen sc1
    s_mov_b64 exec, -1
    s_cmp_ge_u32 s31, 28
    s_cbranch_scc1 Lskip4
    ds_write_b128 v141, a[96:99] offset:0
    ds_write_b128 v141, a[100:103] offset:128
    ds_write_b128 v141, a[104:107] offset:2048
    ds_write_b128 v141, a[108:111] offset:2176
    ds_read_b64_tr_b16 a[96:97], v214 offset:0
    ds_read_b64_tr_b16 a[98:99], v214 offset:1024
    ds_read_b64_tr_b16 a[100:101], v215 offset:0
    ds_read_b64_tr_b16 a[102:103], v215 offset:1024
    ds_read_b64_tr_b16 a[104:105], v214 offset:2048
    ds_read_b64_tr_b16 a[106:107], v214 offset:3072
    ds_read_b64_tr_b16 a[108:109], v215 offset:2048
    ds_read_b64_tr_b16 a[110:111], v215 offset:3072
    s_waitcnt vmcnt(1)
    ds_write_b128 v141, a[112:115] offset:0
    ds_write_b128 v141, a[116:119] offset:128
    ds_write_b128 v141, a[120:123] offset:2048
    ds_write_b128 v141, a[124:127] offset:2176
    ds_read_b64_tr_b16 a[112:113], v214 offset:0
    ds_read_b64_tr_b16 a[114:115], v214 offset:1024
    ds_read_b64_tr_b16 a[116:117], v215 offset:0
    ds_read_b64_tr_b16 a[118:119], v215 offset:1024
    ds_read_b64_tr_b16 a[120:121], v214 offset:2048
    ds_read_b64_tr_b16 a[122:123], v214 offset:3072
    ds_read_b64_tr_b16 a[124:125], v215 offset:2048
    ds_read_b64_tr_b16 a[126:127], v215 offset:3072
Lskip4:
    s_waitcnt lgkmcnt(0)
    s_barrier
    s_mov_b64 exec, 0x3fff
    s_mov_b32 s98, 0x200000
    s_waitcnt vmcnt(0)
    v_cmp_ne_u32 vcc, s24, v200
    s_nop 1
    s_cbranch_vccz Lpoll5d
Lpoll5:
    buffer_load_dword v200, v3, s[12:15], s55 offen sc1
    s_sub_u32 s98, s98, 1
    s_waitcnt vmcnt(0)
    s_cbranch_scc1 Lpoll5d
    v_cmp_ne_u32 vcc, s24, v200
    s_nop 1
    s_cbranch_vccnz Lpoll5
Lpoll5d:
    s_mov_b64 exec, -1
    buffer_load_dwordx2 v[164:165], v201, s[12:15], s54 offen offset:0 sc1
    buffer_load_dwordx2 v[166:167], v201, s[12:15], s54 offen offset:256 sc1
    buffer_load_dwordx2 v[168:169], v201, s[12:15], s54 offen offset:512 sc1
    buffer_load_dwordx2 v[170:171], v201, s[12:15], s54 offen offset:768 sc1
    buffer_load_dwordx2 v[172:173], v201, s[12:15], s54 offen offset:1024 sc1
    buffer_load_dwordx2 v[174:175], v201, s[12:15], s54 offen offset:1280 sc1
    buffer_load_dwordx2 v[176:177], v201, s[12:15], s54 offen offset:1536 sc1
    s_lshl_b32 s99, s0, 11
    v_add_u32 v199, s58, v2
    buffer_load_dwordx4 v[4:7], v199, s[12:15], s99 offen offset:0 sc1
    buffer_load_dwordx4 v[8:11], v199, s[12:15], s99 offen offset:1024 sc1
    s_add_u32 s99, s99, 2048
    s_sub_u32 s53, s99, 28672
    s_min_u32 s99, s99, s53
    buffer_load_dwordx4 v[12:15], v199, s[12:15], s99 offen offset:0 sc1
    buffer_load_dwordx4 v[16:19], v199, s[12:15], s99 offen offset:1024 sc1
    s_add_u32 s99, s99, 2048
    s_sub_u32 s53, s99, 28672
    s_min_u32 s99, s99, s53
    buffer_load_dwordx4 v[20:23], v199, s[12:15], s99 offen offset:0 sc1
    buffer_load_dwordx4 v[24:27], v199, s[12:15], s99 offen offset:1024 sc1
    s_add_u32 s99, s99, 2048
    s_sub_u32 s53, s99, 28672
    s_min_u32 s99, s99, s53
    buffer_load_dwordx4 v[28:31], v199, s[12:15], s99 offen offset:0 sc1
    buffer_load_dwordx4 v[32:35], v199, s[12:15], s99 offen offset:1024 sc1
    s_add_u32 s99, s99, 2048
    s_sub_u32 s53, s99, 28672
    s_min_u32 s99, s99, s53
    buffer_load_dwordx4 v[36:39], v199, s[12:15], s99 offen offset:0 sc1
    buffer_load_dwordx4 v[40:43], v199, s[12:15], s99 offen offset:1024 sc1
    s_or_b32 s53, s2, s3
    s_cmp_lg_u32 s53, 0
    s_cselect_b32 s53, 0x40000000, 16777216
    v_mov_b32 v184, s24
    s_mov_b64 exec, 1
    buffer_store_dword v184, v2, s[12:15], s53 offen sc1
    s_mov_b64 exec, -1
    s_cmp_ge_u32 s31, 28
    s_cbranch_scc1 Lskip6
Lskip6:
    s_mul_i32 s58, s59, 112
    s_mul_i32 s53, s30, 7
    s_add_u32 s58, s58, s53
    s_add_u32 s54, s58, s39
    s_add_u32 s58, s58, s38
    s_lshl_b32 s58, s58, 10
    s_add_u32 s58, s58, 9437184
    s_lshl_b32 s54, s54, 10
    s_add_u32 s54, s54, 9437184
    s_add_u32 s49, s58, 4096
    s_lshl_b32 s55, s59, 4
    s_add_u32 s55, s55, s30
    s_lshl_b32 s55, s55, 7
    s_add_u32 s55, s55, 17235968
    ds_read_b64_tr_b16 v[204:205], v194 offset:0
    ds_read_b64_tr_b16 v[206:207], v194 offset:512
    ds_read_b64_tr_b16 v[208:209], v195 offset:0
    ds_read_b64_tr_b16 v[210:211], v195 offset:512
    ds_read_b64_tr_b16 v[224:225], v198 offset:0
    ds_read_b64_tr_b16 v[226:227], v198 offset:256
    ds_read_b64_tr_b16 v[228:229], v194 offset:1024
    ds_read_b64_tr_b16 v[230:231], v194 offset:1536
    ds_read_b64_tr_b16 v[232:233], v195 offset:1024
    ds_read_b64_tr_b16 v[234:235], v195 offset:1536
    ds_read_b64_tr_b16 v[236:237], v198 offset:512
    ds_read_b64_tr_b16 v[238:239], v198 offset:768
    ds_read_b64_tr_b16 v[240:241], v194 offset:2048
    ds_read_b64_tr_b16 v[242:243], v194 offset:2560
    s_waitcnt vmcnt(10)
    s_waitcnt lgkmcnt(6)
    v_mfma_f32_32x32x16_bf16 v[116:131], v[204:207], v[4:7], 0
    ds_read_b64_tr_b16 v[244:245], v195 offset:2048
    ds_read_b64_tr_b16 v[246:247], v195 offset:2560
    v_mfma_f32_32x32x16_bf16 v[132:147], v[208:211], v[4:7], 0
    ds_read_b64_tr_b16 v[248:249], v198 offset:1024
    ds_read_b64_tr_b16 v[250:251], v198 offset:1280
    s_add_u32 s99, s99, 2048
    s_sub_u32 s53, s99, 28672
    s_min_u32 s99, s99, s53
    buffer_load_dwordx4 v[44:47], v199, s[12:15], s99 offen offset:0 sc1
    v_mfma_f32_32x32x16_bf16 v[148:163], v[224:227], v[4:7], 0
    ds_read_b64_tr_b16 v[252:253], v194 offset:3072
    ds_read_b64_tr_b16 v[254:255], v194 offset:3584
    s_waitcnt vmcnt(10)
    v_mfma_f32_32x32x16_bf16 v[116:131], v[228:231], v[8:11], v[116:131]
    ds_read_b64_tr_b16 v[204:205], v195 offset:3072
    ds_read_b64_tr_b16 v[206:207], v195 offset:3584
    s_waitcnt lgkmcnt(6)
    v_mfma_f32_32x32x16_bf16 v[132:147], v[232:235], v[8:11], v[132:147]
    ds_read_b64_tr_b16 v[208:209], v198 offset:1536
    ds_read_b64_tr_b16 v[210:211], v198 offset:1792
    buffer_load_dwordx4 v[48:51], v199, s[12:15], s99 offen offset:1024 sc1
    v_mfma_f32_32x32x16_bf16 v[148:163], v[236:239], v[8:11], v[148:163]
    ds_read_b64_tr_b16 v[224:225], v194 offset:4096
    ds_read_b64_tr_b16 v[226:227], v194 offset:4608
    s_waitcnt vmcnt(10)
    v_mfma_f32_32x32x16_bf16 v[116:131], v[240:243], v[12:15], v[116:131]
    ds_read_b64_tr_b16 v[228:229], v195 offset:4096
    ds_read_b64_tr_b16 v[230:231], v195 offset:4608
    v_mfma_f32_32x32x16_bf16 v[132:147], v[244:247], v[12:15], v[132:147]
    ds_read_b64_tr_b16 v[232:233], v198 offset:2048
    ds_read_b64_tr_b16 v[234:235], v198 offset:2304
    s_add_u32 s99, s99, 2048
    s_sub_u32 s53, s99, 28672
    s_min_u32 s99, s99, s53
    buffer_load_dwordx4 v[52:55], v199, s[12:15], s99 offen offset:0 sc1
    s_waitcnt lgkmcnt(6)
    v_mfma_f32_32x32x16_bf16 v[148:163], v[248:251], v[12:15], v[148:163]
    ds_read_b64_tr_b16 v[236:237], v194 offset:5120
    ds_read_b64_tr_b16 v[238:239], v194 offset:5632
    s_waitcnt vmcnt(10)
    v_mfma_f32_32x32x16_bf16 v[116:131], v[252:255], v[16:19], v[116:131]
    ds_read_b64_tr_b16 v[240:241], v195 offset:5120
    ds_read_b64_tr_b16 v[242:243], v195 offset:5632
    v_mfma_f32_32x32x16_bf16 v[132:147], v[204:207], v[16:19], v[132:147]
    ds_read_b64_tr_b16 v[244:245], v198 offset:2560
    ds_read_b64_tr_b16 v[246:247], v198 offset:2816
    buffer_load_dwordx4 v[56:59], v199, s[12:15], s99 offen offset:1024 sc1
    v_mfma_f32_32x32x16_bf16 v[148:163], v[208:211], v[16:19], v[148:163]
    ds_read_b64_tr_b16 v[248:249], v194 offset:6144
    ds_read_b64_tr_b16 v[250:251], v194 offset:6656
    s_waitcnt vmcnt(10)
    s_waitcnt lgkmcnt(6)
    v_mfma_f32_32x32x16_bf16 v[116:131], v[224:227], v[20:23], v[116:131]
    ds_read_b64_tr_b16 v[252:253], v195 offset:6144
    ds_read_b64_tr_b16 v[254:255], v195 offset:6656
    v_mfma_f32_32x32x16_bf16 v[132:147], v[228:231], v[20:23], v[132:147]
    ds_read_b64_tr_b16 v[204:205], v198 offset:3072
    ds_read_b64_tr_b16 v[206:207], v198 offset:3328
    s_add_u32 s99, s99, 2048
    s_sub_u32 s53, s99, 28672
    s_min_u32 s99, s99, s53
    buffer_load_dwordx4 v[60:63], v199, s[12:15], s99 offen offset:0 sc1
    v_add_f32 v164, v164, v166
    v_mfma_f32_32x32x16_bf16 v[148:163], v[232:235], v[20:23], v[148:163]
    ds_read_b64_tr_b16 v[208:209], v194 offset:7168
    ds_read_b64_tr_b16 v[210:211], v194 offset:7680
    s_waitcnt vmcnt(10)
    v_add_f32 v165, v165, v167
    v_mfma_f32_32x32x16_bf16 v[116:131], v[236:239], v[24:27], v[116:131]
    ds_read_b64_tr_b16 v[224:225], v195 offset:7168
    ds_read_b64_tr_b16 v[226:227], v195 offset:7680
    v_add_f32 v168, v168, v170
    s_waitcnt lgkmcnt(6)
    v_mfma_f32_32x32x16_bf16 v[132:147], v[240:243], v[24:27], v[132:147]
    ds_read_b64_tr_b16 v[228:229], v198 offset:3584
    ds_read_b64_tr_b16 v[230:231], v198 offset:3840
    buffer_load_dwordx4 v[64:67], v199, s[12:15], s99 offen offset:1024 sc1
    v_add_f32 v169, v169, v171
    v_mfma_f32_32x32x16_bf16 v[148:163], v[244:247], v[24:27], v[148:163]
    ds_read_b64_tr_b16 v[232:233], v194 offset:8192
    ds_read_b64_tr_b16 v[234:235], v194 offset:8704
    s_waitcnt vmcnt(10)
    v_add_f32 v172, v172, v174
    v_mfma_f32_32x32x16_bf16 v[116:131], v[248:251], v[28:31], v[116:131]
    ds_read_b64_tr_b16 v[236:237], v195 offset:8192
    ds_read_b64_tr_b16 v[238:239], v195 offset:8704
    v_add_f32 v173, v173, v175
    v_mfma_f32_32x32x16_bf16 v[132:147], v[252:255], v[28:31], v[132:147]
    ds_read_b64_tr_b16 v[240:241], v198 offset:4096
    ds_read_b64_tr_b16 v[242:243], v198 offset:4352
    s_add_u32 s99, s99, 2048
    s_sub_u32 s53, s99, 28672
    s_min_u32 s99, s99, s53
    buffer_load_dwordx4 v[68:71], v199, s[12:15], s99 offen offset:0 sc1
    v_add_f32 v164, v164, v168
    s_waitcnt lgkmcnt(6)
    v_mfma_f32_32x32x16_bf16 v[148:163], v[204:207], v[28:31], v[148:163]
    ds_read_b64_tr_b16 v[244:245], v194 offset:9216
    ds_read_b64_tr_b16 v[246:247], v194 offset:9728
    s_waitcnt vmcnt(10)
    v_add_f32 v165, v165, v169
    v_mfma_f32_32x32x16_bf16 v[116:131], v[208:211], v[32:35], v[116:131]
    ds_read_b64_tr_b16 v[248:249], v195 offset:9216
    ds_read_b64_tr_b16 v[250:251], v195 offset:9728
    v_add_f32 v172, v172, v176
    v_mfma_f32_32x32x16_bf16 v[132:147], v[224:227], v[32:35], v[132:147]
    ds_read_b64_tr_b16 v[252:253], v198 offset:4608
    ds_read_b64_tr_b16 v[254:255], v198 offset:4864
    buffer_load_dwordx4 v[72:75], v199, s[12:15], s99 offen offset:1024 sc1
    v_add_f32 v173, v173, v177
    v_mfma_f32_32x32x16_bf16 v[148:163], v[228:231], v[32:35], v[148:163]
    ds_read_b64_tr_b16 v[204:205], v194 offset:10240
    ds_read_b64_tr_b16 v[206:207], v194 offset:10752
    s_waitcnt vmcnt(10)
    v_add_f32 v164, v164, v172
    s_waitcnt lgkmcnt(6)
    v_mfma_f32_32x32x16_bf16 v[116:131], v[232:235], v[36:39], v[116:131]
    ds_read_b64_tr_b16 v[208:209], v195 offset:10240
    ds_read_b64_tr_b16 v[210:211], v195 offset:10752
    v_add_f32 v165, v165, v173
    v_mfma_f32_32x32x16_bf16 v[132:147], v[236:239], v[36:39], v[132:147]
    ds_read_b64_tr_b16 v[224:225], v198 offset:5120
    ds_read_b64_tr_b16 v[226:227], v198 offset:5376
    s_add_u32 s99, s99, 2048
    s_sub_u32 s53, s99, 28672
    s_min_u32 s99, s99, s53
    buffer_load_dwordx4 v[76:79], v199, s[12:15], s99 offen offset:0 sc1
    v_mov_b32 v184, v164
    v_mfma_f32_32x32x16_bf16 v[148:163], v[240:243], v[36:39], v[148:163]
    ds_read_b64_tr_b16 v[228:229], v194 offset:11264
    ds_read_b64_tr_b16 v[230:231], v194 offset:11776
    s_waitcnt vmcnt(10)
    v_mov_b32 v186, v165
    v_mfma_f32_32x32x16_bf16 v[116:131], v[244:247], v[40:43], v[116:131]
    ds_read_b64_tr_b16 v[232:233], v195 offset:11264
    ds_read_b64_tr_b16 v[234:235], v195 offset:11776
    s_nop 0
    s_waitcnt lgkmcnt(6)
    v_mfma_f32_32x32x16_bf16 v[132:147], v[248:251], v[40:43], v[132:147]
    ds_read_b64_tr_b16 v[236:237], v198 offset:5632
    ds_read_b64_tr_b16 v[238:239], v198 offset:5888
    buffer_load_dwordx4 v[80:83], v199, s[12:15], s99 offen offset:1024 sc1
    v_permlane32_swap_b32 v184, v164
    v_mfma_f32_32x32x16_bf16 v[148:163], v[252:255], v[40:43], v[148:163]
    ds_read_b64_tr_b16 v[240:241], v194 offset:12288
    ds_read_b64_tr_b16 v[242:243], v194 offset:12800
    s_waitcnt vmcnt(9)
    v_permlane32_swap_b32 v186, v165
    v_mfma_f32_32x32x16_bf16 v[116:131], v[204:207], v[44:47], v[116:131]
    ds_read_b64_tr_b16 v[244:245], v195 offset:12288
    ds_read_b64_tr_b16 v[246:247], v195 offset:12800
    v_add_f32 v184, v184, v164
    v_mfma_f32_32x32x16_bf16 v[132:147], v[208:211], v[44:47], v[132:147]
    ds_read_b64_tr_b16 v[248:249], v198 offset:6144
    ds_read_b64_tr_b16 v[250:251], v198 offset:6400
    s_add_u32 s99, s99, 2048
    s_sub_u32 s53, s99, 28672
    s_min_u32 s99, s99, s53
    buffer_load_dwordx4 v[84:87], v199, s[12:15], s99 offen offset:0 sc1
    v_add_f32 v186, v186, v165
    s_waitcnt lgkmcnt(6)
    v_mfma_f32_32x32x16_bf16 v[148:163], v[224:227], v[44:47], v[148:163]
    ds_read_b64_tr_b16 v[252:253], v194 offset:13312
    ds_read_b64_tr_b16 v[254:255], v194 offset:13824
    s_waitcnt vmcnt(9)
    v_mul_f32 v184, 0x3b124925, v184
    v_mfma_f32_32x32x16_bf16 v[116:131], v[228:231], v[48:51], v[116:131]
    ds_read_b64_tr_b16 v[204:205], v195 offset:13312
    ds_read_b64_tr_b16 v[206:207], v195 offset:13824
    v_mul_f32 v186, 0x3b124925, v186
    v_mfma_f32_32x32x16_bf16 v[132:147], v[232:235], v[48:51], v[132:147]
    ds_read_b64_tr_b16 v[208:209], v198 offset:6656
    ds_read_b64_tr_b16 v[210:211], v198 offset:6912
    buffer_load_dwordx4 v[88:91], v199, s[12:15], s99 offen offset:1024 sc1
    v_fma_f32 v186, -v184, v184, v186
    v_mfma_f32_32x32x16_bf16 v[148:163], v[236:239], v[48:51], v[148:163]
    ds_read_b64_tr_b16 v[224:225], v194 offset:14336
    ds_read_b64_tr_b16 v[226:227], v194 offset:14848
    s_waitcnt vmcnt(9)
    v_max_f32 v186, 0, v186
    s_waitcnt lgkmcnt(6)
    v_mfma_f32_32x32x16_bf16 v[116:131], v[240:243], v[52:55], v[116:131]
    ds_read_b64_tr_b16 v[228:229], v195 offset:14336
    ds_read_b64_tr_b16 v[230:231], v195 offset:14848
    v_add_f32 v193, 0x3727c5ac, v186
    v_mfma_f32_32x32x16_bf16 v[132:147], v[244:247], v[52:55], v[132:147]
    ds_read_b64_tr_b16 v[232:233], v198 offset:7168
    ds_read_b64_tr_b16 v[234:235], v198 offset:7424
    s_add_u32 s99, s99, 2048
    s_sub_u32 s53, s99, 28672
    s_min_u32 s99, s99, s53
    buffer_load_dwordx4 v[92:95], v199, s[12:15], s99 offen offset:0 sc1
    v_rsq_f32 v192, v193
    v_mfma_f32_32x32x16_bf16 v[148:163], v[248:251], v[52:55], v[148:163]
    ds_read_b64_tr_b16 v[236:237], v194 offset:15360
    ds_read_b64_tr_b16 v[238:239], v194 offset:15872
    s_waitcnt vmcnt(9)
    s_nop 0
    v_mfma_f32_32x32x16_bf16 v[116:131], v[252:255], v[56:59], v[116:131]
    ds_read_b64_tr_b16 v[240:241], v195 offset:15360
    ds_read_b64_tr_b16 v[242:243], v195 offset:15872
    v_mul_f32 v192, 0xbfb8aa3b, v192
    s_waitcnt lgkmcnt(6)
    v_mfma_f32_32x32x16_bf16 v[132:147], v[204:207], v[56:59], v[132:147]
    ds_read_b64_tr_b16 v[244:245], v198 offset:7680
    ds_read_b64_tr_b16 v[246:247], v198 offset:7936
    buffer_load_dwordx4 v[96:99], v199, s[12:15], s99 offen offset:1024 sc1
    v_mfma_f32_32x32x16_bf16 v[148:163], v[208:211], v[56:59], v[148:163]
    ds_read_b64_tr_b16 v[248:249], v194 offset:16384
    ds_read_b64_tr_b16 v[250:251], v194 offset:16896
    s_waitcnt vmcnt(9)
    v_mfma_f32_32x32x16_bf16 v[116:131], v[224:227], v[60:63], v[116:131]
    ds_read_b64_tr_b16 v[252:253], v195 offset:16384
    ds_read_b64_tr_b16 v[254:255], v195 offset:16896
    v_mfma_f32_32x32x16_bf16 v[132:147], v[228:231], v[60:63], v[132:147]
    ds_read_b64_tr_b16 v[204:205], v198 offset:8192
    ds_read_b64_tr_b16 v[206:207], v198 offset:8448
    s_add_u32 s99, s99, 2048
    s_sub_u32 s53, s99, 28672
    s_min_u32 s99, s99, s53
    buffer_load_dwordx4 v[100:103], v199, s[12:15], s99 offen offset:0 sc1
    s_waitcnt lgkmcnt(6)
    v_mfma_f32_32x32x16_bf16 v[148:163], v[232:235], v[60:63], v[148:163]
    ds_read_b64_tr_b16 v[208:209], v194 offset:17408
    ds_read_b64_tr_b16 v[210:211], v194 offset:17920
    s_waitcnt vmcnt(9)
    v_mfma_f32_32x32x16_bf16 v[116:131], v[236:239], v[64:67], v[116:131]
    ds_read_b64_tr_b16 v[224:225], v195 offset:17408
    ds_read_b64_tr_b16 v[226:227], v195 offset:17920
    v_mfma_f32_32x32x16_bf16 v[132:147], v[240:243], v[64:67], v[132:147]
    ds_read_b64_tr_b16 v[228:229], v198 offset:8704
    ds_read_b64_tr_b16 v[230:231], v198 offset:8960
    buffer_load_dwordx4 v[104:107], v199, s[12:15], s99 offen offset:1024 sc1
    v_mfma_f32_32x32x16_bf16 v[148:163], v[244:247], v[64:67], v[148:163]
    ds_read_b64_tr_b16 v[232:233], v194 offset:18432
Lpage8:
    s_cbranch_execz Lvis1
    ds_read_b64_tr_b16 v[234:235], v194 offset:18944
    s_waitcnt vmcnt(9)
    s_waitcnt lgkmcnt(6)
    v_mfma_f32_32x32x16_bf16 v[116:131], v[248:251], v[68:71], v[116:131]
    ds_read_b64_tr_b16 v[236:237], v195 offset:18432
    ds_read_b64_tr_b16 v[238:239], v195 offset:18944
    v_mfma_f32_32x32x16_bf16 v[132:147], v[252:255], v[68:71], v[132:147]
    ds_read_b64_tr_b16 v[240:241], v198 offset:9216
    ds_read_b64_tr_b16 v[242:243], v198 offset:9472
    s_add_u32 s99, s99, 2048
    s_sub_u32 s53, s99, 28672
    s_min_u32 s99, s99, s53
    buffer_load_dwordx4 v[108:111], v199, s[12:15], s99 offen offset:0 sc1
    v_mfma_f32_32x32x16_bf16 v[148:163], v[204:207], v[68:71], v[148:163]
    ds_read_b64_tr_b16 v[244:245], v194 offset:19456
    ds_read_b64_tr_b16 v[246:247], v194 offset:19968
    s_waitcnt vmcnt(9)
    v_mfma_f32_32x32x16_bf16 v[116:131], v[208:211], v[72:75], v[116:131]
    ds_read_b64_tr_b16 v[248:249], v195 offset:19456
    ds_read_b64_tr_b16 v[250:251], v195 offset:19968
    s_waitcnt lgkmcnt(6)
    v_mfma_f32_32x32x16_bf16 v[132:147], v[224:227], v[72:75], v[132:147]
    ds_read_b64_tr_b16 v[252:253], v198 offset:9728
    ds_read_b64_tr_b16 v[254:255], v198 offset:9984
    buffer_load_dwordx4 v[112:115], v199, s[12:15], s99 offen offset:1024 sc1
    v_mfma_f32_32x32x16_bf16 v[148:163], v[228:231], v[72:75], v[148:163]
    ds_read_b64_tr_b16 v[204:205], v194 offset:20480
    ds_read_b64_tr_b16 v[206:207], v194 offset:20992
    s_waitcnt vmcnt(9)
    v_mfma_f32_32x32x16_bf16 v[116:131], v[232:235], v[76:79], v[116:131]
    ds_read_b64_tr_b16 v[208:209], v195 offset:20480
    ds_read_b64_tr_b16 v[210:211], v195 offset:20992
    v_mfma_f32_32x32x16_bf16 v[132:147], v[236:239], v[76:79], v[132:147]
    ds_read_b64_tr_b16 v[224:225], v198 offset:10240
    ds_read_b64_tr_b16 v[226:227], v198 offset:10496
    s_waitcnt lgkmcnt(6)
    v_mfma_f32_32x32x16_bf16 v[148:163], v[240:243], v[76:79], v[148:163]
    ds_read_b64_tr_b16 v[228:229], v194 offset:21504
    ds_read_b64_tr_b16 v[230:231], v194 offset:22016
    s_waitcnt vmcnt(8)
    v_mfma_f32_32x32x16_bf16 v[116:131], v[244:247], v[80:83], v[116:131]
    ds_read_b64_tr_b16 v[232:233], v195 offset:21504
    ds_read_b64_tr_b16 v[234:235], v195 offset:22016
    v_mfma_f32_32x32x16_bf16 v[132:147], v[248:251], v[80:83], v[132:147]
    ds_read_b64_tr_b16 v[236:237], v198 offset:10752
    ds_read_b64_tr_b16 v[238:239], v198 offset:11008
    v_mfma_f32_32x32x16_bf16 v[148:163], v[252:255], v[80:83], v[148:163]
    ds_read_b64_tr_b16 v[240:241], v194 offset:22528
    ds_read_b64_tr_b16 v[242:243], v194 offset:23040
    s_waitcnt vmcnt(7)
    s_waitcnt lgkmcnt(6)
    v_mfma_f32_32x32x16_bf16 v[116:131], v[204:207], v[84:87], v[116:131]
    ds_read_b64_tr_b16 v[244:245], v195 offset:22528
    ds_read_b64_tr_b16 v[246:247], v195 offset:23040
    v_mfma_f32_32x32x16_bf16 v[132:147], v[208:211], v[84:87], v[132:147]
    ds_read_b64_tr_b16 v[248:249], v198 offset:11264
    ds_read_b64_tr_b16 v[250:251], v198 offset:11520
    v_mfma_f32_32x32x16_bf16 v[148:163], v[224:227], v[84:87], v[148:163]
    ds_read_b64_tr_b16 v[252:253], v194 offset:23552
    ds_read_b64_tr_b16 v[254:255], v194 offset:24064
    s_waitcnt vmcnt(6)
    v_mfma_f32_32x32x16_bf16 v[116:131], v[228:231], v[88:91], v[116:131]
    ds_read_b64_tr_b16 v[204:205], v195 offset:23552
    ds_read_b64_tr_b16 v[206:207], v195 offset:24064
    s_waitcnt lgkmcnt(6)
    v_mfma_f32_32x32x16_bf16 v[132:147], v[232:235], v[88:91], v[132:147]
    ds_read_b64_tr_b16 v[208:209], v198 offset:11776
    ds_read_b64_tr_b16 v[210:211], v198 offset:12032
    v_mfma_f32_32x32x16_bf16 v[148:163], v[236:239], v[88:91], v[148:163]
    ds_read_b64_tr_b16 v[224:225], v194 offset:24576
    ds_read_b64_tr_b16 v[226:227], v194 offset:25088
    s_waitcnt vmcnt(5)
    v_mfma_f32_32x32x16_bf16 v[116:131], v[240:243], v[92:95], v[116:131]
    ds_read_b64_tr_b16 v[228:229], v195 offset:24576
    ds_read_b64_tr_b16 v[230:231], v195 offset:25088
    v_mfma_f32_32x32x16_bf16 v[132:147], v[244:247], v[92:95], v[132:147]
    ds_read_b64_tr_b16 v[232:233], v198 offset:12288
    ds_read_b64_tr_b16 v[234:235], v198 offset:12544
    s_waitcnt lgkmcnt(6)
    v_mfma_f32_32x32x16_bf16 v[148:163], v[248:251], v[92:95], v[148:163]
    ds_read_b64_tr_b16 v[236:237], v194 offset:25600
    ds_read_b64_tr_b16 v[238:239], v194 offset:26112
    s_waitcnt vmcnt(4)
    v_mfma_f32_32x32x16_bf16 v[116:131], v[252:255], v[96:99], v[116:131]
    ds_read_b64_tr_b16 v[240:241], v195 offset:25600
    ds_read_b64_tr_b16 v[242:243], v195 offset:26112
    v_mfma_f32_32x32x16_bf16 v[132:147], v[204:207], v[96:99], v[132:147]
    ds_read_b64_tr_b16 v[244:245], v198 offset:12800
    ds_read_b64_tr_b16 v[246:247], v198 offset:13056
    v_mfma_f32_32x32x16_bf16 v[148:163], v[208:211], v[96:99], v[148:163]
    ds_read_b64_tr_b16 v[248:249], v194 offset:26624
    ds_read_b64_tr_b16 v[250:251], v194 offset:27136
    s_waitcnt vmcnt(3)
    s_waitcnt lgkmcnt(6)
    v_mfma_f32_32x32x16_bf16 v[116:131], v[224:227], v[100:103], v[116:131]
    ds_read_b64_tr_b16 v[252:253], v195 offset:26624
    ds_read_b64_tr_b16 v[254:255], v195 offset:27136
    v_mfma_f32_32x32x16_bf16 v[132:147], v[228:231], v[100:103], v[132:147]
    ds_read_b64_tr_b16 v[204:205], v198 offset:13312
    ds_read_b64_tr_b16 v[206:207], v198 offset:13568
    v_mfma_f32_32x32x16_bf16 v[148:163], v[232:235], v[100:103], v[148:163]
    ds_read_b64_tr_b16 v[208:209], v194 offset:27648
    ds_read_b64_tr_b16 v[210:211], v194 offset:28160
    s_waitcnt vmcnt(2)
    v_mfma_f32_32x32x16_bf16 v[116:131], v[236:239], v[104:107], v[116:131]
    ds_read_b64_tr_b16 v[224:225], v195 offset:27648
    ds_read_b64_tr_b16 v[226:227], v195 offset:28160
    s_waitcnt lgkmcnt(6)
    v_mfma_f32_32x32x16_bf16 v[132:147], v[240:243], v[104:107], v[132:147]
    ds_read_b64_tr_b16 v[228:229], v198 offset:13824
    ds_read_b64_tr_b16 v[230:231], v198 offset:14080
    v_mfma_f32_32x32x16_bf16 v[148:163], v[244:247], v[104:107], v[148:163]
    ds_read_b64_tr_b16 v[232:233], v196 offset:0
    ds_read_b64_tr_b16 v[234:235], v196 offset:512
    s_waitcnt vmcnt(1)
    v_mfma_f32_32x32x16_bf16 v[116:131], v[248:251], v[108:111], v[116:131]
    ds_read_b64_tr_b16 v[236:237], v196 offset:1024
    ds_read_b64_tr_b16 v[238:239], v196 offset:1536
    v_mfma_f32_32x32x16_bf16 v[132:147], v[252:255], v[108:111], v[132:147]
    ds_read_b64_tr_b16 v[240:241], v196 offset:2048
    ds_read_b64_tr_b16 v[242:243], v196 offset:2560
    s_waitcnt lgkmcnt(6)
    v_mfma_f32_32x32x16_bf16 v[148:163], v[204:207], v[108:111], v[148:163]
    ds_read_b64_tr_b16 v[244:245], v196 offset:3072
    ds_read_b64_tr_b16 v[246:247], v196 offset:3584
    s_waitcnt vmcnt(0)
    v_mfma_f32_32x32x16_bf16 v[116:131], v[208:211], v[112:115], v[116:131]
    ds_read_b64_tr_b16 v[248:249], v196 offset:4096
    ds_read_b64_tr_b16 v[250:251], v196 offset:4608
    v_mfma_f32_32x32x16_bf16 v[132:147], v[224:227], v[112:115], v[132:147]
    ds_read_b64_tr_b16 v[252:253], v196 offset:5120
    ds_read_b64_tr_b16 v[254:255], v196 offset:5632
    v_mfma_f32_32x32x16_bf16 v[148:163], v[228:231], v[112:115], v[148:163]
    ds_read_b64_tr_b16 v[204:205], v196 offset:6144
    ds_read_b64_tr_b16 v[206:207], v196 offset:6656
    s_barrier
    s_mov_b32 s16, s44
    s_mov_b32 s17, s45
    s_mov_b32 s18, 1605632
    s_mov_b32 s19, 0x20000
    s_waitcnt lgkmcnt(6)
    v_mfma_f32_32x32x16_bf16 v[164:179], v[232:235], v[4:7], 0
    ds_read_b64_tr_b16 v[208:209], v196 offset:7168
    ds_read_b64_tr_b16 v[210:211], v196 offset:7680
    s_add_u32 m0, s57, 0
    s_add_u32 s53, s56, s1
    buffer_load_dwordx4 v213, s[20:23], s53 offen lds
    v_mfma_f32_32x32x16_bf16 v[164:179], v[236:239], v[8:11], v[164:179]
    ds_read_b64_tr_b16 v[224:225], v196 offset:8192
    ds_read_b64_tr_b16 v[226:227], v196 offset:8704
    v_mfma_f32_32x32x16_bf16 v[164:179], v[240:243], v[12:15], v[164:179]
    ds_read_b64_tr_b16 v[228:229], v196 offset:9216
    ds_read_b64_tr_b16 v[230:231], v196 offset:9728
    v_mul_f32 v184, v192, v116
    v_mul_f32 v185, v192, v117
    v_mul_f32 v186, v192, v118
    s_add_u32 m0, s57, 1024
    s_add_u32 s53, s56, s1
    s_add_u32 s53, s53, 57344
    buffer_load_dwordx4 v213, s[20:23], s53 offen lds
    s_add_u32 s1, s1, 114688
    s_sub_u32 s53, s1, 1605632
    s_min_u32 s1, s1, s53
    v_mfma_f32_32x32x16_bf16 v[164:179], v[244:247], v[16:19], v[164:179]
    ds_read_b64_tr_b16 v[232:233], v196 offset:10240
    ds_read_b64_tr_b16 v[234:235], v196 offset:10752
    v_mul_f32 v187, v192, v119
    v_mul_f32 v188, v192, v120
    v_mul_f32 v189, v192, v121
    s_waitcnt lgkmcnt(6)
    v_mfma_f32_32x32x16_bf16 v[164:179], v[248:251], v[20:23], v[164:179]
    ds_read_b64_tr_b16 v[236:237], v196 offset:11264
    ds_read_b64_tr_b16 v[238:239], v196 offset:11776
    v_mul_f32 v190, v192, v122
    v_mul_f32 v191, v192, v123
    v_exp_f32 v184, v184
    s_add_u32 m0, s57, 2048
    s_add_u32 s53, s56, s1
    buffer_load_dwordx4 v213, s[20:23], s53 offen lds
    v_mfma_f32_32x32x16_bf16 v[164:179], v[252:255], v[24:27], v[164:179]
    ds_read_b64_tr_b16 v[240:241], v196 offset:12288
    ds_read_b64_tr_b16 v[242:243], v196 offset:12800
    v_exp_f32 v185, v185
    v_exp_f32 v186, v186
    v_exp_f32 v187, v187
    v_mfma_f32_32x32x16_bf16 v[164:179], v[204:207], v[28:31], v[164:179]
    ds_read_b64_tr_b16 v[244:245], v196 offset:13312
    ds_read_b64_tr_b16 v[246:247], v196 offset:13824
    v_exp_f32 v188, v188
    v_exp_f32 v189, v189
    v_exp_f32 v190, v190
    s_add_u32 m0, s57, 3072
    s_add_u32 s53, s56, s1
    s_add_u32 s53, s53, 57344
    buffer_load_dwordx4 v213, s[20:23], s53 offen lds
    s_add_u32 s1, s1, 114688
    s_sub_u32 s53, s1, 1605632
    s_min_u32 s1, s1, s53
    v_mfma_f32_32x32x16_bf16 v[164:179], v[208:211], v[32:35], v[164:179]
    ds_read_b64_tr_b16 v[248:249], v196 offset:14336
    ds_read_b64_tr_b16 v[250:251], v196 offset:14848
    v_exp_f32 v191, v191
    v_mul_f32 v116, v116, v124
    v_mul_f32 v117, v117, v125
    s_waitcnt lgkmcnt(6)
    v_mfma_f32_32x32x16_bf16 v[164:179], v[224:227], v[36:39], v[164:179]
    ds_read_b64_tr_b16 v[252:253], v196 offset:15360
    ds_read_b64_tr_b16 v[254:255], v196 offset:15872
    v_mul_f32 v118, v118, v126
    v_mul_f32 v119, v119, v127
    v_mul_f32 v120, v120, v128
    s_add_u32 m0, s57, 4096
    s_add_u32 s53, s56, s1
    buffer_load_dwordx4 v213, s[20:23], s53 offen lds
    v_mfma_f32_32x32x16_bf16 v[164:179], v[228:231], v[40:43], v[164:179]
    ds_read_b64_tr_b16 v[204:205], v196 offset:16384
    ds_read_b64_tr_b16 v[206:207], v196 offset:16896
    v_mul_f32 v121, v121, v129
    v_mul_f32 v122, v122, v130
    v_mul_f32 v123, v123, v131
    v_mfma_f32_32x32x16_bf16 v[164:179], v[232:235], v[44:47], v[164:179]
    ds_read_b64_tr_b16 v[208:209], v196 offset:17408
    ds_read_b64_tr_b16 v[210:211], v196 offset:17920
    v_fma_f32 v184, v184, v193, v193
    v_fma_f32 v185, v185, v193, v193
    v_fma_f32 v186, v186, v193, v193
    s_add_u32 m0, s57, 5120
    s_add_u32 s53, s56, s1
    s_add_u32 s53, s53, 57344
    buffer_load_dwordx4 v213, s[20:23], s53 offen lds
    s_add_u32 s1, s1, 114688
    s_sub_u32 s53, s1, 1605632
    s_min_u32 s1, s1, s53
    v_mfma_f32_32x32x16_bf16 v[164:179], v[236:239], v[48:51], v[164:179]
    ds_read_b64_tr_b16 v[224:225], v196 offset:18432
    ds_read_b64_tr_b16 v[226:227], v196 offset:18944
    v_fma_f32 v187, v187, v193, v193
    v_fma_f32 v188, v188, v193, v193
    v_fma_f32 v189, v189, v193, v193
    s_waitcnt lgkmcnt(6)
    v_mfma_f32_32x32x16_bf16 v[164:179], v[240:243], v[52:55], v[164:179]
    ds_read_b64_tr_b16 v[228:229], v196 offset:19456
    ds_read_b64_tr_b16 v[230:231], v196 offset:19968
    v_fma_f32 v190, v190, v193, v193
    v_fma_f32 v191, v191, v193, v193
    v_rcp_f32 v184, v184
    s_add_u32 m0, s57, 6144
    s_add_u32 s53, s56, s1
    buffer_load_dwordx4 v213, s[20:23], s53 offen lds
    v_mfma_f32_32x32x16_bf16 v[164:179], v[244:247], v[56:59], v[164:179]
    ds_read_b64_tr_b16 v[232:233], v196 offset:20480
    ds_read_b64_tr_b16 v[234:235], v196 offset:20992
    v_rcp_f32 v185, v185
    v_rcp_f32 v186, v186
    v_rcp_f32 v187, v187
    v_mfma_f32_32x32x16_bf16 v[164:179], v[248:251], v[60:63], v[164:179]
    ds_read_b64_tr_b16 v[236:237], v196 offset:21504
    ds_read_b64_tr_b16 v[238:239], v196 offset:22016
    v_rcp_f32 v188, v188
    v_rcp_f32 v189, v189
    v_rcp_f32 v190, v190
    s_add_u32 m0, s57, 7168
    s_add_u32 s53, s56, s1
    s_add_u32 s53, s53, 57344
    buffer_load_dwordx4 v213, s[20:23], s53 offen lds
    s_add_u32 s1, s1, 114688
    s_sub_u32 s53, s1, 1605632
    s_min_u32 s1, s1, s53
    v_mfma_f32_32x32x16_bf16 v[164:179], v[252:255], v[64:67], v[164:179]
    ds_read_b64_tr_b16 v[240:241], v196 offset:22528
    ds_read_b64_tr_b16 v[242:243], v196 offset:23040
    v_rcp_f32 v191, v191
    v_mul_f32 v116, v116, v184
    v_mul_f32 v117, v117, v185
    s_waitcnt lgkmcnt(6)
    v_mfma_f32_32x32x16_bf16 v[164:179], v[204:207], v[68:71], v[164:179]
    ds_read_b64_tr_b16 v[244:245], v196 offset:23552
    ds_read_b64_tr_b16 v[246:247], v196 offset:24064
    v_mul_f32 v118, v118, v186
    v_mul_f32 v119, v119, v187
    v_mul_f32 v120, v120, v188
    s_add_u32 m0, s57, 8192
    s_add_u32 s53, s56, s1
    buffer_load_dwordx4 v213, s[20:23], s53 offen lds
    v_mfma_f32_32x32x16_bf16 v[164:179], v[208:211], v[72:75], v[164:179]
    ds_read_b64_tr_b16 v[248:249], v196 offset:24576
    ds_read_b64_tr_b16 v[250:251], v196 offset:25088
    v_mul_f32 v121, v121, v189
    v_mul_f32 v122, v122, v190
    v_mul_f32 v123, v123, v191
    v_mfma_f32_32x32x16_bf16 v[164:179], v[224:227], v[76:79], v[164:179]
    ds_read_b64_tr_b16 v[252:253], v196 offset:25600
    ds_read_b64_tr_b16 v[254:255], v196 offset:26112
    v_cvt_pk_bf16_f32 v180, v116, v117
    v_cvt_pk_bf16_f32 v181, v118, v119
    v_cvt_pk_bf16_f32 v182, v120, v121
    s_add_u32 m0, s57, 9216
    s_add_u32 s53, s56, s1
    s_add_u32 s53, s53, 57344
    buffer_load_dwordx4 v213, s[20:23], s53 offen lds
    s_add_u32 s1, s1, 114688
    s_sub_u32 s53, s1, 1605632
    s_min_u32 s1, s1, s53
    v_mfma_f32_32x32x16_bf16 v[164:179], v[228:231], v[80:83], v[164:179]
    ds_read_b64_tr_b16 v[204:205], v196 offset:26624
    ds_read_b64_tr_b16 v[206:207], v196 offset:27136
    v_cvt_pk_bf16_f32 v183, v122, v123
    buffer_store_dwordx4 v[180:183], v2, s[12:15], s58 offen offset:0 sc1
    v_mul_f32 v184, v192, v132
    s_waitcnt lgkmcnt(6)
    v_mfma_f32_32x32x16_bf16 v[164:179], v[232:235], v[84:87], v[164:179]
    ds_read_b64_tr_b16 v[208:209], v196 offset:27648
    ds_read_b64_tr_b16 v[210:211], v196 offset:28160
    v_mul_f32 v185, v192, v133
    v_mul_f32 v186, v192, v134
    s_add_u32 m0, s57, 10240
    s_add_u32 s53, s56, s1
    buffer_load_dwordx4 v213, s[20:23], s53 offen lds
    v_mfma_f32_32x32x16_bf16 v[164:179], v[236:239], v[88:91], v[164:179]
    ds_read_b64_tr_b16 v[224:225], v197 offset:0
    ds_read_b64_tr_b16 v[226:227], v197 offset:512
    v_mul_f32 v187, v192, v135
    v_mul_f32 v188, v192, v136
    v_mul_f32 v189, v192, v137
    v_mfma_f32_32x32x16_bf16 v[164:179], v[240:243], v[92:95], v[164:179]
    ds_read_b64_tr_b16 v[228:229], v197 offset:1024
    ds_read_b64_tr_b16 v[230:231], v197 offset:1536
    v_mul_f32 v190, v192, v138
    v_mul_f32 v191, v192, v139
    v_exp_f32 v184, v184
    s_add_u32 m0, s57, 11264
    s_add_u32 s53, s56, s1
    s_add_u32 s53, s53, 57344
    buffer_load_dwordx4 v213, s[20:23], s53 offen lds
    s_add_u32 s1, s1, 114688
    s_sub_u32 s53, s1, 1605632
    s_min_u32 s1, s1, s53
    v_mfma_f32_32x32x16_bf16 v[164:179], v[244:247], v[96:99], v[164:179]
    ds_read_b64_tr_b16 v[232:233], v197 offset:2048
    ds_read_b64_tr_b16 v[234:235], v197 offset:2560
    v_exp_f32 v185, v185
    v_exp_f32 v186, v186
    v_exp_f32 v187, v187
    s_waitcnt lgkmcnt(6)
    v_mfma_f32_32x32x16_bf16 v[164:179], v[248:251], v[100:103], v[164:179]
    ds_read_b64_tr_b16 v[236:237], v197 offset:3072
    ds_read_b64_tr_b16 v[238:239], v197 offset:3584
    v_exp_f32 v188, v188
    v_exp_f32 v189, v189
    v_exp_f32 v190, v190
    s_add_u32 m0, s57, 12288
    s_add_u32 s53, s56, s1
    buffer_load_dwordx4 v213, s[20:23], s53 offen lds
    v_mfma_f32_32x32x16_bf16 v[164:179], v[252:255], v[104:107], v[164:179]
    ds_read_b64_tr_b16 v[240:241], v197 offset:4096
    ds_read_b64_tr_b16 v[242:243], v197 offset:4608
    v_exp_f32 v191, v191
    v_mul_f32 v132, v132, v140
    v_mul_f32 v133, v133, v141
    v_mfma_f32_32x32x16_bf16 v[164:179], v[204:207], v[108:111], v[164:179]
    ds_read_b64_tr_b16 v[244:245], v197 offset:5120
    ds_read_b64_tr_b16 v[246:247], v197 offset:5632
    v_mul_f32 v134, v134, v142
    v_mul_f32 v135, v135, v143
    v_mul_f32 v136, v136, v144
    s_add_u32 m0, s57, 13312
    s_add_u32 s53, s56, s1
    s_add_u32 s53, s53, 57344
    buffer_load_dwordx4 v213, s[20:23], s53 offen lds
    s_add_u32 s1, s1, 114688
    s_sub_u32 s53, s1, 1605632
    s_min_u32 s1, s1, s53
    v_mfma_f32_32x32x16_bf16 v[164:179], v[208:211], v[112:115], v[164:179]
    ds_read_b64_tr_b16 v[248:249], v197 offset:6144
    ds_read_b64_tr_b16 v[250:251], v197 offset:6656
    v_mul_f32 v137, v137, v145
    v_mul_f32 v138, v138, v146
    v_mul_f32 v139, v139, v147
    s_waitcnt lgkmcnt(6)
    v_mfma_f32_32x32x16_bf16 v[116:131], v[224:227], v[4:7], 0
    ds_read_b64_tr_b16 v[252:253], v197 offset:7168
    ds_read_b64_tr_b16 v[254:255], v197 offset:7680
    v_fma_f32 v184, v184, v193, v193
    v_fma_f32 v185, v185, v193, v193
    v_fma_f32 v186, v186, v193, v193
    s_mul_i32 s101, s3, 12288
    s_add_u32 m0, s101, 114688
    s_add_u32 s53, s100, 229376
    buffer_load_dwordx4 v0, s[16:19], s53 offen offset:0 lds
    v_mfma_f32_32x32x16_bf16 v[116:131], v[228:231], v[8:11], v[116:131]
    ds_read_b64_tr_b16 v[204:205], v197 offset:8192
    ds_read_b64_tr_b16 v[206:207], v197 offset:8704
    v_fma_f32 v187, v187, v193, v193
    v_fma_f32 v188, v188, v193, v193
    v_fma_f32 v189, v189, v193, v193
    v_mfma_f32_32x32x16_bf16 v[116:131], v[232:235], v[12:15], v[116:131]
    ds_read_b64_tr_b16 v[208:209], v197 offset:9216
    ds_read_b64_tr_b16 v[210:211], v197 offset:9728
    v_fma_f32 v190, v190, v193, v193
    v_fma_f32 v191, v191, v193, v193
    v_rcp_f32 v184, v184
    s_add_u32 s53, s100, 235520
    buffer_load_dwordx4 v0, s[16:19], s53 offen offset:1024 lds
    v_mfma_f32_32x32x16_bf16 v[116:131], v[236:239], v[16:19], v[116:131]
    ds_read_b64_tr_b16 v[224:225], v197 offset:10240
    ds_read_b64_tr_b16 v[226:227], v197 offset:10752
    v_rcp_f32 v185, v185
    v_rcp_f32 v186, v186
    v_rcp_f32 v187, v187
    s_waitcnt lgkmcnt(6)
    v_mfma_f32_32x32x16_bf16 v[116:131], v[240:243], v[20:23], v[116:131]
    ds_read_b64_tr_b16 v[228:229], v197 offset:11264
    ds_read_b64_tr_b16 v[230:231], v197 offset:11776
    v_rcp_f32 v188, v188
    v_rcp_f32 v189, v189
    v_rcp_f32 v190, v190
    s_add_u32 s53, s100, 241664
    buffer_load_dwordx4 v0, s[16:19], s53 offen offset:2048 lds
    v_mfma_f32_32x32x16_bf16 v[116:131], v[244:247], v[24:27], v[116:131]
    ds_read_b64_tr_b16 v[232:233], v197 offset:12288
    ds_read_b64_tr_b16 v[234:235], v197 offset:12800
    v_rcp_f32 v191, v191
    v_mul_f32 v132, v132, v184
    v_mul_f32 v133, v133, v185
    v_mfma_f32_32x32x16_bf16 v[116:131], v[248:251], v[28:31], v[116:131]
    ds_read_b64_tr_b16 v[236:237], v197 offset:13312
    ds_read_b64_tr_b16 v[238:239], v197 offset:13824
    v_mul_f32 v134, v134, v186
    v_mul_f32 v135, v135, v187
    v_mul_f32 v136, v136, v188
    s_add_u32 s53, s100, 247808
    buffer_load_dwordx4 v0, s[16:19], s53 offen offset:3072 lds
    v_mfma_f32_32x32x16_bf16 v[116:131], v[252:255], v[32:35], v[116:131]
    ds_read_b64_tr_b16 v[240:241], v197 offset:14336
    ds_read_b64_tr_b16 v[242:243], v197 offset:14848
    v_mul_f32 v137, v137, v189
    v_mul_f32 v138, v138, v190
    v_mul_f32 v139, v139, v191
    s_waitcnt lgkmcnt(6)
    v_mfma_f32_32x32x16_bf16 v[116:131], v[204:207], v[36:39], v[116:131]
    ds_read_b64_tr_b16 v[244:245], v197 offset:15360
    ds_read_b64_tr_b16 v[246:247], v197 offset:15872
    v_cvt_pk_bf16_f32 v180, v132, v133
    v_cvt_pk_bf16_f32 v181, v134, v135
    v_cvt_pk_bf16_f32 v182, v136, v137
    s_mul_i32 s101, s3, 12288
    s_add_u32 m0, s101, 118784
    s_add_u32 s53, s100, 258048
    buffer_load_dwordx4 v0, s[16:19], s53 offen offset:0 lds
    v_mfma_f32_32x32x16_bf16 v[116:131], v[208:211], v[40:43], v[116:131]
    ds_read_b64_tr_b16 v[248:249], v197 offset:16384
    ds_read_b64_tr_b16 v[250:251], v197 offset:16896
    v_cvt_pk_bf16_f32 v183, v138, v139
    buffer_store_dwordx4 v[180:183], v2, s[12:15], s58 offen offset:1024 sc1
    v_mul_f32 v184, v192, v148
    v_mfma_f32_32x32x16_bf16 v[116:131], v[224:227], v[44:47], v[116:131]
    ds_read_b64_tr_b16 v[252:253], v197 offset:17408
    ds_read_b64_tr_b16 v[254:255], v197 offset:17920
    v_mul_f32 v185, v192, v149
    v_mul_f32 v186, v192, v150
    s_add_u32 s53, s100, 264192
    buffer_load_dwordx4 v0, s[16:19], s53 offen offset:1024 lds
    v_mfma_f32_32x32x16_bf16 v[116:131], v[228:231], v[48:51], v[116:131]
    ds_read_b64_tr_b16 v[204:205], v197 offset:18432
    ds_read_b64_tr_b16 v[206:207], v197 offset:18944
    v_mul_f32 v187, v192, v151
    v_mul_f32 v188, v192, v152
    v_mul_f32 v189, v192, v153
    s_waitcnt lgkmcnt(6)
    v_mfma_f32_32x32x16_bf16 v[116:131], v[232:235], v[52:55], v[116:131]
    ds_read_b64_tr_b16 v[208:209], v197 offset:19456
    ds_read_b64_tr_b16 v[210:211], v197 offset:19968
    v_mul_f32 v190, v192, v154
    v_mul_f32 v191, v192, v155
    v_exp_f32 v184, v184
    s_add_u32 s53, s100, 270336
    buffer_load_dwordx4 v0, s[16:19], s53 offen offset:2048 lds
    v_mfma_f32_32x32x16_bf16 v[116:131], v[236:239], v[56:59], v[116:131]
    ds_read_b64_tr_b16 v[224:225], v197 offset:20480
    ds_read_b64_tr_b16 v[226:227], v197 offset:20992
    v_exp_f32 v185, v185
    v_exp_f32 v186, v186
    v_exp_f32 v187, v187
    v_mfma_f32_32x32x16_bf16 v[116:131], v[240:243], v[60:63], v[116:131]
    ds_read_b64_tr_b16 v[228:229], v197 offset:21504
    ds_read_b64_tr_b16 v[230:231], v197 offset:22016
    v_exp_f32 v188, v188
    v_exp_f32 v189, v189
    v_exp_f32 v190, v190
    s_add_u32 s53, s100, 276480
    buffer_load_dwordx4 v0, s[16:19], s53 offen offset:3072 lds
    v_mfma_f32_32x32x16_bf16 v[116:131], v[244:247], v[64:67], v[116:131]
    ds_read_b64_tr_b16 v[232:233], v197 offset:22528
    ds_read_b64_tr_b16 v[234:235], v197 offset:23040
    v_exp_f32 v191, v191
    v_mul_f32 v148, v148, v156
    v_mul_f32 v149, v149, v157
    s_waitcnt lgkmcnt(6)
    v_mfma_f32_32x32x16_bf16 v[116:131], v[248:251], v[68:71], v[116:131]
    ds_read_b64_tr_b16 v[236:237], v197 offset:23552
    ds_read_b64_tr_b16 v[238:239], v197 offset:24064
    v_mul_f32 v150, v150, v158
    v_mul_f32 v151, v151, v159
    v_mul_f32 v152, v152, v160
    s_mul_i32 s101, s3, 12288
    s_add_u32 m0, s101, 122880
    s_add_u32 s53, s100, 286720
    buffer_load_dwordx4 v0, s[16:19], s53 offen offset:0 lds
    v_mfma_f32_32x32x16_bf16 v[116:131], v[252:255], v[72:75], v[116:131]
    ds_read_b64_tr_b16 v[240:241], v197 offset:24576
    ds_read_b64_tr_b16 v[242:243], v197 offset:25088
    v_mul_f32 v153, v153, v161
    v_mul_f32 v154, v154, v162
    v_mul_f32 v155, v155, v163
    v_mfma_f32_32x32x16_bf16 v[116:131], v[204:207], v[76:79], v[116:131]
    ds_read_b64_tr_b16 v[244:245], v197 offset:25600
    ds_read_b64_tr_b16 v[246:247], v197 offset:26112
    v_fma_f32 v184, v184, v193, v193
    v_fma_f32 v185, v185, v193, v193
    v_fma_f32 v186, v186, v193, v193
    s_add_u32 s53, s100, 292864
    buffer_load_dwordx4 v0, s[16:19], s53 offen offset:1024 lds
    v_mfma_f32_32x32x16_bf16 v[116:131], v[208:211], v[80:83], v[116:131]
    ds_read_b64_tr_b16 v[248:249], v197 offset:26624
    ds_read_b64_tr_b16 v[250:251], v197 offset:27136
    v_fma_f32 v187, v187, v193, v193
    v_fma_f32 v188, v188, v193, v193
    v_fma_f32 v189, v189, v193, v193
    s_waitcnt lgkmcnt(6)
    v_mfma_f32_32x32x16_bf16 v[116:131], v[224:227], v[84:87], v[116:131]
    ds_read_b64_tr_b16 v[252:253], v197 offset:27648
    ds_read_b64_tr_b16 v[254:255], v197 offset:28160
    v_fma_f32 v190, v190, v193, v193
    v_fma_f32 v191, v191, v193, v193
    v_rcp_f32 v184, v184
    s_add_u32 s53, s100, 299008
    buffer_load_dwordx4 v0, s[16:19], s53 offen offset:2048 lds
    s_waitcnt vmcnt(12)
    s_barrier
    v_mfma_f32_32x32x16_bf16 v[116:131], v[228:231], v[88:91], v[116:131]
    ds_read_b64_tr_b16 v[204:205], v194 offset:0
    ds_read_b64_tr_b16 v[206:207], v194 offset:512
    v_rcp_f32 v185, v185
    v_rcp_f32 v186, v186
    v_rcp_f32 v187, v187
    v_mfma_f32_32x32x16_bf16 v[116:131], v[232:235], v[92:95], v[116:131]
    ds_read_b64_tr_b16 v[208:209], v194 offset:1024
    ds_read_b64_tr_b16 v[210:211], v194 offset:1536
    v_rcp_f32 v188, v188
    v_rcp_f32 v189, v189
    v_rcp_f32 v190, v190
    s_add_u32 s53, s100, 305152
    buffer_load_dwordx4 v0, s[16:19], s53 offen offset:3072 lds
    v_mfma_f32_32x32x16_bf16 v[116:131], v[236:239], v[96:99], v[116:131]
    ds_read_b64_tr_b16 v[224:225], v194 offset:2048
    ds_read_b64_tr_b16 v[226:227], v194 offset:2560
    v_rcp_f32 v191, v191
    v_mul_f32 v148, v148, v184
    v_mul_f32 v149, v149, v185
    s_waitcnt lgkmcnt(6)
    v_mfma_f32_32x32x16_bf16 v[116:131], v[240:243], v[100:103], v[116:131]
    ds_read_b64_tr_b16 v[228:229], v194 offset:3072
    ds_read_b64_tr_b16 v[230:231], v194 offset:3584
    v_mul_f32 v150, v150, v186
    v_mul_f32 v151, v151, v187
    v_mul_f32 v152, v152, v188
    v_mfma_f32_32x32x16_bf16 v[116:131], v[244:247], v[104:107], v[116:131]
    ds_read_b64_tr_b16 v[232:233], v194 offset:4096
    ds_read_b64_tr_b16 v[234:235], v194 offset:4608
    v_mul_f32 v153, v153, v189
    v_mul_f32 v154, v154, v190
    v_mul_f32 v155, v155, v191
    v_mfma_f32_32x32x16_bf16 v[116:131], v[248:251], v[108:111], v[116:131]
    ds_read_b64_tr_b16 v[236:237], v194 offset:5120
    ds_read_b64_tr_b16 v[238:239], v194 offset:5632
    v_cvt_pk_bf16_f32 v180, v148, v149
    v_cvt_pk_bf16_f32 v181, v150, v151
    v_cvt_pk_bf16_f32 v182, v152, v153
    v_mfma_f32_32x32x16_bf16 v[116:131], v[252:255], v[112:115], v[116:131]
    ds_read_b64_tr_b16 v[240:241], v194 offset:6144
    ds_read_b64_tr_b16 v[242:243], v194 offset:6656
    v_cvt_pk_bf16_f32 v183, v154, v155
    buffer_store_dwordx4 v[180:183], v2, s[12:15], s49 offen offset:0 sc1
    v_mul_f32 v184, v192, v164
    s_waitcnt lgkmcnt(6)
    v_mfma_f32_32x32x16_bf16 v[132:147], v[204:207], v[4:7], 0
    ds_read_b64_tr_b16 v[244:245], v194 offset:7168
    ds_read_b64_tr_b16 v[246:247], v194 offset:7680
    v_mul_f32 v185, v192, v165
    v_mul_f32 v186, v192, v166
    s_barrier
    s_mul_i32 s101, s3, 14336
    s_add_u32 m0, s101, 57344
    s_add_u32 s53, s100, 315392
    buffer_load_dwordx4 v0, s[16:19], s53 offen offset:0 lds
    v_mfma_f32_32x32x16_bf16 v[132:147], v[208:211], v[8:11], v[132:147]
    ds_read_b64_tr_b16 v[248:249], v194 offset:8192
    ds_read_b64_tr_b16 v[250:251], v194 offset:8704
    v_mul_f32 v187, v192, v167
    v_mul_f32 v188, v192, v168
    v_mul_f32 v189, v192, v169
    v_mfma_f32_32x32x16_bf16 v[132:147], v[224:227], v[12:15], v[132:147]
    ds_read_b64_tr_b16 v[252:253], v194 offset:9216
    ds_read_b64_tr_b16 v[254:255], v194 offset:9728
    v_mul_f32 v190, v192, v170
    v_mul_f32 v191, v192, v171
    v_exp_f32 v184, v184
    s_add_u32 s53, s100, 321536
    buffer_load_dwordx4 v0, s[16:19], s53 offen offset:1024 lds
Lpage9:
    s_cbranch_execz Lvis2
    v_mfma_f32_32x32x16_bf16 v[132:147], v[228:231], v[16:19], v[132:147]
    ds_read_b64_tr_b16 v[204:205], v194 offset:10240
    ds_read_b64_tr_b16 v[206:207], v194 offset:10752
    v_exp_f32 v185, v185
    v_exp_f32 v186, v186
    v_exp_f32 v187, v187
    s_waitcnt lgkmcnt(6)
    v_mfma_f32_32x32x16_bf16 v[132:147], v[232:235], v[20:23], v[132:147]
    ds_read_b64_tr_b16 v[208:209], v194 offset:11264
    ds_read_b64_tr_b16 v[210:211], v194 offset:11776
    v_exp_f32 v188, v188
    v_exp_f32 v189, v189
    v_exp_f32 v190, v190
    s_add_u32 s53, s100, 327680
    buffer_load_dwordx4 v0, s[16:19], s53 offen offset:2048 lds
    v_mfma_f32_32x32x16_bf16 v[132:147], v[236:239], v[24:27], v[132:147]
    ds_read_b64_tr_b16 v[224:225], v194 offset:12288
    ds_read_b64_tr_b16 v[226:227], v194 offset:12800
    v_exp_f32 v191, v191
    v_mul_f32 v164, v164, v172
    v_mul_f32 v165, v165, v173
    v_mfma_f32_32x32x16_bf16 v[132:147], v[240:243], v[28:31], v[132:147]
    ds_read_b64_tr_b16 v[228:229], v194 offset:13312
    ds_read_b64_tr_b16 v[230:231], v194 offset:13824
    v_mul_f32 v166, v166, v174
    v_mul_f32 v167, v167, v175
    v_mul_f32 v168, v168, v176
    s_add_u32 s53, s100, 333824
    buffer_load_dwordx4 v0, s[16:19], s53 offen offset:3072 lds
    s_waitcnt vmcnt(12)
    v_mov_b32 v200, s24
    s_mov_b64 exec, 1
    buffer_store_dword v200, v2, s[12:15], s55 offen sc1
    s_mov_b64 exec, -1
    v_mfma_f32_32x32x16_bf16 v[132:147], v[244:247], v[32:35], v[132:147]
    ds_read_b64_tr_b16 v[232:233], v194 offset:14336
    ds_read_b64_tr_b16 v[234:235], v194 offset:14848
    v_mul_f32 v169, v169, v177
    v_mul_f32 v170, v170, v178
    v_mul_f32 v171, v171, v179
    s_waitcnt lgkmcnt(6)
    v_mfma_f32_32x32x16_bf16 v[132:147], v[248:251], v[36:39], v[132:147]
    ds_read_b64_tr_b16 v[236:237], v194 offset:15360
    ds_read_b64_tr_b16 v[238:239], v194 offset:15872
    v_fma_f32 v184, v184, v193, v193
    v_fma_f32 v185, v185, v193, v193
    v_fma_f32 v186, v186, v193, v193
    s_mul_i32 s101, s3, 14336
    s_add_u32 m0, s101, 61440
    s_add_u32 s53, s100, 344064
    buffer_load_dwordx4 v0, s[16:19], s53 offen offset:0 lds
    v_mfma_f32_32x32x16_bf16 v[132:147], v[252:255], v[40:43], v[132:147]
    ds_read_b64_tr_b16 v[240:241], v194 offset:16384
    ds_read_b64_tr_b16 v[242:243], v194 offset:16896
    v_fma_f32 v187, v187, v193, v193
    v_fma_f32 v188, v188, v193, v193
    v_fma_f32 v189, v189, v193, v193
    v_mfma_f32_32x32x16_bf16 v[132:147], v[204:207], v[44:47], v[132:147]
    ds_read_b64_tr_b16 v[244:245], v194 offset:17408
    ds_read_b64_tr_b16 v[246:247], v194 offset:17920
    v_fma_f32 v190, v190, v193, v193
    v_fma_f32 v191, v191, v193, v193
    v_rcp_f32 v184, v184
    s_add_u32 s53, s100, 350208
    buffer_load_dwordx4 v0, s[16:19], s53 offen offset:1024 lds
    v_mfma_f32_32x32x16_bf16 v[132:147], v[208:211], v[48:51], v[132:147]
    ds_read_b64_tr_b16 v[248:249], v194 offset:18432
    ds_read_b64_tr_b16 v[250:251], v194 offset:18944
    v_rcp_f32 v185, v185
    v_rcp_f32 v186, v186
    v_rcp_f32 v187, v187
    s_waitcnt lgkmcnt(6)
    v_mfma_f32_32x32x16_bf16 v[132:147], v[224:227], v[52:55], v[132:147]
    ds_read_b64_tr_b16 v[252:253], v194 offset:19456
    ds_read_b64_tr_b16 v[254:255], v194 offset:19968
    v_rcp_f32 v188, v188
    v_rcp_f32 v189, v189
    v_rcp_f32 v190, v190
    s_add_u32 s53, s100, 356352
    buffer_load_dwordx4 v0, s[16:19], s53 offen offset:2048 lds
    v_mfma_f32_32x32x16_bf16 v[132:147], v[228:231], v[56:59], v[132:147]
    ds_read_b64_tr_b16 v[204:205], v194 offset:20480
    ds_read_b64_tr_b16 v[206:207], v194 offset:20992
    v_rcp_f32 v191, v191
    v_mul_f32 v164, v164, v184
    v_mul_f32 v165, v165, v185
    v_mfma_f32_32x32x16_bf16 v[132:147], v[232:235], v[60:63], v[132:147]
    ds_read_b64_tr_b16 v[208:209], v194 offset:21504
    ds_read_b64_tr_b16 v[210:211], v194 offset:22016
    v_mul_f32 v166, v166, v186
    v_mul_f32 v167, v167, v187
    v_mul_f32 v168, v168, v188
    s_add_u32 s53, s100, 362496
    buffer_load_dwordx4 v0, s[16:19], s53 offen offset:3072 lds
    v_mfma_f32_32x32x16_bf16 v[132:147], v[236:239], v[64:67], v[132:147]
    ds_read_b64_tr_b16 v[224:225], v194 offset:22528
    ds_read_b64_tr_b16 v[226:227], v194 offset:23040
    v_mul_f32 v169, v169, v189
    v_mul_f32 v170, v170, v190
    v_mul_f32 v171, v171, v191
    s_waitcnt lgkmcnt(6)
    v_mfma_f32_32x32x16_bf16 v[132:147], v[240:243], v[68:71], v[132:147]
    ds_read_b64_tr_b16 v[228:229], v194 offset:23552
    ds_read_b64_tr_b16 v[230:231], v194 offset:24064
    v_cvt_pk_bf16_f32 v180, v164, v165
    v_cvt_pk_bf16_f32 v181, v166, v167
    v_cvt_pk_bf16_f32 v182, v168, v169
    s_mul_i32 s101, s3, 14336
    s_add_u32 m0, s101, 65536
    s_add_u32 s53, s100, 372736
    buffer_load_dwordx4 v0, s[16:19], s53 offen offset:0 lds
    v_mfma_f32_32x32x16_bf16 v[132:147], v[244:247], v[72:75], v[132:147]
    ds_read_b64_tr_b16 v[232:233], v194 offset:24576
    ds_read_b64_tr_b16 v[234:235], v194 offset:25088
    v_cvt_pk_bf16_f32 v183, v170, v171
    buffer_store_dwordx4 v[180:183], v2, s[12:15], s58 offen offset:2048 sc1
    v_mul_f32 v184, v192, v116
    v_mfma_f32_32x32x16_bf16 v[132:147], v[248:251], v[76:79], v[132:147]
    ds_read_b64_tr_b16 v[236:237], v194 offset:25600
    ds_read_b64_tr_b16 v[238:239], v194 offset:26112
    v_mul_f32 v185, v192, v117
    v_mul_f32 v186, v192, v118
    s_add_u32 s53, s100, 378880
    buffer_load_dwordx4 v0, s[16:19], s53 offen offset:1024 lds
    v_mfma_f32_32x32x16_bf16 v[132:147], v[252:255], v[80:83], v[132:147]
    ds_read_b64_tr_b16 v[240:241], v194 offset:26624
    ds_read_b64_tr_b16 v[242:243], v194 offset:27136
    v_mul_f32 v187, v192, v119
    v_mul_f32 v188, v192, v120
    v_mul_f32 v189, v192, v121
    s_waitcnt lgkmcnt(6)
    v_mfma_f32_32x32x16_bf16 v[132:147], v[204:207], v[84:87], v[132:147]
    ds_read_b64_tr_b16 v[244:245], v194 offset:27648
    ds_read_b64_tr_b16 v[246:247], v194 offset:28160
    v_mul_f32 v190, v192, v122
    v_mul_f32 v191, v192, v123
    v_exp_f32 v184, v184
    s_add_u32 s53, s100, 385024
    buffer_load_dwordx4 v0, s[16:19], s53 offen offset:2048 lds
    v_mfma_f32_32x32x16_bf16 v[132:147], v[208:211], v[88:91], v[132:147]
    ds_read_b64_tr_b16 v[248:249], v195 offset:0
    ds_read_b64_tr_b16 v[250:251], v195 offset:512
    v_exp_f32 v185, v185
    v_exp_f32 v186, v186
    v_exp_f32 v187, v187
    v_mfma_f32_32x32x16_bf16 v[132:147], v[224:227], v[92:95], v[132:147]
    ds_read_b64_tr_b16 v[252:253], v195 offset:1024
    ds_read_b64_tr_b16 v[254:255], v195 offset:1536
    v_exp_f32 v188, v188
    v_exp_f32 v189, v189
    v_exp_f32 v190, v190
    s_add_u32 s53, s100, 391168
    buffer_load_dwordx4 v0, s[16:19], s53 offen offset:3072 lds
    v_mfma_f32_32x32x16_bf16 v[132:147], v[228:231], v[96:99], v[132:147]
    ds_read_b64_tr_b16 v[204:205], v195 offset:2048
    ds_read_b64_tr_b16 v[206:207], v195 offset:2560
    v_exp_f32 v191, v191
    v_mul_f32 v116, v116, v124
    v_mul_f32 v117, v117, v125
    s_waitcnt lgkmcnt(6)
    v_mfma_f32_32x32x16_bf16 v[132:147], v[232:235], v[100:103], v[132:147]
    ds_read_b64_tr_b16 v[208:209], v195 offset:3072
    ds_read_b64_tr_b16 v[210:211], v195 offset:3584
    v_mul_f32 v118, v118, v126
    v_mul_f32 v119, v119, v127
    v_mul_f32 v120, v120, v128
    v_mfma_f32_32x32x16_bf16 v[132:147], v[236:239], v[104:107], v[132:147]
    ds_read_b64_tr_b16 v[224:225], v195 offset:4096
    ds_read_b64_tr_b16 v[226:227], v195 offset:4608
    v_mul_f32 v121, v121, v129
    v_mul_f32 v122, v122, v130
    v_mul_f32 v123, v123, v131
    v_mfma_f32_32x32x16_bf16 v[132:147], v[240:243], v[108:111], v[132:147]
    ds_read_b64_tr_b16 v[228:229], v195 offset:5120
    ds_read_b64_tr_b16 v[230:231], v195 offset:5632
    v_fma_f32 v184, v184, v193, v193
    v_fma_f32 v185, v185, v193, v193
    v_fma_f32 v186, v186, v193, v193
    v_mfma_f32_32x32x16_bf16 v[132:147], v[244:247], v[112:115], v[132:147]
    ds_read_b64_tr_b16 v[232:233], v195 offset:6144
    ds_read_b64_tr_b16 v[234:235], v195 offset:6656
    v_fma_f32 v187, v187, v193, v193
    v_fma_f32 v188, v188, v193, v193
    v_fma_f32 v189, v189, v193, v193
    s_waitcnt lgkmcnt(6)
    v_mfma_f32_32x32x16_bf16 v[148:163], v[248:251], v[4:7], 0
    ds_read_b64_tr_b16 v[236:237], v195 offset:7168
    ds_read_b64_tr_b16 v[238:239], v195 offset:7680
    v_fma_f32 v190, v190, v193, v193
    v_fma_f32 v191, v191, v193, v193
    v_rcp_f32 v184, v184
    v_mfma_f32_32x32x16_bf16 v[148:163], v[252:255], v[8:11], v[148:163]
    ds_read_b64_tr_b16 v[240:241], v195 offset:8192
    ds_read_b64_tr_b16 v[242:243], v195 offset:8704
    v_rcp_f32 v185, v185
    v_rcp_f32 v186, v186
    v_rcp_f32 v187, v187
    v_mfma_f32_32x32x16_bf16 v[148:163], v[204:207], v[12:15], v[148:163]
    ds_read_b64_tr_b16 v[244:245], v195 offset:9216
    ds_read_b64_tr_b16 v[246:247], v195 offset:9728
    v_rcp_f32 v188, v188
    v_rcp_f32 v189, v189
    v_rcp_f32 v190, v190
    v_mfma_f32_32x32x16_bf16 v[148:163], v[208:211], v[16:19], v[148:163]
    ds_read_b64_tr_b16 v[248:249], v195 offset:10240
    ds_read_b64_tr_b16 v[250:251], v195 offset:10752
    v_rcp_f32 v191, v191
    v_mul_f32 v116, v116, v184
    v_mul_f32 v117, v117, v185
    s_waitcnt lgkmcnt(6)
    v_mfma_f32_32x32x16_bf16 v[148:163], v[224:227], v[20:23], v[148:163]
    ds_read_b64_tr_b16 v[252:253], v195 offset:11264
    ds_read_b64_tr_b16 v[254:255], v195 offset:11776
    v_mul_f32 v118, v118, v186
    v_mul_f32 v119, v119, v187
    v_mul_f32 v120, v120, v188
    v_mfma_f32_32x32x16_bf16 v[148:163], v[228:231], v[24:27], v[148:163]
    ds_read_b64_tr_b16 v[204:205], v195 offset:12288
    ds_read_b64_tr_b16 v[206:207], v195 offset:12800
    v_mul_f32 v121, v121, v189
    v_mul_f32 v122, v122, v190
    v_mul_f32 v123, v123, v191
    v_mfma_f32_32x32x16_bf16 v[148:163], v[232:235], v[28:31], v[148:163]
    ds_read_b64_tr_b16 v[208:209], v195 offset:13312
    ds_read_b64_tr_b16 v[210:211], v195 offset:13824
    v_cvt_pk_bf16_f32 v180, v116, v117
    v_cvt_pk_bf16_f32 v181, v118, v119
    v_cvt_pk_bf16_f32 v182, v120, v121
    v_mfma_f32_32x32x16_bf16 v[148:163], v[236:239], v[32:35], v[148:163]
    ds_read_b64_tr_b16 v[224:225], v195 offset:14336
    ds_read_b64_tr_b16 v[226:227], v195 offset:14848
    v_cvt_pk_bf16_f32 v183, v122, v123
    buffer_store_dwordx4 v[180:183], v2, s[12:15], s58 offen offset:3072 sc1
    v_mul_f32 v184, v192, v132
    s_waitcnt lgkmcnt(6)
    v_mfma_f32_32x32x16_bf16 v[148:163], v[240:243], v[36:39], v[148:163]
    ds_read_b64_tr_b16 v[228:229], v195 offset:15360
    ds_read_b64_tr_b16 v[230:231], v195 offset:15872
    v_mul_f32 v185, v192, v133
    v_mul_f32 v186, v192, v134
    v_mfma_f32_32x32x16_bf16 v[148:163], v[244:247], v[40:43], v[148:163]
    ds_read_b64_tr_b16 v[232:233], v195 offset:16384
    ds_read_b64_tr_b16 v[234:235], v195 offset:16896
    v_mul_f32 v187, v192, v135
    v_mul_f32 v188, v192, v136
    v_mul_f32 v189, v192, v137
    v_mfma_f32_32x32x16_bf16 v[148:163], v[248:251], v[44:47], v[148:163]
    ds_read_b64_tr_b16 v[236:237], v195 offset:17408
    ds_read_b64_tr_b16 v[238:239], v195 offset:17920
    v_mul_f32 v190, v192, v138
    v_mul_f32 v191, v192, v139
    v_exp_f32 v184, v184
    v_mfma_f32_32x32x16_bf16 v[148:163], v[252:255], v[48:51], v[148:163]
    ds_read_b64_tr_b16 v[240:241], v195 offset:18432
    ds_read_b64_tr_b16 v[242:243], v195 offset:18944
    v_exp_f32 v185, v185
    v_exp_f32 v186, v186
    v_exp_f32 v187, v187
    s_waitcnt lgkmcnt(6)
    v_mfma_f32_32x32x16_bf16 v[148:163], v[204:207], v[52:55], v[148:163]
    ds_read_b64_tr_b16 v[244:245], v195 offset:19456
    ds_read_b64_tr_b16 v[246:247], v195 offset:19968
    v_exp_f32 v188, v188
    v_exp_f32 v189, v189
    v_exp_f32 v190, v190
    v_mfma_f32_32x32x16_bf16 v[148:163], v[208:211], v[56:59], v[148:163]
    ds_read_b64_tr_b16 v[248:249], v195 offset:20480
    ds_read_b64_tr_b16 v[250:251], v195 offset:20992
    v_exp_f32 v191, v191
    v_mul_f32 v132, v132, v140
    v_mul_f32 v133, v133, v141
    v_mfma_f32_32x32x16_bf16 v[148:163], v[224:227], v[60:63], v[148:163]
    ds_read_b64_tr_b16 v[252:253], v195 offset:21504
    ds_read_b64_tr_b16 v[254:255], v195 offset:22016
    v_mul_f32 v134, v134, v142
    v_mul_f32 v135, v135, v143
    v_mul_f32 v136, v136, v144
    v_mfma_f32_32x32x16_bf16 v[148:163], v[228:231], v[64:67], v[148:163]
    ds_read_b64_tr_b16 v[204:205], v195 offset:22528
    ds_read_b64_tr_b16 v[206:207], v195 offset:23040
    v_mul_f32 v137, v137, v145
    v_mul_f32 v138, v138, v146
    v_mul_f32 v139, v139, v147
    s_waitcnt lgkmcnt(6)
    v_mfma_f32_32x32x16_bf16 v[148:163], v[232:235], v[68:71], v[148:163]
    ds_read_b64_tr_b16 v[208:209], v195 offset:23552
    ds_read_b64_tr_b16 v[210:211], v195 offset:24064
    v_fma_f32 v184, v184, v193, v193
    v_fma_f32 v185, v185, v193, v193
    v_fma_f32 v186, v186, v193, v193
    v_mfma_f32_32x32x16_bf16 v[148:163], v[236:239], v[72:75], v[148:163]
    ds_read_b64_tr_b16 v[224:225], v195 offset:24576
    ds_read_b64_tr_b16 v[226:227], v195 offset:25088
    v_fma_f32 v187, v187, v193, v193
    v_fma_f32 v188, v188, v193, v193
    v_fma_f32 v189, v189, v193, v193
    v_mfma_f32_32x32x16_bf16 v[148:163], v[240:243], v[76:79], v[148:163]
    ds_read_b64_tr_b16 v[228:229], v195 offset:25600
    ds_read_b64_tr_b16 v[230:231], v195 offset:26112
    v_fma_f32 v190, v190, v193, v193
    v_fma_f32 v191, v191, v193, v193
    v_rcp_f32 v184, v184
    v_lshrrev_b32 v200, 2, v1
    v_lshlrev_b32 v200, 11, v200
    v_and_b32 v198, 3, v1
    v_lshl_add_u32 v201, v198, 7, v200
    s_lshl_b32 s53, s27, 3
    s_add_u32 s53, s53, s3
    s_lshl_b32 s99, s53, 9
    s_add_u32 s99, s99, 17235968
    s_mov_b64 exec, 0xff
    buffer_load_dword v200, v201, s[12:15], s99 offen sc1
    s_mov_b64 exec, -1
    v_mfma_f32_32x32x16_bf16 v[148:163], v[244:247], v[80:83], v[148:163]
    ds_read_b64_tr_b16 v[232:233], v195 offset:26624
    ds_read_b64_tr_b16 v[234:235], v195 offset:27136
    v_rcp_f32 v185, v185
    v_rcp_f32 v186, v186
    v_rcp_f32 v187, v187
    s_waitcnt lgkmcnt(6)
    v_mfma_f32_32x32x16_bf16 v[148:163], v[248:251], v[84:87], v[148:163]
    ds_read_b64_tr_b16 v[236:237], v195 offset:27648
    ds_read_b64_tr_b16 v[238:239], v195 offset:28160
    v_rcp_f32 v188, v188
    v_rcp_f32 v189, v189
    v_rcp_f32 v190, v190
    v_mfma_f32_32x32x16_bf16 v[148:163], v[252:255], v[88:91], v[148:163]
    v_rcp_f32 v191, v191
    v_mul_f32 v132, v132, v184
    v_mul_f32 v133, v133, v185
    v_mfma_f32_32x32x16_bf16 v[148:163], v[204:207], v[92:95], v[148:163]
    v_mul_f32 v134, v134, v186
    v_mul_f32 v135, v135, v187
    v_mul_f32 v136, v136, v188
    v_mfma_f32_32x32x16_bf16 v[148:163], v[208:211], v[96:99], v[148:163]
    v_mul_f32 v137, v137, v189
    v_mul_f32 v138, v138, v190
    v_mul_f32 v139, v139, v191
    s_waitcnt lgkmcnt(0)
    v_mfma_f32_32x32x16_bf16 v[148:163], v[224:227], v[100:103], v[148:163]
    v_cvt_pk_bf16_f32 v180, v132, v133
    v_cvt_pk_bf16_f32 v181, v134, v135
    v_cvt_pk_bf16_f32 v182, v136, v137
    v_mfma_f32_32x32x16_bf16 v[148:163], v[228:231], v[104:107], v[148:163]
    v_cvt_pk_bf16_f32 v183, v138, v139
    buffer_store_dwordx4 v[180:183], v2, s[12:15], s54 offen offset:0 sc1
    v_mfma_f32_32x32x16_bf16 v[148:163], v[232:235], v[108:111], v[148:163]
    v_mfma_f32_32x32x16_bf16 v[148:163], v[236:239], v[112:115], v[148:163]
    s_add_u32 s55, s55, 131072
    s_waitcnt vmcnt(2)
    v_mov_b32 v196, s24
    s_mov_b64 exec, 1
    buffer_store_dword v196, v2, s[12:15], s55 offen sc1
    s_mov_b64 exec, -1
    s_add_u32 s55, s55, 131072
    s_nop 4
    v_pk_mul_f32 v[184:185], v[148:149], v[192:193] op_sel_hi:[1,0]
    v_pk_mul_f32 v[186:187], v[150:151], v[192:193] op_sel_hi:[1,0]
    v_pk_mul_f32 v[188:189], v[152:153], v[192:193] op_sel_hi:[1,0]
    v_pk_mul_f32 v[190:191], v[154:155], v[192:193] op_sel_hi:[1,0]
    v_exp_f32 v184, v184
    v_exp_f32 v185, v185
    v_exp_f32 v186, v186
    v_exp_f32 v187, v187
    v_exp_f32 v188, v188
    v_exp_f32 v189, v189
    v_exp_f32 v190, v190
    v_exp_f32 v191, v191
    v_pk_mul_f32 v[148:149], v[148:149], v[156:157]
    v_pk_mul_f32 v[150:151], v[150:151], v[158:159]
    v_pk_mul_f32 v[152:153], v[152:153], v[160:161]
    v_pk_mul_f32 v[154:155], v[154:155], v[162:163]
    v_pk_fma_f32 v[184:185], v[184:185], v[192:193], v[192:193] op_sel:[0,1,1] op_sel_hi:[1,1,1]
    v_pk_fma_f32 v[186:187], v[186:187], v[192:193], v[192:193] op_sel:[0,1,1] op_sel_hi:[1,1,1]
    v_pk_fma_f32 v[188:189], v[188:189], v[192:193], v[192:193] op_sel:[0,1,1] op_sel_hi:[1,1,1]
    v_pk_fma_f32 v[190:191], v[190:191], v[192:193], v[192:193] op_sel:[0,1,1] op_sel_hi:[1,1,1]
    v_rcp_f32 v184, v184
    v_rcp_f32 v185, v185
    v_rcp_f32 v186, v186
    v_rcp_f32 v187, v187
    v_rcp_f32 v188, v188
    v_rcp_f32 v189, v189
    v_rcp_f32 v190, v190
    v_rcp_f32 v191, v191
    v_pk_mul_f32 v[148:149], v[148:149], v[184:185]
    v_pk_mul_f32 v[150:151], v[150:151], v[186:187]
    v_pk_mul_f32 v[152:153], v[152:153], v[188:189]
    v_pk_mul_f32 v[154:155], v[154:155], v[190:191]
    v_cvt_pk_bf16_f32 v180, v148, v149
    v_cvt_pk_bf16_f32 v181, v150, v151
    v_cvt_pk_bf16_f32 v182, v152, v153
    v_cvt_pk_bf16_f32 v183, v154, v155
    buffer_store_dwordx4 v[180:183], v2, s[12:15], s54 offen offset:1024 sc1
    s_cmp_ge_u32 s31, 28
    s_cbranch_scc0 LE
    s_waitcnt vmcnt(0)
    v_mov_b32 v4, s24
    s_mov_b64 exec, 1
    buffer_store_dword v4, v2, s[12:15], s55 offen sc1
    s_mov_b64 exec, -1
    s_branch Lfin
LE:
    s_and_b32 s54, s3, 1
    s_lshl_b32 s53, s27, 1
    s_add_u32 s54, s54, s53
    s_lshr_b32 s56, s3, 1
    s_lshl_b32 s53, s28, 1
    s_add_u32 s56, s56, s53
    s_mul_i32 s57, s3, 28672
    s_xor_b32 s53, s54, 0
    s_mul_i32 s53, s53, 114688
    s_add_u32 s53, s53, s57
    s_add_u32 s48, s53, 9437184
    s_xor_b32 s53, s54, 1
    s_mul_i32 s53, s53, 114688
    s_add_u32 s53, s53, s57
    s_add_u32 s49, s53, 9437184
    s_mov_b64 exec, 0xff
    s_mov_b32 s98, 0x200000
    s_waitcnt vmcnt(3)
    v_cmp_ne_u32 vcc, s24, v200
    s_nop 1
    s_cbranch_vccz Lpoll7d
Lpoll7:
    buffer_load_dword v200, v201, s[12:15], s99 offen sc1
    s_sub_u32 s98, s98, 1
    s_waitcnt vmcnt(0)
    s_cbranch_scc1 Lpoll7d
    v_cmp_ne_u32 vcc, s24, v200
    s_nop 1
    s_cbranch_vccnz Lpoll7
Lpoll7d:
    s_mov_b64 exec, -1
    s_add_u32 s53, s48, 0
    buffer_load_dwordx4 v[68:71], v2, s[12:15], s53 offen offset:0 sc1
    s_add_u32 s53, s49, 0
    buffer_load_dwordx4 v[72:75], v2, s[12:15], s53 offen offset:0 sc1
    s_add_u32 s53, s48, 4096
    buffer_load_dwordx4 v[76:79], v2, s[12:15], s53 offen offset:3072 sc1
    s_add_u32 s53, s49, 4096
    buffer_load_dwordx4 v[80:83], v2, s[12:15], s53 offen offset:3072 sc1
    s_add_u32 s53, s48, 16384
    buffer_load_dwordx4 v[84:87], v2, s[12:15], s53 offen offset:0 sc1
    s_add_u32 s53, s49, 16384
    buffer_load_dwordx4 v[88:91], v2, s[12:15], s53 offen offset:0 sc1
    s_add_u32 s99, s99, 131072
    s_mov_b64 exec, 0xff
    buffer_load_dword v200, v201, s[12:15], s99 offen sc1
    s_mov_b64 exec, -1
    s_add_u32 s53, s48, 20480
    buffer_load_dwordx4 v[92:95], v2, s[12:15], s53 offen offset:1024 sc1
    s_add_u32 s53, s49, 20480
    buffer_load_dwordx4 v[96:99], v2, s[12:15], s53 offen offset:1024 sc1
    s_add_u32 s53, s48, 0
    buffer_load_dwordx4 v[100:103], v2, s[12:15], s53 offen offset:1024 sc1
    s_add_u32 s53, s49, 0
    buffer_load_dwordx4 v[104:107], v2, s[12:15], s53 offen offset:1024 sc1
    s_add_u32 s53, s48, 8192
    buffer_load_dwordx4 v[108:111], v2, s[12:15], s53 offen offset:0 sc1
    s_add_u32 s53, s49, 8192
    buffer_load_dwordx4 v[112:115], v2, s[12:15], s53 offen offset:0 sc1
    s_add_u32 s53, s48, 16384
    buffer_load_dwordx4 v[116:119], v2, s[12:15], s53 offen offset:1024 sc1
    s_add_u32 s53, s49, 16384
    buffer_load_dwordx4 v[120:123], v2, s[12:15], s53 offen offset:1024 sc1
    s_waitcnt vmcnt(15)
    v_mov_b32 v208, s24
    s_mov_b64 exec, 1
    buffer_store_dword v208, v2, s[12:15], s55 offen sc1
    s_mov_b64 exec, -1
    s_add_u32 s53, s48, 20480
    buffer_load_dwordx4 v[124:127], v2, s[12:15], s53 offen offset:2048 sc1
    s_add_u32 s53, s49, 20480
    buffer_load_dwordx4 v[128:131], v2, s[12:15], s53 offen offset:2048 sc1
    v_lshlrev_b32 v4, 16, v216
    v_and_b32 v5, 0xffff0000, v216
    v_lshlrev_b32 v6, 16, v217
    v_and_b32 v7, 0xffff0000, v217
    v_lshlrev_b32 v8, 16, v218
    v_and_b32 v9, 0xffff0000, v218
    v_lshlrev_b32 v10, 16, v219
    v_and_b32 v11, 0xffff0000, v219
    v_lshlrev_b32 v12, 16, v220
    v_and_b32 v13, 0xffff0000, v220
    v_lshlrev_b32 v14, 16, v221
    v_and_b32 v15, 0xffff0000, v221
    v_lshlrev_b32 v16, 16, v222
    v_and_b32 v17, 0xffff0000, v222
    v_lshlrev_b32 v18, 16, v223
    v_and_b32 v19, 0xffff0000, v223
    s_xor_b32 s53, s3, 0
    s_mul_i32 s53, s53, 12288
    s_add_u32 s53, s53, 114688
    v_add_u32 v204, s53, v2
    s_xor_b32 s53, s3, 1
    s_mul_i32 s53, s53, 12288
    s_add_u32 s53, s53, 114688
    v_add_u32 v205, s53, v2
    s_xor_b32 s53, s3, 2
    s_mul_i32 s53, s53, 12288
    s_add_u32 s53, s53, 114688
    v_add_u32 v206, s53, v2
    s_xor_b32 s53, s3, 3
    s_mul_i32 s53, s53, 12288
    s_add_u32 s53, s53, 114688
    v_add_u32 v207, s53, v2
    s_lshl_b32 s53, s3, 13
    v_add_u32 v209, s53, v214
    v_add_u32 v210, s53, v215
    s_mul_i32 s53, s3, 10240
    s_sub_u32 s53, s53, 57344
    v_add_u32 v211, s53, v214
    v_add_u32 v212, s53, v215
    ds_read_b64_tr_b16 v[224:225], v209 offset:0
    ds_read_b64_tr_b16 v[226:227], v209 offset:1024
    ds_read_b64_tr_b16 v[228:229], v210 offset:0
    ds_read_b64_tr_b16 v[230:231], v210 offset:1024
    ds_read_b64_tr_b16 v[232:233], v209 offset:10240
    ds_read_b64_tr_b16 v[234:235], v209 offset:11264
    ds_read_b64_tr_b16 v[236:237], v210 offset:10240
    ds_read_b64_tr_b16 v[238:239], v210 offset:11264
    ds_read_b64_tr_b16 v[240:241], v209 offset:2048
    ds_read_b64_tr_b16 v[242:243], v209 offset:3072
    ds_read_b64_tr_b16 v[244:245], v210 offset:2048
    ds_read_b64_tr_b16 v[246:247], v210 offset:3072
    s_waitcnt vmcnt(16)
    v_mfma_f32_32x32x16_bf16 v[4:19], a[0:3], v[68:71], v[4:19]
    s_mov_b64 exec, 0xff
    s_mov_b32 s98, 0x200000
    s_waitcnt vmcnt(11)
    v_cmp_ne_u32 vcc, s24, v200
    s_nop 1
    s_cbranch_vccz Lpoll8d
Lpoll8:
    buffer_load_dword v200, v201, s[12:15], s99 offen sc1
    s_sub_u32 s98, s98, 1
    s_waitcnt vmcnt(0)
    s_cbranch_scc1 Lpoll8d
    v_cmp_ne_u32 vcc, s24, v200
    s_nop 1
    s_cbranch_vccnz Lpoll8
Lpoll8d:
    s_mov_b64 exec, -1
    s_add_u32 s53, s48, 4096
    buffer_load_dwordx4 v[132:135], v2, s[12:15], s53 offen offset:0 sc1
    v_mfma_f32_32x32x16_bf16 v[20:35], a[0:3], v[72:75], 0
    v_mfma_f32_32x32x16_bf16 v[36:51], a[4:7], v[68:71], 0
    s_add_u32 s53, s49, 4096
    buffer_load_dwordx4 v[136:139], v2, s[12:15], s53 offen offset:0 sc1
    v_mfma_f32_32x32x16_bf16 v[52:67], a[4:7], v[72:75], 0
    v_mfma_f32_32x32x16_bf16 v[4:19], a[56:59], v[76:79], v[4:19]
    s_add_u32 s53, s48, 8192
    buffer_load_dwordx4 v[140:143], v2, s[12:15], s53 offen offset:3072 sc1
    v_mfma_f32_32x32x16_bf16 v[20:35], a[56:59], v[80:83], v[20:35]
    v_mfma_f32_32x32x16_bf16 v[36:51], a[60:63], v[76:79], v[36:51]
    s_add_u32 s53, s49, 8192
    buffer_load_dwordx4 v[144:147], v2, s[12:15], s53 offen offset:3072 sc1
    v_mfma_f32_32x32x16_bf16 v[52:67], a[60:63], v[80:83], v[52:67]
    s_waitcnt lgkmcnt(8)
    v_mfma_f32_32x32x16_bf16 v[4:19], v[224:227], v[84:87], v[4:19]
    ds_read_b64_tr_b16 v[248:249], v211 offset:0
    s_add_u32 s53, s48, 20480
    buffer_load_dwordx4 v[148:151], v2, s[12:15], s53 offen offset:0 sc1
    v_mfma_f32_32x32x16_bf16 v[20:35], v[224:227], v[88:91], v[20:35]
    ds_read_b64_tr_b16 v[250:251], v211 offset:1024
    v_mfma_f32_32x32x16_bf16 v[36:51], v[228:231], v[84:87], v[36:51]
    ds_read_b64_tr_b16 v[252:253], v212 offset:0
    s_add_u32 s53, s49, 20480
    buffer_load_dwordx4 v[152:155], v2, s[12:15], s53 offen offset:0 sc1
    v_mfma_f32_32x32x16_bf16 v[52:67], v[228:231], v[88:91], v[52:67]
    ds_read_b64_tr_b16 v[254:255], v212 offset:1024
    s_waitcnt lgkmcnt(8)
    s_waitcnt vmcnt(15)
    v_mfma_f32_32x32x16_bf16 v[4:19], v[232:235], v[92:95], v[4:19]
    ds_read_b64_tr_b16 v[224:225], v209 offset:8192
    s_add_u32 s53, s48, 24576
    buffer_load_dwordx4 v[156:159], v2, s[12:15], s53 offen offset:1024 sc1
    v_mfma_f32_32x32x16_bf16 v[20:35], v[232:235], v[96:99], v[20:35]
    ds_read_b64_tr_b16 v[226:227], v209 offset:9216
    v_mfma_f32_32x32x16_bf16 v[36:51], v[236:239], v[92:95], v[36:51]
    ds_read_b64_tr_b16 v[228:229], v210 offset:8192
    s_add_u32 s53, s49, 24576
    buffer_load_dwordx4 v[160:163], v2, s[12:15], s53 offen offset:1024 sc1
    v_mfma_f32_32x32x16_bf16 v[52:67], v[236:239], v[96:99], v[52:67]
    ds_read_b64_tr_b16 v[230:231], v210 offset:9216
    s_waitcnt vmcnt(15)
    v_mfma_f32_32x32x16_bf16 v[4:19], a[8:11], v[100:103], v[4:19]
    s_add_u32 s53, s48, 0
    buffer_load_dwordx4 v[164:167], v2, s[12:15], s53 offen offset:2048 sc1
    v_mfma_f32_32x32x16_bf16 v[20:35], a[8:11], v[104:107], v[20:35]
    v_mfma_f32_32x32x16_bf16 v[36:51], a[12:15], v[100:103], v[36:51]
    s_add_u32 s53, s49, 0
    buffer_load_dwordx4 v[168:171], v2, s[12:15], s53 offen offset:2048 sc1
    v_mfma_f32_32x32x16_bf16 v[52:67], a[12:15], v[104:107], v[52:67]
    s_waitcnt vmcnt(15)
    v_mfma_f32_32x32x16_bf16 v[4:19], a[64:67], v[108:111], v[4:19]
    s_add_u32 s53, s48, 8192
    buffer_load_dwordx4 v[172:175], v2, s[12:15], s53 offen offset:1024 sc1
    v_mfma_f32_32x32x16_bf16 v[20:35], a[64:67], v[112:115], v[20:35]
    v_mfma_f32_32x32x16_bf16 v[36:51], a[68:71], v[108:111], v[36:51]
    s_add_u32 s53, s49, 8192
    buffer_load_dwordx4 v[176:179], v2, s[12:15], s53 offen offset:1024 sc1
    v_mfma_f32_32x32x16_bf16 v[52:67], a[68:71], v[112:115], v[52:67]
    s_waitcnt lgkmcnt(8)
    s_waitcnt vmcnt(15)
    v_mfma_f32_32x32x16_bf16 v[4:19], v[240:243], v[116:119], v[4:19]
    ds_read_b64_tr_b16 v[232:233], v211 offset:6144
    s_add_u32 s53, s48, 16384
    buffer_load_dwordx4 v[180:183], v2, s[12:15], s53 offen offset:2048 sc1
    v_mfma_f32_32x32x16_bf16 v[20:35], v[240:243], v[120:123], v[20:35]
    ds_read_b64_tr_b16 v[234:235], v211 offset:7168
    v_mfma_f32_32x32x16_bf16 v[36:51], v[244:247], v[116:119], v[36:51]
    ds_read_b64_tr_b16 v[236:237], v212 offset:6144
    s_add_u32 s53, s49, 16384
    buffer_load_dwordx4 v[184:187], v2, s[12:15], s53 offen offset:2048 sc1
    v_mfma_f32_32x32x16_bf16 v[52:67], v[244:247], v[120:123], v[52:67]
    ds_read_b64_tr_b16 v[238:239], v212 offset:7168
    s_waitcnt lgkmcnt(8)
    s_waitcnt vmcnt(14)
    v_mfma_f32_32x32x16_bf16 v[4:19], v[248:251], v[124:127], v[4:19]
    ds_read_b64_tr_b16 v[240:241], v209 offset:4096
    s_add_u32 s99, s99, 131072
    s_mov_b64 exec, 0xff
    buffer_load_dword v200, v201, s[12:15], s99 offen sc1
    s_mov_b64 exec, -1
    s_add_u32 s53, s48, 20480
    buffer_load_dwordx4 v[188:191], v2, s[12:15], s53 offen offset:3072 sc1
    v_mfma_f32_32x32x16_bf16 v[20:35], v[248:251], v[128:131], v[20:35]
    ds_read_b64_tr_b16 v[242:243], v209 offset:5120
    v_mfma_f32_32x32x16_bf16 v[36:51], v[252:255], v[124:127], v[36:51]
    ds_read_b64_tr_b16 v[244:245], v210 offset:4096
    s_add_u32 s53, s49, 20480
    buffer_load_dwordx4 v[192:195], v2, s[12:15], s53 offen offset:3072 sc1
    v_mfma_f32_32x32x16_bf16 v[52:67], v[252:255], v[128:131], v[52:67]
    ds_read_b64_tr_b16 v[246:247], v210 offset:5120
Lpage10:
    s_cbranch_execz Lvis2
    s_waitcnt vmcnt(15)
    v_mfma_f32_32x32x16_bf16 v[4:19], a[32:35], v[132:135], v[4:19]
    s_add_u32 s53, s48, 0
    buffer_load_dwordx4 v[68:71], v2, s[12:15], s53 offen offset:3072 sc1
    v_mfma_f32_32x32x16_bf16 v[20:35], a[32:35], v[136:139], v[20:35]
    v_mfma_f32_32x32x16_bf16 v[36:51], a[36:39], v[132:135], v[36:51]
    s_add_u32 s53, s49, 0
    buffer_load_dwordx4 v[72:75], v2, s[12:15], s53 offen offset:3072 sc1
    v_mfma_f32_32x32x16_bf16 v[52:67], a[36:39], v[136:139], v[52:67]
    s_waitcnt vmcnt(15)
    v_mfma_f32_32x32x16_bf16 v[4:19], a[88:91], v[140:143], v[4:19]
    s_add_u32 s53, s48, 8192
    buffer_load_dwordx4 v[76:79], v2, s[12:15], s53 offen offset:2048 sc1
    v_mfma_f32_32x32x16_bf16 v[20:35], a[88:91], v[144:147], v[20:35]
    v_mfma_f32_32x32x16_bf16 v[36:51], a[92:95], v[140:143], v[36:51]
    s_add_u32 s53, s49, 8192
    buffer_load_dwordx4 v[80:83], v2, s[12:15], s53 offen offset:2048 sc1
    v_mfma_f32_32x32x16_bf16 v[52:67], a[92:95], v[144:147], v[52:67]
    s_waitcnt lgkmcnt(8)
    s_waitcnt vmcnt(15)
    v_mfma_f32_32x32x16_bf16 v[4:19], v[224:227], v[148:151], v[4:19]
    ds_read_b64_tr_b16 v[248:249], v211 offset:2048
    s_add_u32 s53, s48, 16384
    buffer_load_dwordx4 v[84:87], v2, s[12:15], s53 offen offset:3072 sc1
    v_mfma_f32_32x32x16_bf16 v[20:35], v[224:227], v[152:155], v[20:35]
    ds_read_b64_tr_b16 v[250:251], v211 offset:3072
    v_mfma_f32_32x32x16_bf16 v[36:51], v[228:231], v[148:151], v[36:51]
    ds_read_b64_tr_b16 v[252:253], v212 offset:2048
    s_add_u32 s53, s49, 16384
    buffer_load_dwordx4 v[88:91], v2, s[12:15], s53 offen offset:3072 sc1
    v_mfma_f32_32x32x16_bf16 v[52:67], v[228:231], v[152:155], v[52:67]
    ds_read_b64_tr_b16 v[254:255], v212 offset:3072
    s_waitcnt lgkmcnt(8)
    s_waitcnt vmcnt(15)
    v_mfma_f32_32x32x16_bf16 v[4:19], v[232:235], v[156:159], v[4:19]
    ds_read_b64_tr_b16 v[224:225], v209 offset:6144
    s_add_u32 s53, s48, 24576
    buffer_load_dwordx4 v[92:95], v2, s[12:15], s53 offen offset:0 sc1
    v_mfma_f32_32x32x16_bf16 v[20:35], v[232:235], v[160:163], v[20:35]
    ds_read_b64_tr_b16 v[226:227], v209 offset:7168
    v_mfma_f32_32x32x16_bf16 v[36:51], v[236:239], v[156:159], v[36:51]
    ds_read_b64_tr_b16 v[228:229], v210 offset:6144
    s_add_u32 s53, s49, 24576
    buffer_load_dwordx4 v[96:99], v2, s[12:15], s53 offen offset:0 sc1
    v_mfma_f32_32x32x16_bf16 v[52:67], v[236:239], v[160:163], v[52:67]
    ds_read_b64_tr_b16 v[230:231], v210 offset:7168
    s_waitcnt vmcnt(15)
    v_mfma_f32_32x32x16_bf16 v[4:19], a[16:19], v[164:167], v[4:19]
    s_mov_b64 exec, 0xff
    s_mov_b32 s98, 0x200000
    s_waitcnt vmcnt(10)
    v_cmp_ne_u32 vcc, s24, v200
    s_nop 1
    s_cbranch_vccz Lpoll9d
Lpoll9:
    buffer_load_dword v200, v201, s[12:15], s99 offen sc1
    s_sub_u32 s98, s98, 1
    s_waitcnt vmcnt(0)
    s_cbranch_scc1 Lpoll9d
    v_cmp_ne_u32 vcc, s24, v200
    s_nop 1
    s_cbranch_vccnz Lpoll9
Lpoll9d:
    s_mov_b64 exec, -1
    s_add_u32 s53, s48, 4096
    buffer_load_dwordx4 v[100:103], v2, s[12:15], s53 offen offset:1024 sc1
    v_mfma_f32_32x32x16_bf16 v[20:35], a[16:19], v[168:171], v[20:35]
    v_mfma_f32_32x32x16_bf16 v[36:51], a[20:23], v[164:167], v[36:51]
    s_add_u32 s53, s49, 4096
    buffer_load_dwordx4 v[104:107], v2, s[12:15], s53 offen offset:1024 sc1
    v_mfma_f32_32x32x16_bf16 v[52:67], a[20:23], v[168:171], v[52:67]
    v_mfma_f32_32x32x16_bf16 v[4:19], a[72:75], v[172:175], v[4:19]
    s_add_u32 s53, s48, 12288
    buffer_load_dwordx4 v[108:111], v2, s[12:15], s53 offen offset:0 sc1
    v_mfma_f32_32x32x16_bf16 v[20:35], a[72:75], v[176:179], v[20:35]
    v_mfma_f32_32x32x16_bf16 v[36:51], a[76:79], v[172:175], v[36:51]
    s_add_u32 s53, s49, 12288
    buffer_load_dwordx4 v[112:115], v2, s[12:15], s53 offen offset:0 sc1
    v_mfma_f32_32x32x16_bf16 v[52:67], a[76:79], v[176:179], v[52:67]
    s_waitcnt lgkmcnt(8)
    v_mfma_f32_32x32x16_bf16 v[4:19], v[240:243], v[180:183], v[4:19]
    ds_read_b64_tr_b16 v[232:233], v211 offset:4096
    s_add_u32 s53, s48, 12288
    buffer_load_dwordx4 v[116:119], v2, s[12:15], s53 offen offset:2048 sc1
    v_mfma_f32_32x32x16_bf16 v[20:35], v[240:243], v[184:187], v[20:35]
    ds_read_b64_tr_b16 v[234:235], v211 offset:5120
    v_mfma_f32_32x32x16_bf16 v[36:51], v[244:247], v[180:183], v[36:51]
    ds_read_b64_tr_b16 v[236:237], v212 offset:4096
    s_add_u32 s53, s49, 12288
    buffer_load_dwordx4 v[120:123], v2, s[12:15], s53 offen offset:2048 sc1
    v_mfma_f32_32x32x16_bf16 v[52:67], v[244:247], v[184:187], v[52:67]
    ds_read_b64_tr_b16 v[238:239], v212 offset:5120
    s_waitcnt lgkmcnt(8)
    s_waitcnt vmcnt(14)
    v_mfma_f32_32x32x16_bf16 v[4:19], v[248:251], v[188:191], v[4:19]
    ds_read_b64_tr_b16 v[240:241], v211 offset:8192
    s_add_u32 s53, s48, 24576
    buffer_load_dwordx4 v[124:127], v2, s[12:15], s53 offen offset:2048 sc1
    v_mfma_f32_32x32x16_bf16 v[20:35], v[248:251], v[192:195], v[20:35]
    ds_read_b64_tr_b16 v[242:243], v211 offset:9216
    v_mfma_f32_32x32x16_bf16 v[36:51], v[252:255], v[188:191], v[36:51]
    ds_read_b64_tr_b16 v[244:245], v212 offset:8192
    s_add_u32 s53, s49, 24576
    buffer_load_dwordx4 v[128:131], v2, s[12:15], s53 offen offset:2048 sc1
    v_mfma_f32_32x32x16_bf16 v[52:67], v[252:255], v[192:195], v[52:67]
    ds_read_b64_tr_b16 v[246:247], v212 offset:9216
    s_waitcnt vmcnt(14)
    v_mfma_f32_32x32x16_bf16 v[4:19], a[24:27], v[68:71], v[4:19]
    s_add_u32 s53, s48, 4096
    buffer_load_dwordx4 v[132:135], v2, s[12:15], s53 offen offset:2048 sc1
    v_mfma_f32_32x32x16_bf16 v[20:35], a[24:27], v[72:75], v[20:35]
    v_mfma_f32_32x32x16_bf16 v[36:51], a[28:31], v[68:71], v[36:51]
    s_add_u32 s53, s49, 4096
    buffer_load_dwordx4 v[136:139], v2, s[12:15], s53 offen offset:2048 sc1
    v_mfma_f32_32x32x16_bf16 v[52:67], a[28:31], v[72:75], v[52:67]
    s_waitcnt vmcnt(14)
    v_mfma_f32_32x32x16_bf16 v[4:19], a[80:83], v[76:79], v[4:19]
    s_add_u32 s53, s48, 12288
    buffer_load_dwordx4 v[140:143], v2, s[12:15], s53 offen offset:1024 sc1
    v_mfma_f32_32x32x16_bf16 v[20:35], a[80:83], v[80:83], v[20:35]
    v_mfma_f32_32x32x16_bf16 v[36:51], a[84:87], v[76:79], v[36:51]
    s_add_u32 s53, s49, 12288
    buffer_load_dwordx4 v[144:147], v2, s[12:15], s53 offen offset:1024 sc1
    v_mfma_f32_32x32x16_bf16 v[52:67], a[84:87], v[80:83], v[52:67]
    s_waitcnt lgkmcnt(8)
    s_waitcnt vmcnt(14)
    v_mfma_f32_32x32x16_bf16 v[4:19], v[224:227], v[84:87], v[4:19]
    ds_read_b64_tr_b16 v[248:249], v211 offset:10240
    s_add_u32 s53, s48, 12288
    buffer_load_dwordx4 v[148:151], v2, s[12:15], s53 offen offset:3072 sc1
    v_mfma_f32_32x32x16_bf16 v[20:35], v[224:227], v[88:91], v[20:35]
    ds_read_b64_tr_b16 v[250:251], v211 offset:11264
    v_mfma_f32_32x32x16_bf16 v[36:51], v[228:231], v[84:87], v[36:51]
    ds_read_b64_tr_b16 v[252:253], v212 offset:10240
    s_add_u32 s53, s49, 12288
    buffer_load_dwordx4 v[152:155], v2, s[12:15], s53 offen offset:3072 sc1
    v_mfma_f32_32x32x16_bf16 v[52:67], v[228:231], v[88:91], v[52:67]
    ds_read_b64_tr_b16 v[254:255], v212 offset:11264
    s_waitcnt lgkmcnt(8)
    s_waitcnt vmcnt(14)
    v_mfma_f32_32x32x16_bf16 v[4:19], v[232:235], v[92:95], v[4:19]
    s_add_u32 s53, s48, 24576
    buffer_load_dwordx4 v[156:159], v2, s[12:15], s53 offen offset:3072 sc1
    v_mfma_f32_32x32x16_bf16 v[20:35], v[232:235], v[96:99], v[20:35]
    v_mfma_f32_32x32x16_bf16 v[36:51], v[236:239], v[92:95], v[36:51]
    s_add_u32 s53, s49, 24576
    buffer_load_dwordx4 v[160:163], v2, s[12:15], s53 offen offset:3072 sc1
    v_mfma_f32_32x32x16_bf16 v[52:67], v[236:239], v[96:99], v[52:67]
    s_waitcnt vmcnt(14)
    v_mfma_f32_32x32x16_bf16 v[4:19], a[40:43], v[100:103], v[4:19]
    v_mfma_f32_32x32x16_bf16 v[20:35], a[40:43], v[104:107], v[20:35]
    v_mfma_f32_32x32x16_bf16 v[36:51], a[44:47], v[100:103], v[36:51]
    v_mfma_f32_32x32x16_bf16 v[52:67], a[44:47], v[104:107], v[52:67]
    s_barrier
    s_waitcnt vmcnt(12)
    v_mfma_f32_32x32x16_bf16 v[4:19], a[96:99], v[108:111], v[4:19]
    v_mfma_f32_32x32x16_bf16 v[20:35], a[96:99], v[112:115], v[20:35]
    v_mfma_f32_32x32x16_bf16 v[36:51], a[100:103], v[108:111], v[36:51]
    v_mfma_f32_32x32x16_bf16 v[52:67], a[100:103], v[112:115], v[52:67]
    s_waitcnt vmcnt(10)
    v_mfma_f32_32x32x16_bf16 v[4:19], a[112:115], v[116:119], v[4:19]
    v_mfma_f32_32x32x16_bf16 v[20:35], a[112:115], v[120:123], v[20:35]
    v_mfma_f32_32x32x16_bf16 v[36:51], a[116:119], v[116:119], v[36:51]
    v_mfma_f32_32x32x16_bf16 v[52:67], a[116:119], v[120:123], v[52:67]
    s_waitcnt lgkmcnt(4)
    s_waitcnt vmcnt(8)
    v_mfma_f32_32x32x16_bf16 v[4:19], v[240:243], v[124:127], v[4:19]
    v_mfma_f32_32x32x16_bf16 v[20:35], v[240:243], v[128:131], v[20:35]
    v_mfma_f32_32x32x16_bf16 v[36:51], v[244:247], v[124:127], v[36:51]
    v_mfma_f32_32x32x16_bf16 v[52:67], v[244:247], v[128:131], v[52:67]
    s_waitcnt vmcnt(6)
    v_mfma_f32_32x32x16_bf16 v[4:19], a[48:51], v[132:135], v[4:19]
    v_mfma_f32_32x32x16_bf16 v[20:35], a[48:51], v[136:139], v[20:35]
    v_mfma_f32_32x32x16_bf16 v[36:51], a[52:55], v[132:135], v[36:51]
    v_mfma_f32_32x32x16_bf16 v[52:67], a[52:55], v[136:139], v[52:67]
    s_waitcnt lgkmcnt(0)
    s_waitcnt vmcnt(4)
    v_mfma_f32_32x32x16_bf16 v[20:35], a[104:107], v[144:147], v[20:35]
    s_waitcnt vmcnt(2)
    v_mfma_f32_32x32x16_bf16 v[20:35], a[120:123], v[152:155], v[20:35]
    s_waitcnt vmcnt(0)
    v_mfma_f32_32x32x16_bf16 v[20:35], v[248:251], v[160:163], v[20:35]
    v_mfma_f32_32x32x16_bf16 v[36:51], a[108:111], v[140:143], v[36:51]
    v_mfma_f32_32x32x16_bf16 v[36:51], a[124:127], v[148:151], v[36:51]
    v_mfma_f32_32x32x16_bf16 v[36:51], v[252:255], v[156:159], v[36:51]
    s_nop 8
    ds_write_b128 v205, v[20:23] offset:0
    ds_write_b128 v205, v[24:27] offset:1024
    ds_write_b128 v205, v[28:31] offset:2048
    ds_write_b128 v205, v[32:35] offset:3072
    v_mfma_f32_32x32x16_bf16 v[52:67], a[108:111], v[144:147], v[52:67]
    v_mfma_f32_32x32x16_bf16 v[52:67], a[124:127], v[152:155], v[52:67]
    v_mfma_f32_32x32x16_bf16 v[52:67], v[252:255], v[160:163], v[52:67]
    ds_write_b128 v206, v[36:39] offset:4096
    ds_write_b128 v206, v[40:43] offset:5120
    ds_write_b128 v206, v[44:47] offset:6144
    ds_write_b128 v206, v[48:51] offset:7168
    v_mfma_f32_32x32x16_bf16 v[4:19], a[104:107], v[140:143], v[4:19]
    v_mfma_f32_32x32x16_bf16 v[4:19], a[120:123], v[148:151], v[4:19]
    v_mfma_f32_32x32x16_bf16 v[4:19], v[248:251], v[156:159], v[4:19]
    s_nop 4
    ds_write_b128 v207, v[52:55] offset:8192
    ds_write_b128 v207, v[56:59] offset:9216
    ds_write_b128 v207, v[60:63] offset:10240
    ds_write_b128 v207, v[64:67] offset:11264
    s_mov_b32 s16, s46
    s_mov_b32 s17, s47
    s_mov_b32 s18, 1835008
    s_mov_b32 s19, 0x20000
    v_and_b32 v201, 31, v1
    v_lshrrev_b32 v200, 5, v1
    v_mul_u32_u24 v201, 896, v201
    v_lshl_add_u32 v201, v200, 4, v201
    s_mul_i32 s53, s54, 28672
    s_lshl_b32 s55, s56, 6
    s_add_u32 s53, s53, s55
    s_waitcnt lgkmcnt(0)
    s_barrier
    ds_read_b128 v[20:23], v204 offset:0
    ds_read_b128 v[24:27], v204 offset:1024
    ds_read_b128 v[28:31], v204 offset:2048
    ds_read_b128 v[32:35], v204 offset:3072
    ds_read_b128 v[36:39], v204 offset:4096
    ds_read_b128 v[40:43], v204 offset:5120
    ds_read_b128 v[44:47], v204 offset:6144
    ds_read_b128 v[48:51], v204 offset:7168
    ds_read_b128 v[52:55], v204 offset:8192
    ds_read_b128 v[56:59], v204 offset:9216
    ds_read_b128 v[60:63], v204 offset:10240
    ds_read_b128 v[64:67], v204 offset:11264
    s_waitcnt lgkmcnt(8)
    v_pk_add_f32 v[4:5], v[4:5], v[20:21]
    v_pk_add_f32 v[6:7], v[6:7], v[22:23]
    v_pk_add_f32 v[8:9], v[8:9], v[24:25]
    v_pk_add_f32 v[10:11], v[10:11], v[26:27]
    v_pk_add_f32 v[12:13], v[12:13], v[28:29]
    v_pk_add_f32 v[14:15], v[14:15], v[30:31]
    v_pk_add_f32 v[16:17], v[16:17], v[32:33]
    v_pk_add_f32 v[18:19], v[18:19], v[34:35]
    s_waitcnt lgkmcnt(4)
    v_pk_add_f32 v[4:5], v[4:5], v[36:37]
    v_pk_add_f32 v[6:7], v[6:7], v[38:39]
    v_pk_add_f32 v[8:9], v[8:9], v[40:41]
    v_pk_add_f32 v[10:11], v[10:11], v[42:43]
    v_pk_add_f32 v[12:13], v[12:13], v[44:45]
    v_pk_add_f32 v[14:15], v[14:15], v[46:47]
    v_pk_add_f32 v[16:17], v[16:17], v[48:49]
    v_pk_add_f32 v[18:19], v[18:19], v[50:51]
    s_waitcnt lgkmcnt(0)
    v_pk_add_f32 v[4:5], v[4:5], v[52:53]
    v_pk_add_f32 v[6:7], v[6:7], v[54:55]
    v_pk_add_f32 v[8:9], v[8:9], v[56:57]
    v_pk_add_f32 v[10:11], v[10:11], v[58:59]
    v_pk_add_f32 v[12:13], v[12:13], v[60:61]
    v_pk_add_f32 v[14:15], v[14:15], v[62:63]
    v_pk_add_f32 v[16:17], v[16:17], v[64:65]
    v_pk_add_f32 v[18:19], v[18:19], v[66:67]
    v_cvt_pk_bf16_f32 v20, v4, v5
    v_cvt_pk_bf16_f32 v21, v6, v7
    v_cvt_pk_bf16_f32 v22, v8, v9
    v_cvt_pk_bf16_f32 v23, v10, v11
    v_cvt_pk_bf16_f32 v24, v12, v13
    v_cvt_pk_bf16_f32 v25, v14, v15
    v_cvt_pk_bf16_f32 v26, v16, v17
    v_cvt_pk_bf16_f32 v27, v18, v19
    v_permlane32_swap_b32 v20, v22
    v_permlane32_swap_b32 v21, v23
    v_permlane32_swap_b32 v24, v26
    v_permlane32_swap_b32 v25, v27
    buffer_store_dwordx4 v[20:23], v201, s[16:19], s53 offen nt
    buffer_store_dwordx4 v[24:27], v201, s[16:19], s53 offen offset:32 nt
Lfin:
Lend:
    s_endpgm
Lfb:
    v_cmp_lt_u32 vcc, 31, v1
    s_lshl_b32 s54, s25, 18
    s_mov_b32 s55, 64
    v_mov_b32 v196, 0xff7fffff
    v_cndmask_b32_e64 v58, v58, 0, vcc
    v_cndmask_b32_e64 v59, v59, 0, vcc
Lfb1:
    buffer_load_dwordx4 v[4:7], v2, s[12:15], s54 offen sc1
    buffer_load_dwordx4 v[8:11], v2, s[12:15], s54 offen offset:1024 sc1
    s_add_u32 s54, s54, 4096
    s_waitcnt vmcnt(0)
    v_mfma_f32_32x32x16_bf16 v[148:163], v[4:7], v[52:55], 0
    v_mfma_f32_32x32x16_bf16 v[148:163], v[8:11], v[56:59], v[148:163]
    s_nop 11
    v_max3_f32 v196, v196, v148, v149
    v_max3_f32 v196, v196, v150, v151
    v_max3_f32 v196, v196, v152, v153
    v_max3_f32 v196, v196, v154, v155
    v_max3_f32 v196, v196, v156, v157
    v_max3_f32 v196, v196, v158, v159
    v_max3_f32 v196, v196, v160, v161
    v_max3_f32 v196, v196, v162, v163
    s_sub_u32 s55, s55, 1
    s_cmp_lg_u32 s55, 0
    s_cbranch_scc1 Lfb1
    v_mov_b32 v197, v196
    s_nop 1
    v_permlane32_swap_b32 v196, v197
    v_max_f32 v196, v196, v197
    v_cvt_pk_bf16_f32 v197, -v196, 0
    v_lshlrev_b32 v198, 16, v197
    v_sub_f32 v196, -v196, v198
    v_cvt_pk_bf16_f32 v198, v196, 0
    v_lshlrev_b32 v198, 16, v198
    v_sub_f32 v196, v196, v198
    v_or_b32 v197, v197, v198
    v_cvt_pk_bf16_f32 v196, v196, 0
    v_cndmask_b32 v58, v58, v197, vcc
    v_cndmask_b32 v59, v59, v196, vcc
    s_lshl_b32 s54, s25, 18
    s_mov_b32 s55, 64
    v_mov_b32 v84, 0
    v_mov_b32 v85, 0
    v_mov_b32 v86, 0
    v_mov_b32 v87, 0
    v_mov_b32 v88, 0
    v_mov_b32 v89, 0
    v_mov_b32 v90, 0
    v_mov_b32 v91, 0
    v_mov_b32 v92, 0
    v_mov_b32 v93, 0
    v_mov_b32 v94, 0
    v_mov_b32 v95, 0
    v_mov_b32 v96, 0
    v_mov_b32 v97, 0
    v_mov_b32 v98, 0
    v_mov_b32 v99, 0
Lfb2:
    buffer_load_dwordx4 v[4:7], v2, s[12:15], s54 offen offset:0 sc1
    buffer_load_dwordx4 v[8:11], v2, s[12:15], s54 offen offset:1024 sc1
    buffer_load_dwordx4 v[12:15], v2, s[12:15], s54 offen offset:2048 sc1
    buffer_load_dwordx4 v[16:19], v2, s[12:15], s54 offen offset:3072 sc1
    s_add_u32 s54, s54, 4096
    s_waitcnt vmcnt(0)
    v_mfma_f32_32x32x16_bf16 v[148:163], v[4:7], v[52:55], 0
    v_mfma_f32_32x32x16_bf16 v[148:163], v[8:11], v[56:59], v[148:163]
    s_nop 11
    v_exp_f32 v148, v148
    v_exp_f32 v149, v149
    v_exp_f32 v150, v150
    v_exp_f32 v151, v151
    v_exp_f32 v152, v152
    v_exp_f32 v153, v153
    v_exp_f32 v154, v154
    v_exp_f32 v155, v155
    v_exp_f32 v156, v156
    v_exp_f32 v157, v157
    v_exp_f32 v158, v158
    v_exp_f32 v159, v159
    v_exp_f32 v160, v160
    v_exp_f32 v161, v161
    v_exp_f32 v162, v162
    v_exp_f32 v163, v163
    v_cvt_pk_bf16_f32 v180, v148, v149
    v_cvt_pk_bf16_f32 v181, v150, v151
    v_cvt_pk_bf16_f32 v182, v152, v153
    v_cvt_pk_bf16_f32 v183, v154, v155
    v_cvt_pk_bf16_f32 v184, v156, v157
    v_cvt_pk_bf16_f32 v185, v158, v159
    v_cvt_pk_bf16_f32 v186, v160, v161
    v_cvt_pk_bf16_f32 v187, v162, v163
    v_mfma_f32_32x32x16_bf16 v[84:99], v[12:15], v[180:183], v[84:99]
    s_nop 0
    v_mfma_f32_32x32x16_bf16 v[84:99], v[16:19], v[184:187], v[84:99]
    s_sub_u32 s55, s55, 1
    s_cmp_lg_u32 s55, 0
    s_nop 7
    s_cbranch_scc1 Lfb2
    s_nop 7
    v_mov_b32 v196, v96
    v_mov_b32 v197, v96
    s_nop 1
    v_permlane32_swap_b32 v196, v197
    v_rcp_f32 v198, v197
    s_branch Lfb_ret
Lcode_end:
Lpage11:
    s_branch Lvis2
Lpage12:
    s_branch Lvis2
.section .rodata,"a"
.p2align 6
.amdhsa_kernel sequential_preLN__mha_block__glu_gated_swiglu__prompt_kernel
  .amdhsa_next_free_vgpr 512
  .amdhsa_next_free_sgpr 102
  .amdhsa_accum_offset 256
  .amdhsa_group_segment_fixed_size 0
  .amdhsa_kernarg_size 80
  .amdhsa_user_sgpr_count 2
  .amdhsa_user_sgpr_kernarg_segment_ptr 1
  .amdhsa_system_sgpr_workgroup_id_x 1
.end_amdhsa_kernel
```
